```python
import torch

def _softmax(x, axis=-1):
    return torch.softmax(x, dim=axis)
def _gelu(x):
    return torch.nn.functional.gelu(x, approximate="tanh")
def _silu(x):
    return torch.nn.functional.silu(x)
def _sigmoid(x):
    return torch.sigmoid(x)
def _layernorm(x, axis=-1, eps=1e-5):
    m = x.mean(dim=axis, keepdim=True)
    v = x.var(dim=axis, keepdim=True, unbiased=False)
    return (x - m) / torch.sqrt(v + eps)
def _scatter_add(tgt, idx, src, axis=0):
    return tgt.clone().index_add_(axis, idx, src)
def _segment_sum(src, seg, n):
    out = torch.zeros((n,) + src.shape[1:], dtype=src.dtype)
    return out.index_add_(0, seg, src)
def _pad(x, pw):
    flat = tuple(v for pair in reversed(pw) for v in pair)
    return torch.nn.functional.pad(x, flat)

kernel_name = 'sequential_preLN__spectral_gfnet__moe_arch_mod__prompt'

def setup_inputs():

    _w = (lambda a: (lambda t: t.to(torch.bfloat16) if t.is_floating_point() else t)(torch.as_tensor(a)))
    def _A_setup():
        B, S, D = 1, 2048, 576
        Df = D // 2 + 1
        return {
            "x": _w((lambda *s: torch.randn(*s, dtype=torch.bfloat16) * 0.05)(B, S, D)),
            "w_r": _w((lambda *s: torch.randn(*s, dtype=torch.bfloat16) * 0.8)(S, Df) * 0.02),
            "w_i": _w((lambda *s: torch.randn(*s, dtype=torch.bfloat16) * 0.8)(S, Df) * 0.02),
        }
    _A_in = _A_setup()

    def _B_setup():
        B, S, D, F, C = 1, 2048, 576, 4608, 8
        return {
            "x": _w((lambda *s: torch.randn(*s, dtype=torch.bfloat16) * 0.05)(B, S, D)),
            "w_r": _w((lambda *s: torch.randn(*s, dtype=torch.bfloat16) * 0.2)(D)),
            "w_gate": _w((lambda *s: torch.randn(*s, dtype=torch.bfloat16) * 0.2)(D, F)),
            "w_up": _w((lambda *s: torch.randn(*s, dtype=torch.bfloat16) * 0.2)(D, F)),
            "w_down": _w((lambda *s: torch.randn(*s, dtype=torch.bfloat16) * 0.2)(F, D)),
        }
    _B_in = _B_setup()

    return {
        "A_x": _A_in["x"],
        "A_w_r": _A_in["w_r"],
        "A_w_i": _A_in["w_i"],
        "B_x": _B_in["x"],
        "B_w_r": _B_in["w_r"],
        "B_w_gate": _B_in["w_gate"],
        "B_w_up": _B_in["w_up"],
        "B_w_down": _B_in["w_down"],
    }

def reference(A_x, A_w_r, A_w_i, B_x, B_w_r, B_w_gate, B_w_up, B_w_down):
    def _A_ref(x, w_r, w_i):
        B, S, D = x.shape
        X = (lambda x, axes=(-2,-1): torch.fft.rfft2(x.float(), dim=axes))(x, axes=(-2, -1))
        W = w_r + 1j * w_i
        X = X * W
        y = (lambda x, s, axes=(-2,-1): torch.fft.irfft2(x, s=s, dim=axes).to(torch.bfloat16))(X, (S, D), axes=(-2, -1))
        return y

    def _B_ref(x, w_r, w_gate, w_up, w_down):
        B, S, D = x.shape
        C = 8
        r = x @ w_r
        idx = torch.argsort(-r, axis=-1)[:, :C]
        idx_e = (lambda x, n, axis: torch.repeat_interleave(x, n, dim=axis))(idx.reshape(B, C, 1), D, axis=2)
        x_sel = (lambda x, i, axis: torch.take_along_dim(x, i, dim=axis))(x, idx_e, axis=1)
        g = _silu(x_sel @ w_gate)
        u = x_sel @ w_up
        y = (g * u) @ w_down
        r_sel = _sigmoid((lambda x, i, axis: torch.take_along_dim(x, i, dim=axis))(r, idx, axis=1))
        y = y * r_sel.reshape(B, C, 1)
        b_off = (torch.arange(B) * S).reshape(B, 1)
        flat_idx = (idx + b_off).reshape(B * C)
        zero = (x * 0.0).reshape(B * S, D)
        upd = _scatter_add(zero, flat_idx, y.reshape(B * C, D), axis=0)
        return x + upd.reshape(B, S, D)

    x = A_x
    h = x + _A_ref(_layernorm(x, axis=-1), A_w_r, A_w_i)
    h2 = h + _B_ref(_layernorm(h, axis=-1), B_w_r, B_w_gate, B_w_up, B_w_down)
    return h2
```

```asm
; @launch kernel=phK_kernel grid=(256,1,1) block=(512,1,1) lds=160256
.amdgcn_target "amdgcn-amd-amdhsa--gfx950"
.text
.globl phK_kernel
.p2align 8
.type phK_kernel,@function
phK_kernel:
    s_cmp_ge_u32 s2, 256
    s_cbranch_scc1 phK_end
    s_memrealtime s[70:71]
    s_load_dwordx16 s[36:51], s[0:1], 0
    s_setprio 2
    s_load_dwordx2 s[52:53], s[0:1], 64
    s_load_dwordx2 s[54:55], s[0:1], 80
    v_lshrrev_b32 v2, 6, v0
    v_lshlrev_b32 v7, 4, v0
    v_readfirstlane_b32 s3, v2
    s_getpc_b64 s[28:29]
pc_1:
    s_add_u32 s28, s28, tblS-pc_1
    s_addc_u32 s29, s29, 0
    s_and_b32 s29, s29, 0xffff
    s_mov_b32 s30, 65536
    s_mov_b32 s31, 0x00020000
    s_cmp_lt_u32 s2, 104
    s_cselect_b32 s75, 81920, 0
    s_lshl_b32 s56, s3, 10
    s_add_u32 s56, s56, s75
    s_add_u32 m0, s56, 36864
    s_movk_i32 s57, 0x4000
    s_movk_i32 s58, 0x6000
    buffer_load_dwordx4 v7, s[28:31], s57 offen lds
    s_add_u32 m0, s56, 45056
    s_mov_b32 s57, 0x8000
    buffer_load_dwordx4 v7, s[28:31], s58 offen lds
    s_add_u32 m0, s56, 53248
    s_mov_b32 s59, 40960
    buffer_load_dwordx4 v7, s[28:31], s57 offen lds
    buffer_load_dwordx4 v[200:203], v7, s[28:31], s59 offen
    s_add_u32 m0, s56, 20480
    v_and_b32 v1, 63, v0
    v_lshlrev_b32 v5, 4, v1
    s_lshr_b32 s35, s3, 2
    v_and_b32 v3, 15, v0
    v_bfe_u32 v4, v0, 4, 2
    v_lshlrev_b32 v6, 2, v1
    s_and_b32 s34, s3, 3
    s_and_b32 s32, s2, 7
    s_lshr_b32 s33, s2, 3
    s_lshl_b32 s60, s3, 8
    s_add_u32 s60, s60, s2
    s_mul_i32 s61, s60, 1152
    v_mov_b32 v254, 0
    v_mov_b32 v52, 0
    s_mov_b32 s14, 2359296
    s_mov_b32 s15, 0x00020000
    s_mov_b32 s26, 20971520
    s_mov_b32 s27, 0x00020000
    s_mov_b32 s6, 1183744
    s_mov_b32 s7, 0x00020000
    v_and_b32 v8, 31, v1
    v_lshrrev_b32 v9, 5, v1
    v_mul_u32_u24 v10, 36, v8
    v_mad_u32_u24 v10, v9, 20, v10
    v_lshlrev_b32 v8, 7, v8
    v_min_u32 v8, 592, v8
    v_mul_u32_u24 v9, 4624, v9
    v_add_u32 v8, v8, v9
    s_mul_i32 s62, s33, 36992
    s_mul_i32 s63, s34, 9248
    s_add_u32 s62, s62, s63
    s_mul_i32 s63, s32, 578
    s_add_u32 s62, s62, s63
    s_and_b32 s62, s62, -4
    s_sub_u32 s8, s28, tblS-phK_kernel
    s_subb_u32 s9, s29, 0
    s_mov_b32 s10, tblS-phK_kernel
    s_mov_b32 s11, 0x00020000
    s_sub_u32 s56, s2, 104
    s_lshr_b32 s56, s56, 3
    s_min_u32 s56, s56, 0x4000
    s_lshl_b32 s56, s56, 10
    s_mov_b32 s10, tblS-phK_kernel+65536
    s_cmp_eq_u32 s3, 6
    s_cselect_b32 s57, tblS-phK_kernel, 0
    s_cmp_eq_u32 s3, 5
    s_cselect_b32 s57, tblS-phK_kernel+49152, s57
    s_bitcmp0_b32 240, s3
    s_cselect_b32 s57, 0x1000000, s57
    s_add_u32 s56, s56, s57
    v_lshrrev_b32 v17, 3, v1
    v_lshlrev_b32 v17, 25, v17
    v_lshl_add_u32 v16, v1, 7, v17
    v_add_u32 v16, s56, v16
    v_mov_b32 v12, 0
    v_mov_b32 v13, 0
    v_mov_b32 v14, 0
    v_mov_b32 v15, 0
    v_lshlrev_b32 v11, 4, v3
    ds_write_b128 v11, v[12:15] offset:192
    s_waitcnt lgkmcnt(0)
    s_mov_b32 s12, s36
    s_and_b32 s13, s37, 0xffff
    buffer_load_dwordx4 v[48:51], v10, s[12:15], s61 offen
    s_mov_b32 exec_hi, 0
    buffer_load_dword v52, v10, s[12:15], s61 offen offset:16
    s_mov_b32 exec_hi, -1
    s_cmp_eq_u32 s3, 4
    s_cselect_b64 s[8:9], s[44:45], s[8:9]
    s_cselect_b32 s10, 1152, s10
    s_and_b32 s9, s9, 0xffff
    buffer_load_dword v255, v16, s[8:11], 0 offen
    s_mov_b32 s24, s54
    s_and_b32 s25, s55, 0xffff
    s_cmp_eq_u32 s35, 1
    s_cselect_b64 s[4:5], s[40:41], s[38:39]
    s_and_b32 s5, s5, 0xffff
    s_mov_b32 s71, 0
    s_cmp_lg_u32 s60, 1792
    s_cbranch_scc1 phK_an
    v_lshlrev_b32 v12, 7, v1
    v_mov_b32 v14, s70
    s_xor_b32 s72, s70, 0x5bd1e995
    v_mov_b32 v15, s72
    s_mov_b32 s72, 6963200
    s_mov_b32 exec_lo, -1
    s_mov_b32 exec_hi, 0x0
    buffer_store_dwordx2 v[14:15], v12, s[24:27], s72 offen sc1
    s_mov_b64 exec, -1
phK_an:
    v_mov_b32 v248, 0
    v_mov_b32 v249, 1
    s_mov_b32 s43, 0x3f803f80
    s_movk_i32 s54, 0x3f80
    s_mov_b32 s55, 1.0
    s_mul_i32 s56, s35, 3072
    v_add_u32 v32, s75, v5
    v_add_u32 v31, s56, v32
    v_and_b32 v22, 7, v3
    v_mul_u32_u24 v44, 425984, v22
    v_lshrrev_b32 v59, 3, v3
    v_lshl_add_u32 v44, v59, 3, v44
    v_lshl_add_u32 v44, v4, 4, v44
    v_mul_u32_u24 v22, s2, v22
    v_cvt_f32_u32 v33, v22
    v_mov_b32 v34, 0x3e800000
    s_lshl_b32 s64, s2, 6
    s_lshl_b32 s56, s3, 14
    s_add_u32 s64, s64, s56
    s_and_b32 s66, s2, 31
    s_lshl_b32 s66, s66, 7
    s_add_u32 s66, s66, 6963200
    s_bfe_u32 s58, s70, 917512
    s_lshr_b32 s59, s70, 22
    v_cmp_lt_u32 s[56:57], 7, v3
    v_mov_b32 v45, s58
    v_mov_b32 v2, s59
    v_cndmask_b32 v45, v45, v2, s[56:57]
    v_add_u32 v45, 0x400, v45
    v_cvt_f32_f16 v45, v45
    v_mov_b32 v107, 0
    v_mov_b32 v111, 0
    s_mul_i32 s57, s34, 2304
    s_add_u32 s57, s57, 512
    v_lshl_add_u32 v36, v4, 4, s57
    v_lshl_add_u32 v35, v3, 6, v36
    v_and_b32 v23, 1, v3
    v_lshl_add_u32 v36, v23, 6, v36
    s_mov_b32 s16, s38
    s_and_b32 s17, s39, 0xffff
    s_mov_b32 s18, 1183744
    s_mov_b32 s19, 0x00020000
    s_mov_b32 s20, s40
    s_and_b32 s21, s41, 0xffff
    s_mov_b32 s22, 1183744
    s_mov_b32 s23, 0x00020000
    s_mov_b32 s68, s62
    v_mov_b32 v53, v8
    v_mov_b32 v198, 0
    v_mov_b32 v246, 0
    s_mov_b32 s10, 0
    s_cmp_ge_u32 s2, 104
    s_cbranch_scc1 phK_r1
    v_lshrrev_b32 v8, 2, v1
    v_and_b32 v9, 3, v1
    v_mul_u32_u24 v198, 4624, v8
    s_cmp_eq_u32 s33, 12
    s_cselect_b32 s56, 0, 12
    v_mad_u32_u24 v198, v9, s56, v198
    s_mul_i32 s62, s3, 147968
    s_mul_i32 s56, s33, 48
    s_add_u32 s62, s62, s56
    s_add_u32 s62, s62, s63
    s_and_b32 s62, s62, -4
    s_add_u32 s63, s62, 73984
    s_branch phK_tp
phK_r1:
    s_mul_i32 s8, s3, 19
    s_add_u32 s8, s8, s33
    s_sub_u32 s8, s8, 13
    s_cmp_ge_u32 s8, 81
    s_cselect_b64 s[4:5], s[48:49], s[46:47]
    s_cselect_b32 s9, 81, 0
    s_mul_i32 s10, s32, 1152
    s_and_b32 s5, s5, 0xffff
    s_mov_b32 s6, 5308416
    s_sub_u32 s9, s8, s9
    s_lshl_b32 s9, s9, 6
    v_add_u32 v246, s9, v1
    s_cmp_lt_u32 s8, 76
    s_cselect_b32 s9, -1, 0
    v_mul_u32_u24 v247, 7282, v246
    v_lshrrev_b32 v247, 16, v247
    v_lshlrev_b32 v246, 7, v246
    s_movk_i32 s11, 8064
    v_mad_u32_u24 v246, v247, s11, v246
    s_mov_b32 s11, 1179648
    v_bfe_u32 v245, v247, 4, 2
    v_mad_u32_u24 v246, v245, s11, v246
    s_mov_b32 s11, 442368
    v_lshrrev_b32 v245, 6, v247
    v_mul_u32_u24 v245, s11, v245
    v_sub_u32 v246, v246, v245
    v_and_b32 v246, s9, v246
phK_tp:
Kw_2:
    s_memrealtime s[72:73]
    s_waitcnt lgkmcnt(0)
    s_sub_u32 s72, s72, s70
    s_cmp_ge_u32 s72, 70
    s_cbranch_scc1 Kx_3
    s_sleep 1
    s_branch Kw_2
Kx_3:
    s_cmp_eq_u32 s35, 1
    s_cbranch_scc1 phK_wi
    buffer_load_dword v255, v53, s[16:19], s68 offen
    s_branch phK_wj
phK_wi:
    buffer_load_dword v255, v53, s[20:23], s68 offen
phK_wj:
    s_waitcnt vmcnt(5)
    s_barrier
    ds_read_b128 v[204:207], v31 offset:36864
    ds_read_b128 v[208:211], v31 offset:37888
    ds_read_b128 v[212:215], v31 offset:38912
    ds_read_b128 v[76:79], v31 offset:53248
    ds_read_b128 v[80:83], v31 offset:54272
    ds_read_b128 v[84:87], v31 offset:55296
    ds_read_b128 v[112:115], v32 offset:45056
    ds_read_b128 v[116:119], v32 offset:46080
    ds_read_b128 v[120:123], v32 offset:47104
    ds_read_b128 v[124:127], v32 offset:48128
    ds_read_b128 v[128:131], v32 offset:49152
    ds_read_b128 v[64:67], v32 offset:43008
    s_waitcnt vmcnt(2)
    s_cmp_lt_u32 s2, 104
    s_cbranch_scc1 phK_r2
    s_cmp_ge_u32 s8, 76
    s_cbranch_scc1 phK_r2
    buffer_load_dword v255, v246, s[4:7], s10 offen
phK_r2:
    v_dot2_f32_bf16 v18, v48, s43, 0
    v_dot2_f32_bf16 v20, v48, v48, 0
    v_dot2_f32_bf16 v18, v49, s43, v18
    v_dot2_f32_bf16 v20, v49, v49, v20
    v_dot2_f32_bf16 v18, v50, s43, v18
    v_dot2_f32_bf16 v20, v50, v50, v20
    v_dot2_f32_bf16 v18, v51, s43, v18
    v_dot2_f32_bf16 v20, v51, v51, v20
    v_dot2_f32_bf16 v18, v52, s43, v18
    v_dot2_f32_bf16 v20, v52, v52, v20
    v_mov_b32 v19, 0x3ae38e39
    s_nop 0
    s_nop 0
    v_add_f32_dpp v18, v18, v18 quad_perm:[1,0,3,2] row_mask:0xf bank_mask:0xf
    v_add_f32_dpp v20, v20, v20 quad_perm:[1,0,3,2] row_mask:0xf bank_mask:0xf
    s_nop 0
    v_add_f32_dpp v18, v18, v18 quad_perm:[2,3,0,1] row_mask:0xf bank_mask:0xf
    v_add_f32_dpp v20, v20, v20 quad_perm:[2,3,0,1] row_mask:0xf bank_mask:0xf
    s_nop 0
    v_add_f32_dpp v18, v18, v18 row_half_mirror row_mask:0xf bank_mask:0xf
    v_add_f32_dpp v20, v20, v20 row_half_mirror row_mask:0xf bank_mask:0xf
    s_nop 0
    v_add_f32_dpp v18, v18, v18 row_mirror row_mask:0xf bank_mask:0xf
    v_add_f32_dpp v20, v20, v20 row_mirror row_mask:0xf bank_mask:0xf
    s_nop 0
    v_add_f32_dpp v18, v18, v18 row_bcast:15 row_mask:0xa bank_mask:0xf
    v_add_f32_dpp v20, v20, v20 row_bcast:15 row_mask:0xa bank_mask:0xf
    s_nop 0
    v_add_f32_dpp v18, v18, v18 row_bcast:31 row_mask:0xc bank_mask:0xf
    v_add_f32_dpp v20, v20, v20 row_bcast:31 row_mask:0xc bank_mask:0xf
    s_nop 0
    v_readlane_b32 s58, v18, 63
    v_readlane_b32 s59, v20, 63
    s_nop 0
    v_mul_f32 v18, s58, v19
    v_mul_f32 v20, s59, v19
    v_fma_f32 v20, -v18, v18, v20
    v_cvt_pk_bf16_f32 v18, v18, v18
    v_and_b32 v18, 0xffff0000, v18
    v_max_f32 v20, 0, v20
    v_cvt_pk_bf16_f32 v20, v20, v20
    v_and_b32 v20, 0xffff0000, v20
    v_add_f32 v20, 0x3727c5ac, v20
    v_cvt_pk_bf16_f32 v20, v20, v20
    v_and_b32 v20, 0xffff0000, v20
    v_sqrt_f32 v20, v20
    v_dot2_f32_bf16 v8, v48, s54, v18 neg_lo:[0,0,1]
    v_dot2_f32_bf16 v9, v48, s55, v18 neg_lo:[0,0,1]
    v_dot2_f32_bf16 v10, v49, s54, v18 neg_lo:[0,0,1]
    v_dot2_f32_bf16 v11, v49, s55, v18 neg_lo:[0,0,1]
    v_dot2_f32_bf16 v12, v50, s54, v18 neg_lo:[0,0,1]
    v_dot2_f32_bf16 v13, v50, s55, v18 neg_lo:[0,0,1]
    v_dot2_f32_bf16 v14, v51, s54, v18 neg_lo:[0,0,1]
    v_dot2_f32_bf16 v15, v51, s55, v18 neg_lo:[0,0,1]
    v_dot2_f32_bf16 v16, v52, s54, v18 neg_lo:[0,0,1]
    v_dot2_f32_bf16 v17, v52, s55, v18 neg_lo:[0,0,1]
    v_cvt_pk_bf16_f32 v20, v20, v20
    v_and_b32 v20, 0xffff0000, v20
    v_rcp_f32 v20, v20
    v_cvt_pk_bf16_f32 v24, v8, v9
    v_cvt_pk_bf16_f32 v25, v10, v11
    v_cvt_pk_bf16_f32 v26, v12, v13
    v_cvt_pk_bf16_f32 v27, v14, v15
    v_cvt_pk_bf16_f32 v28, v16, v17
    v_lshlrev_b32 v8, 16, v24
    v_and_b32 v9, 0xffff0000, v24
    v_lshlrev_b32 v10, 16, v25
    v_and_b32 v11, 0xffff0000, v25
    v_lshlrev_b32 v12, 16, v26
    v_and_b32 v13, 0xffff0000, v26
    v_lshlrev_b32 v14, 16, v27
    v_and_b32 v15, 0xffff0000, v27
    v_lshlrev_b32 v16, 16, v28
    v_and_b32 v17, 0xffff0000, v28
    v_pk_mul_f32 v[8:9], v[8:9], v[20:21] op_sel_hi:[1,0]
    v_pk_mul_f32 v[10:11], v[10:11], v[20:21] op_sel_hi:[1,0]
    v_pk_mul_f32 v[12:13], v[12:13], v[20:21] op_sel_hi:[1,0]
    v_pk_mul_f32 v[14:15], v[14:15], v[20:21] op_sel_hi:[1,0]
    v_pk_mul_f32 v[16:17], v[16:17], v[20:21] op_sel_hi:[1,0]
    v_cvt_pk_bf16_f32 v24, v8, v9
    v_cvt_pk_bf16_f32 v25, v10, v11
    v_cvt_pk_bf16_f32 v26, v12, v13
    v_cvt_pk_bf16_f32 v27, v14, v15
    v_cvt_pk_bf16_f32 v28, v16, v17
    v_lshrrev_b32 v30, 16, v203
    v_lshlrev_b32 v8, 16, v24
    v_and_b32 v9, 0xffff0000, v24
    v_lshlrev_b32 v10, 16, v25
    v_and_b32 v11, 0xffff0000, v25
    v_lshlrev_b32 v12, 16, v26
    v_and_b32 v13, 0xffff0000, v26
    v_lshlrev_b32 v14, 16, v27
    v_and_b32 v15, 0xffff0000, v27
    v_lshlrev_b32 v16, 16, v28
    v_and_b32 v17, 0xffff0000, v28
    v_cvt_pk_f16_f32 v24, v8, v9
    v_cvt_pk_f16_f32 v25, v10, v11
    v_cvt_pk_f16_f32 v26, v12, v13
    v_cvt_pk_f16_f32 v27, v14, v15
    v_cvt_pk_f16_f32 v28, v16, v17
    ds_write_b16 v30, v24 offset:0
    ds_write_b16_d16_hi v30, v24 offset:64
    ds_write_b16 v30, v25 offset:128
    ds_write_b16_d16_hi v30, v25 offset:192
    ds_write_b16 v30, v26 offset:256
    ds_write_b16_d16_hi v30, v26 offset:320
    ds_write_b16 v30, v27 offset:384
    ds_write_b16_d16_hi v30, v27 offset:448
    s_mov_b32 exec_hi, 0
    ds_write_b16 v30, v28 offset:512
    ds_write_b16_d16_hi v30, v28 offset:576
    s_mov_b32 exec_hi, -1
    s_cmp_lg_u32 s3, 7
    s_cbranch_scc1 phK_e0
    buffer_load_dwordx2 v[196:197], v248, s[24:27], s66 offen sc1
phK_e0:
    s_waitcnt lgkmcnt(0)
    s_barrier
    ds_read_b128 v[48:51], v35 offset:0
    ds_read_b128 v[56:59], v36 offset:1024
    ds_read_b128 v[52:55], v35 offset:1152
    ds_read_b128 v[60:63], v36 offset:2176
    s_waitcnt lgkmcnt(3)
    v_mfma_f32_16x16x32_f16 v[88:91], v[48:51], v[204:207], 0
    v_mfma_f32_16x16x32_f16 v[92:95], v[48:51], v[212:215], 0
    s_waitcnt lgkmcnt(2)
    v_mfma_f32_16x16x32_f16 v[96:99], v[56:59], v[204:207], 0
    v_mfma_f32_16x16x32_f16 v[100:103], v[56:59], v[212:215], 0
    s_waitcnt lgkmcnt(1)
    v_mfma_f32_16x16x32_f16 v[88:91], v[52:55], v[208:211], v[88:91]
    v_mfma_f32_16x16x32_f16 v[92:95], v[52:55], v[204:207], v[92:95]
    s_waitcnt lgkmcnt(0)
    v_mfma_f32_16x16x32_f16 v[96:99], v[60:63], v[208:211], v[96:99]
    v_mfma_f32_16x16x32_f16 v[100:103], v[60:63], v[204:207], v[100:103]
    s_cmp_ge_u32 s2, 104
    s_cbranch_scc1 phK_s3
    s_cmp_ge_u32 s3, 4
    s_cbranch_scc1 phK_s3
    buffer_load_dwordx4 v[180:183], v198, s[16:19], s62 offen
    buffer_load_dwordx4 v[184:187], v198, s[20:23], s62 offen
    buffer_load_dwordx4 v[188:191], v198, s[16:19], s63 offen
    buffer_load_dwordx4 v[192:195], v198, s[20:23], s63 offen
    s_add_u32 s62, s62, 591872
    s_add_u32 s63, s63, 591872
    buffer_load_dwordx4 v[216:219], v198, s[16:19], s62 offen
    buffer_load_dwordx4 v[220:223], v198, s[20:23], s62 offen
    buffer_load_dwordx4 v[224:227], v198, s[16:19], s63 offen
    buffer_load_dwordx4 v[228:231], v198, s[20:23], s63 offen
phK_s3:
    v_and_b32 v40, 0xffff, v200
    v_lshrrev_b32 v41, 16, v200
    v_and_b32 v42, 0xffff, v201
    v_lshrrev_b32 v43, 16, v201
    v_and_b32 v37, 0xffff, v202
    v_lshrrev_b32 v38, 16, v202
    v_and_b32 v39, 0xffff, v203
    s_waitcnt lgkmcnt(6)
    v_pk_mul_f32 v[8:9], v[88:89], v[76:77]
    v_pk_mul_f32 v[10:11], v[92:93], v[76:77]
    v_pk_fma_f32 v[8:9], v[92:93], v[80:81], v[8:9]
    v_pk_fma_f32 v[10:11], v[88:89], v[80:81], v[10:11] neg_lo:[1,0,0] neg_hi:[1,0,0]
    v_cvt_pk_f16_f32 v104, v8, v9
    v_cvt_pk_f16_f32 v108, v10, v11
    v_pk_mul_f32 v[8:9], v[90:91], v[78:79]
    v_pk_mul_f32 v[10:11], v[94:95], v[78:79]
    v_pk_fma_f32 v[8:9], v[94:95], v[82:83], v[8:9]
    v_pk_fma_f32 v[10:11], v[90:91], v[82:83], v[10:11] neg_lo:[1,0,0] neg_hi:[1,0,0]
    v_cvt_pk_f16_f32 v105, v8, v9
    v_cvt_pk_f16_f32 v109, v10, v11
    v_pk_mul_f32 v[8:9], v[96:97], v[84:85]
    v_pk_mul_f32 v[10:11], v[100:101], v[84:85]
    v_pk_fma_f32 v[8:9], v[100:101], v[86:87], v[8:9]
    v_pk_fma_f32 v[10:11], v[96:97], v[86:87], v[10:11] neg_lo:[1,0,0] neg_hi:[1,0,0]
    v_cvt_pk_f16_f32 v106, v8, v9
    v_cvt_pk_f16_f32 v110, v10, v11
    s_waitcnt lgkmcnt(0)
    s_nop 0
    v_mfma_f32_16x16x32_f16 v[136:139], v[104:107], v[112:115], 0
    v_mfma_f32_16x16x32_f16 v[140:143], v[104:107], v[120:123], 0
    v_mfma_f32_16x16x32_f16 v[144:147], v[104:107], v[124:127], 0
    v_mfma_f32_16x16x32_f16 v[136:139], v[108:111], v[116:119], v[136:139]
    v_mfma_f32_16x16x32_f16 v[140:143], v[108:111], v[112:115], v[140:143]
    v_mfma_f32_16x16x32_f16 v[144:147], v[108:111], v[128:131], v[144:147]
    v_fmamk_f32 v64, v33, 0x3a000000, v64
    v_fmamk_f32 v65, v33, 0x3a000000, v65
    v_fmamk_f32 v66, v33, 0x3a000000, v66
    v_fmamk_f32 v67, v33, 0x3a000000, v67
    v_cos_f32 v64, v64
    v_cos_f32 v65, v65
    v_cos_f32 v66, v66
    v_cos_f32 v67, v67
    v_cvt_pk_f16_f32 v20, v136, v137
    v_cvt_pk_f16_f32 v21, v138, v139
    ds_write_b16 v37, v20
    ds_write_b16_d16_hi v37, v20 offset:8
    ds_write_b16 v37, v21 offset:16
    ds_write_b16_d16_hi v37, v21 offset:24
    v_cvt_pk_f16_f32 v22, v140, v141
    v_cvt_pk_f16_f32 v23, v142, v143
    ds_write_b16 v38, v22
    ds_write_b16_d16_hi v38, v22 offset:8
    ds_write_b16 v38, v23 offset:16
    ds_write_b16_d16_hi v38, v23 offset:24
    v_cvt_pk_f16_f32 v24, v144, v145
    v_cvt_pk_f16_f32 v25, v146, v147
    ds_write_b16 v39, v24
    ds_write_b16_d16_hi v39, v24 offset:8
    ds_write_b16 v39, v25 offset:16
    ds_write_b16_d16_hi v39, v25 offset:24
    v_mul_f32 v64, v34, v64
    v_mul_f32 v65, v34, v65
    v_mul_f32 v66, v34, v66
    v_mul_f32 v67, v34, v67
    v_cvt_pk_f16_f32 v46, v64, v65
    v_cvt_pk_f16_f32 v47, v66, v67
    s_waitcnt lgkmcnt(0)
    s_barrier
    ds_read_b64 v[148:149], v40
    ds_read_b64 v[150:151], v41
    ds_read_b64 v[152:153], v42
    ds_read_b64 v[154:155], v43
    s_waitcnt lgkmcnt(3)
    v_mfma_f32_16x16x16_f16 v[156:159], v[148:149], v[46:47], 0
    s_waitcnt lgkmcnt(2)
    v_mfma_f32_16x16x16_f16 v[160:163], v[150:151], v[46:47], 0
    s_waitcnt lgkmcnt(1)
    v_mfma_f32_16x16x16_f16 v[164:167], v[152:153], v[46:47], 0
    s_waitcnt lgkmcnt(0)
    v_mfma_f32_16x16x16_f16 v[168:171], v[154:155], v[46:47], 0
    s_nop 3
phK_g1s:
    s_mov_b32 s56, s64
    v_cvt_pk_f16_f32 v172, v156, v157
    v_cvt_pk_f16_f32 v173, v158, v45
    buffer_store_dwordx2 v[172:173], v44, s[24:27], s56 offen sc1
    s_add_u32 s56, s56, 131072
    v_cvt_pk_f16_f32 v174, v160, v161
    v_cvt_pk_f16_f32 v175, v162, v45
    buffer_store_dwordx2 v[174:175], v44, s[24:27], s56 offen sc1
    s_add_u32 s56, s56, 131072
    v_cvt_pk_f16_f32 v176, v164, v165
    v_cvt_pk_f16_f32 v177, v166, v45
    buffer_store_dwordx2 v[176:177], v44, s[24:27], s56 offen sc1
    s_add_u32 s56, s56, 131072
    s_cmp_lg_u32 s3, 0
    s_cbranch_scc1 phK_a3t
    v_cvt_pk_f16_f32 v178, v168, v169
    v_cvt_pk_f16_f32 v179, v170, v45
    buffer_store_dwordx2 v[178:179], v44, s[24:27], s56 offen sc1
phK_a3t:
    s_cmp_eq_u32 s71, -1
    s_cbranch_scc1 phK_g1d
    s_setprio 0
    s_mov_b32 s37, 0
    s_lshl_b32 s63, s33, 1
    s_add_u32 s63, s63, s35
    s_cmp_lt_u32 s2, 104
    s_cbranch_scc1 phK_w1
    s_cmp_lg_u32 s3, 7
    s_cbranch_scc1 phK_ew
    s_waitcnt vmcnt(3)
    s_branch phK_w2
phK_w1:
    ds_read_b128 v[76:79], v32 offset:50176
    ds_read_b128 v[80:83], v32 offset:51200
    ds_read_b128 v[84:87], v32 offset:52224
    ds_read_b128 v[88:91], v32 offset:59392
    ds_read_b128 v[92:95], v32 offset:60416
    v_lshrrev_b32 v7, 3, v1
    v_lshrrev_b32 v8, 5, v1
    v_xor_b32 v8, v8, v1
    v_and_b32 v8, 3, v8
    v_lshlrev_b32 v8, 4, v8
    v_lshl_add_u32 v125, v7, 6, v8
    v_bfe_u32 v8, v1, 2, 1
    v_mul_u32_u24 v8, 49216, v8
    s_lshl_b32 s56, s3, 11
    v_add3_u32 v125, v125, v8, s56
    v_xor_b32 v126, 32, v125
    s_mul_i32 s62, s32, 13
    s_add_u32 s62, s62, s33
    s_lshl_b32 s62, s62, 3
    s_add_u32 s62, s62, s3
    s_lshl_b32 s62, s62, 12
    v_lshrrev_b32 v7, 2, v1
    v_and_b32 v8, 3, v1
    v_and_b32 v9, 1, v8
    v_lshlrev_b32 v9, 1, v9
    v_xor_b32 v9, v9, v4
    v_lshlrev_b32 v9, 4, v9
    v_lshl_add_u32 v9, v7, 6, v9
    v_lshrrev_b32 v8, 1, v8
    v_lshlrev_b32 v12, 2, v8
    v_mul_u32_u24 v8, 49216, v8
    s_lshl_b32 s56, s3, 11
    v_add3_u32 v10, v9, v8, s56
    v_xor_b32 v11, 16, v10
    s_waitcnt vmcnt(4)
    s_cmp_eq_u32 s3, 0
    s_cbranch_scc1 phK_w04
    s_waitcnt vmcnt(3)
phK_w04:
    s_cmp_ge_u32 s3, 4
    s_cbranch_scc1 phK_w2
    s_and_b32 s57, s32, 1
    s_lshl_b32 s57, s57, 4
    s_mov_b32 s58, 0x7fff7fff
    v_alignbit_b32 v24, v181, v180, s57
    v_alignbit_b32 v25, v182, v181, s57
    v_alignbit_b32 v182, v183, v182, s57
    v_alignbit_b32 v28, v182, v25, 16
    v_lshrrev_b32 v29, 16, v182
    v_alignbit_b32 v26, v185, v184, s57
    v_alignbit_b32 v27, v186, v185, s57
    v_alignbit_b32 v186, v187, v186, s57
    v_alignbit_b32 v30, v186, v27, 16
    v_lshrrev_b32 v31, 16, v186
    ds_write_b128 v10, v[24:27] offset:33280
    ds_write_b128 v11, v[28:31] offset:33280
    v_and_b32 v16, s58, v24
    v_and_b32 v17, s58, v25
    v_pk_max_u16 v16, v16, v17
    v_and_b32 v17, s58, v182
    v_pk_max_u16 v16, v16, v17
    v_and_b32 v17, s58, v26
    v_pk_max_u16 v16, v16, v17
    v_and_b32 v17, s58, v27
    v_pk_max_u16 v16, v16, v17
    v_and_b32 v17, s58, v186
    v_pk_max_u16 v16, v16, v17
    v_alignbit_b32 v32, v189, v188, s57
    v_alignbit_b32 v33, v190, v189, s57
    v_alignbit_b32 v190, v191, v190, s57
    v_alignbit_b32 v36, v190, v33, 16
    v_lshrrev_b32 v37, 16, v190
    v_alignbit_b32 v34, v193, v192, s57
    v_alignbit_b32 v35, v194, v193, s57
    v_alignbit_b32 v194, v195, v194, s57
    v_alignbit_b32 v38, v194, v35, 16
    v_lshrrev_b32 v39, 16, v194
    ds_write_b128 v10, v[32:35] offset:34304
    ds_write_b128 v11, v[36:39] offset:34304
    v_and_b32 v17, s58, v32
    v_pk_max_u16 v16, v16, v17
    v_and_b32 v17, s58, v33
    v_pk_max_u16 v16, v16, v17
    v_and_b32 v17, s58, v190
    v_pk_max_u16 v16, v16, v17
    v_and_b32 v17, s58, v34
    v_pk_max_u16 v16, v16, v17
    v_and_b32 v17, s58, v35
    v_pk_max_u16 v16, v16, v17
    v_and_b32 v17, s58, v194
    v_pk_max_u16 v16, v16, v17
    v_alignbit_b32 v24, v217, v216, s57
    v_alignbit_b32 v25, v218, v217, s57
    v_alignbit_b32 v218, v219, v218, s57
    v_alignbit_b32 v28, v218, v25, 16
    v_lshrrev_b32 v29, 16, v218
    v_alignbit_b32 v26, v221, v220, s57
    v_alignbit_b32 v27, v222, v221, s57
    v_alignbit_b32 v222, v223, v222, s57
    v_alignbit_b32 v30, v222, v27, 16
    v_lshrrev_b32 v31, 16, v222
    ds_write_b128 v10, v[24:27] offset:41472
    ds_write_b128 v11, v[28:31] offset:41472
    v_and_b32 v17, s58, v24
    v_pk_max_u16 v16, v16, v17
    v_and_b32 v17, s58, v25
    v_pk_max_u16 v16, v16, v17
    v_and_b32 v17, s58, v218
    v_pk_max_u16 v16, v16, v17
    v_and_b32 v17, s58, v26
    v_pk_max_u16 v16, v16, v17
    v_and_b32 v17, s58, v27
    v_pk_max_u16 v16, v16, v17
    v_and_b32 v17, s58, v222
    v_pk_max_u16 v16, v16, v17
    v_alignbit_b32 v32, v225, v224, s57
    v_alignbit_b32 v33, v226, v225, s57
    v_alignbit_b32 v226, v227, v226, s57
    v_alignbit_b32 v36, v226, v33, 16
    v_lshrrev_b32 v37, 16, v226
    v_alignbit_b32 v34, v229, v228, s57
    v_alignbit_b32 v35, v230, v229, s57
    v_alignbit_b32 v230, v231, v230, s57
    v_alignbit_b32 v38, v230, v35, 16
    v_lshrrev_b32 v39, 16, v230
    ds_write_b128 v10, v[32:35] offset:42496
    ds_write_b128 v11, v[36:39] offset:42496
    v_and_b32 v17, s58, v32
    v_pk_max_u16 v16, v16, v17
    v_and_b32 v17, s58, v33
    v_pk_max_u16 v16, v16, v17
    v_and_b32 v17, s58, v226
    v_pk_max_u16 v16, v16, v17
    v_and_b32 v17, s58, v34
    v_pk_max_u16 v16, v16, v17
    v_and_b32 v17, s58, v35
    v_pk_max_u16 v16, v16, v17
    v_and_b32 v17, s58, v230
    v_pk_max_u16 v16, v16, v17
    v_lshrrev_b32 v17, 16, v16
    v_and_b32 v16, 0xffff, v16
    v_max_u32 v16, v16, v17
    ds_max_u32 v12, v16 offset:296
phK_w2:
    s_cmp_lg_u32 s3, 7
    s_cbranch_scc1 phK_ew
    s_sub_u32 s69, s70, 65536
    s_mov_b32 s57, 0
phK_ic:
    v_readfirstlane_b32 s65, v196
    v_readfirstlane_b32 s58, v197
    s_nop 3
    s_xor_b32 s58, s58, 0x5bd1e995
    s_sub_u32 s59, s65, s69
    s_lshr_b32 s59, s59, 17
    s_xor_b32 s58, s58, s65
    s_or_b32 s59, s59, s58
    s_cbranch_scc0 phK_iok
    s_sleep 2
    buffer_load_dwordx2 v[196:197], v248, s[24:27], s66 offen sc1
    s_add_u32 s57, s57, 1
    s_waitcnt vmcnt(0)
    s_cmp_lt_u32 s57, 20000
    s_cbranch_scc1 phK_ic
phK_iok:
    ds_write_b32 v248, v196 offset:288
phK_ew:
    s_waitcnt lgkmcnt(0)
    s_barrier
    ds_read_b32 v2, v248 offset:288
    s_waitcnt lgkmcnt(0)
    v_readfirstlane_b32 s65, v2
    s_nop 3
    s_sub_u32 s67, s65, 256
    s_lshr_b32 s56, s70, 8
    s_lshr_b32 s57, s67, 8
    s_sub_u32 s58, s56, s57
    s_xor_b32 s56, s56, s57
    s_lshr_b32 s58, s58, 2
    s_lshr_b32 s56, s56, 14
    s_mov_b32 s71, -1
    s_or_b32 s56, s56, s58
    s_cbranch_scc0 phK_g1d
    s_bfe_u32 s58, s67, 917512
    s_lshr_b32 s59, s67, 22
    v_cmp_lt_u32 s[56:57], 7, v3
    v_mov_b32 v45, s58
    v_mov_b32 v2, s59
    v_cndmask_b32 v45, v45, v2, s[56:57]
    v_add_u32 v45, 0x400, v45
    v_cvt_f32_f16 v45, v45
    s_branch phK_g1s
phK_g1d:
    s_cmp_lt_u32 s63, 25
    s_cbranch_scc1 phK_b1
    v_lshlrev_b32 v129, 4, v0
    s_movk_i32 s56, 0x2000
    buffer_load_dwordx4 v129, s[28:31], 0 offen lds
    s_add_u32 m0, m0, s56
    buffer_load_dwordx4 v[250:253], v5, s[12:15], s61 offen
    buffer_load_dwordx4 v129, s[28:31], s56 offen lds
    s_mov_b32 exec_hi, 0
    buffer_load_dword v254, v6, s[12:15], s61 offen offset:1024
    s_mov_b32 exec_hi, -1
    s_mov_b32 s56, 49152
    s_mov_b32 s57, 57344
    s_mov_b32 s12, s44
    s_and_b32 s13, s45, 0xffff
    s_mov_b32 s14, 1152
    s_mov_b32 s15, 0x00020000
    buffer_load_dwordx4 v[228:231], v129, s[28:31], s56 offen
    buffer_load_dwordx4 v[232:235], v129, s[28:31], s57 offen
    buffer_load_dwordx4 v[240:243], v5, s[12:15], 0 offen
    buffer_load_dword v244, v6, s[12:15], 0 offen offset:1024
    s_cmp_ge_u32 s2, 104
    s_cbranch_scc1 phK_nb
    s_branch phK_bs
phK_b1:
    s_mul_i32 s64, s32, 26
    s_add_u32 s64, s64, s63
    s_lshl_b32 s64, s64, 14
    s_lshl_b32 s56, s34, 12
    s_add_u32 s64, s64, s56
Kw_4:
    s_memrealtime s[72:73]
    s_waitcnt lgkmcnt(0)
    s_sub_u32 s72, s72, s65
    s_cmp_ge_u32 s72, 370
    s_cbranch_scc1 Kx_5
    s_sleep 1
    s_branch Kw_4
Kx_5:
    buffer_load_dwordx4 v[136:139], v5, s[24:27], s64 offen offset:0 sc1
    buffer_load_dwordx4 v[140:143], v5, s[24:27], s64 offen offset:1024 sc1
    buffer_load_dwordx4 v[144:147], v5, s[24:27], s64 offen offset:2048 sc1
    buffer_load_dwordx4 v[148:151], v5, s[24:27], s64 offen offset:3072 sc1
    s_mul_i32 s57, s35, 49216
    v_lshrrev_b32 v127, 2, v3
    v_xor_b32 v127, s34, v127
    v_lshlrev_b32 v127, 4, v127
    v_lshl_add_u32 v7, v4, 6, v3
    v_lshl_add_u32 v127, v7, 6, v127
    v_add_u32 v127, s57, v127
    s_lshl_b32 s56, s35, 2
    v_mov_b32 v7, s56
    v_mov_b32 v131, s56
    ds_read_b32 v132, v7 offset:296
    ds_read_b128 v[8:11], v127 offset:33280
    ds_read_b128 v[12:15], v127 offset:34304
    ds_read_b128 v[16:19], v127 offset:35328
    ds_read_b128 v[20:23], v127 offset:36352
    s_lshl_b32 s56, s34, 12
    s_add_u32 s56, s56, s57
    v_and_b32 v128, 3, v1
    v_xor_b32 v128, v128, v4
    v_lshlrev_b32 v128, 4, v128
    v_lshrrev_b32 v7, 2, v1
    v_lshl_add_u32 v128, v7, 6, v128
    v_add_u32 v128, s56, v128
    s_bfe_u32 s58, s67, 917512
    s_lshr_b32 s59, s67, 22
    s_add_u32 s58, s58, 0x400
    s_add_u32 s59, s59, 0x400
    s_lshl_b32 s58, s58, 16
    s_lshl_b32 s59, s59, 16
    s_mov_b32 s8, 0x05040100
    s_mov_b32 s9, 0x07060302
    s_andn2_b32 s56, s65, 0x1ff
    s_bitset1_b32 s56, 31
    s_waitcnt lgkmcnt(0)
    v_bfe_u32 v132, v132, 7, 8
    v_min_u32 v132, 252, v132
    v_sub_u32 v134, 253, v132
    v_lshlrev_b32 v134, 23, v134
    v_or_b32 v132, s56, v132
    v_lshlrev_b32 v100, 16, v8
    v_lshlrev_b32 v101, 16, v12
    v_lshlrev_b32 v102, 16, v16
    v_lshlrev_b32 v103, 16, v20
    v_lshlrev_b32 v104, 16, v10
    v_lshlrev_b32 v105, 16, v14
    v_lshlrev_b32 v106, 16, v18
    v_lshlrev_b32 v107, 16, v22
    v_and_b32 v108, 0xffff0000, v8
    v_and_b32 v109, 0xffff0000, v12
    v_and_b32 v110, 0xffff0000, v16
    v_and_b32 v111, 0xffff0000, v20
    v_and_b32 v112, 0xffff0000, v10
    v_and_b32 v113, 0xffff0000, v14
    v_and_b32 v114, 0xffff0000, v18
    v_and_b32 v115, 0xffff0000, v22
    v_lshlrev_b32 v116, 16, v9
    v_lshlrev_b32 v117, 16, v13
    v_lshlrev_b32 v118, 16, v17
    v_lshlrev_b32 v119, 16, v21
    v_lshlrev_b32 v120, 16, v11
    v_lshlrev_b32 v121, 16, v15
    v_lshlrev_b32 v122, 16, v19
    v_lshlrev_b32 v123, 16, v23
    v_pk_mul_f32 v[100:101], v[100:101], v[134:135] op_sel_hi:[1,0]
    v_pk_mul_f32 v[102:103], v[102:103], v[134:135] op_sel_hi:[1,0]
    v_pk_mul_f32 v[104:105], v[104:105], v[134:135] op_sel_hi:[1,0]
    v_pk_mul_f32 v[106:107], v[106:107], v[134:135] op_sel_hi:[1,0]
    v_pk_mul_f32 v[108:109], v[108:109], v[134:135] op_sel_hi:[1,0]
    v_pk_mul_f32 v[110:111], v[110:111], v[134:135] op_sel_hi:[1,0]
    v_pk_mul_f32 v[112:113], v[112:113], v[134:135] op_sel_hi:[1,0]
    v_pk_mul_f32 v[114:115], v[114:115], v[134:135] op_sel_hi:[1,0]
    v_pk_mul_f32 v[116:117], v[116:117], v[134:135] op_sel_hi:[1,0]
    v_pk_mul_f32 v[118:119], v[118:119], v[134:135] op_sel_hi:[1,0]
    v_pk_mul_f32 v[120:121], v[120:121], v[134:135] op_sel_hi:[1,0]
    v_pk_mul_f32 v[122:123], v[122:123], v[134:135] op_sel_hi:[1,0]
    s_mov_b32 s57, 0
    s_cmp_lt_u32 s3, 4
    s_cbranch_scc1 phK_g1c
    s_setprio 1
    s_branch phK_g1c
phK_g1:
    buffer_load_dwordx4 v[136:139], v5, s[24:27], s64 offen offset:0 sc1
    buffer_load_dwordx4 v[140:143], v5, s[24:27], s64 offen offset:1024 sc1
    buffer_load_dwordx4 v[144:147], v5, s[24:27], s64 offen offset:2048 sc1
    buffer_load_dwordx4 v[148:151], v5, s[24:27], s64 offen offset:3072 sc1
    s_waitcnt vmcnt(0)
phK_g1c:
    s_add_u32 s57, s57, 1
    s_waitcnt vmcnt(3)
    v_subrev_u32 v60, s58, v137
    v_subrev_u32 v64, s59, v139
    s_waitcnt vmcnt(2)
    v_subrev_u32 v61, s58, v141
    v_subrev_u32 v65, s59, v143
    s_waitcnt vmcnt(1)
    v_subrev_u32 v62, s58, v145
    v_subrev_u32 v66, s59, v147
    s_waitcnt vmcnt(0)
    v_subrev_u32 v63, s58, v149
    v_subrev_u32 v67, s59, v151
    v_or3_b32 v60, v60, v61, v62
    v_or3_b32 v64, v64, v65, v66
    v_or_b32 v60, v60, v63
    v_lshrrev_b32 v60, 2, v60
    v_or3_b32 v60, v60, v64, v67
    v_cmp_lt_u32 vcc, 0xffff, v60
    s_wqm_b64 exec, vcc
    s_cbranch_scc0 phK_g1k
    s_sleep 2
    s_cmp_lt_u32 s57, 20000
    s_cbranch_scc1 phK_g1
phK_g1k:
    s_mov_b64 exec, -1
    ds_write_b128 v128, v[136:139] offset:512
    ds_write_b128 v128, v[140:143] offset:1536
    ds_write_b128 v128, v[144:147] offset:2560
    ds_write_b128 v128, v[148:151] offset:3584
    s_mov_b64 exec, 1
    s_mov_b32 s57, 0
    ds_add_u32 v131, v249 offset:312
phK_hb:
    ds_read_b32 v130, v131 offset:312
    s_add_u32 s57, s57, 1
    s_waitcnt lgkmcnt(0)
    v_cmp_gt_u32 vcc, 4, v130
    s_cbranch_vccz phK_hc
    s_cmp_lt_u32 s57, 0x1000000
    s_cbranch_scc1 phK_hb
phK_hc:
    s_mov_b64 exec, -1
    ds_read_b128 v[8:11], v127 offset:512
    ds_read_b128 v[12:15], v127 offset:1536
    ds_read_b128 v[16:19], v127 offset:2560
    ds_read_b128 v[20:23], v127 offset:3584
    v_lshlrev_b32 v129, 4, v0
    s_movk_i32 s56, 0x2000
    buffer_load_dwordx4 v129, s[28:31], 0 offen lds
    s_add_u32 m0, m0, s56
    buffer_load_dwordx4 v[250:253], v5, s[12:15], s61 offen
    s_waitcnt lgkmcnt(2)
    v_perm_b32 v24, v12, v8, s8
    v_perm_b32 v26, v14, v10, s8
    v_perm_b32 v28, v12, v8, s9
    v_perm_b32 v30, v14, v10, s9
    v_perm_b32 v32, v13, v9, s8
    v_perm_b32 v34, v15, v11, s8
    s_waitcnt lgkmcnt(0)
    v_perm_b32 v25, v20, v16, s8
    v_perm_b32 v27, v22, v18, s8
    v_perm_b32 v29, v20, v16, s9
    v_perm_b32 v31, v22, v18, s9
    v_perm_b32 v33, v21, v17, s8
    v_perm_b32 v35, v23, v19, s8
    s_nop 0
    v_mfma_f32_16x16x32_f16 v[36:39], v[24:27], v[82:85], 0
    v_mfma_f32_16x16x32_f16 v[40:43], v[24:27], v[80:83], 0
    v_mfma_f32_16x16x32_f16 v[44:47], v[28:31], v[82:85], 0
    v_mfma_f32_16x16x32_f16 v[48:51], v[28:31], v[80:83], 0
    v_mfma_f32_16x16x32_f16 v[52:55], v[32:35], v[82:85], 0
    v_mfma_f32_16x16x32_f16 v[56:59], v[32:35], v[80:83], 0
    buffer_load_dwordx4 v129, s[28:31], s56 offen lds
    s_mov_b32 exec_hi, 0
    buffer_load_dword v254, v6, s[12:15], s61 offen offset:1024
    s_mov_b32 exec_hi, -1
    v_pk_mul_f32 v[60:61], v[36:37], v[88:89]
    v_pk_mul_f32 v[64:65], v[40:41], v[88:89]
    v_pk_fma_f32 v[60:61], v[40:41], v[92:93], v[60:61]
    v_pk_fma_f32 v[64:65], v[36:37], v[92:93], v[64:65] neg_lo:[1,0,0] neg_hi:[1,0,0]
    v_pk_mul_f32 v[62:63], v[38:39], v[90:91]
    v_pk_mul_f32 v[66:67], v[42:43], v[90:91]
    v_pk_fma_f32 v[62:63], v[42:43], v[94:95], v[62:63]
    v_pk_fma_f32 v[66:67], v[38:39], v[94:95], v[66:67] neg_lo:[1,0,0] neg_hi:[1,0,0]
    v_cvt_pk_f16_f32 v24, v60, v61
    v_cvt_pk_f16_f32 v25, v62, v63
    v_cvt_pk_f16_f32 v26, v64, v65
    v_cvt_pk_f16_f32 v27, v66, v67
    v_pk_mul_f32 v[68:69], v[44:45], v[88:89]
    v_pk_mul_f32 v[72:73], v[48:49], v[88:89]
    v_pk_fma_f32 v[68:69], v[48:49], v[92:93], v[68:69]
    v_pk_fma_f32 v[72:73], v[44:45], v[92:93], v[72:73] neg_lo:[1,0,0] neg_hi:[1,0,0]
    v_pk_mul_f32 v[70:71], v[46:47], v[90:91]
    v_pk_mul_f32 v[74:75], v[50:51], v[90:91]
    v_pk_fma_f32 v[70:71], v[50:51], v[94:95], v[70:71]
    v_pk_fma_f32 v[74:75], v[46:47], v[94:95], v[74:75] neg_lo:[1,0,0] neg_hi:[1,0,0]
    v_cvt_pk_f16_f32 v28, v68, v69
    v_cvt_pk_f16_f32 v29, v70, v71
    v_cvt_pk_f16_f32 v30, v72, v73
    v_cvt_pk_f16_f32 v31, v74, v75
    v_pk_mul_f32 v[60:61], v[52:53], v[88:89]
    v_pk_mul_f32 v[64:65], v[56:57], v[88:89]
    v_pk_fma_f32 v[60:61], v[56:57], v[92:93], v[60:61]
    v_pk_fma_f32 v[64:65], v[52:53], v[92:93], v[64:65] neg_lo:[1,0,0] neg_hi:[1,0,0]
    v_pk_mul_f32 v[62:63], v[54:55], v[90:91]
    v_pk_mul_f32 v[66:67], v[58:59], v[90:91]
    v_pk_fma_f32 v[62:63], v[58:59], v[94:95], v[62:63]
    v_pk_fma_f32 v[66:67], v[54:55], v[94:95], v[66:67] neg_lo:[1,0,0] neg_hi:[1,0,0]
    v_cvt_pk_f16_f32 v32, v60, v61
    v_cvt_pk_f16_f32 v33, v62, v63
    v_cvt_pk_f16_f32 v34, v64, v65
    v_cvt_pk_f16_f32 v35, v66, v67
    s_nop 0
    v_mfma_f32_16x16x32_f16 v[36:39], v[82:85], v[24:27], 0
    v_mfma_f32_16x16x32_f16 v[40:43], v[80:83], v[24:27], 0
    v_mfma_f32_16x16x32_f16 v[44:47], v[82:85], v[28:31], 0
    v_mfma_f32_16x16x32_f16 v[48:51], v[80:83], v[28:31], 0
    v_mfma_f32_16x16x32_f16 v[52:55], v[82:85], v[32:35], 0
    v_mfma_f32_16x16x32_f16 v[56:59], v[80:83], v[32:35], 0
    s_mov_b32 s56, 49152
    s_mov_b32 s57, 57344
    s_mov_b32 s12, s44
    s_and_b32 s13, s45, 0xffff
    s_mov_b32 s14, 1152
    s_mov_b32 s15, 0x00020000
    buffer_load_dwordx4 v[228:231], v129, s[28:31], s56 offen
    buffer_load_dwordx4 v[232:235], v129, s[28:31], s57 offen
    v_pk_mul_f32 v[60:61], v[36:37], v[100:101]
    v_pk_mul_f32 v[64:65], v[40:41], v[100:101]
    v_pk_fma_f32 v[60:61], v[40:41], v[104:105], v[60:61] neg_lo:[1,0,0] neg_hi:[1,0,0]
    v_pk_fma_f32 v[64:65], v[36:37], v[104:105], v[64:65]
    v_pk_mul_f32 v[62:63], v[38:39], v[102:103]
    v_pk_mul_f32 v[66:67], v[42:43], v[102:103]
    v_pk_fma_f32 v[62:63], v[42:43], v[106:107], v[62:63] neg_lo:[1,0,0] neg_hi:[1,0,0]
    v_pk_fma_f32 v[66:67], v[38:39], v[106:107], v[66:67]
    v_cvt_pk_f16_f32 v24, v60, v61
    v_cvt_pk_f16_f32 v25, v62, v63
    v_cvt_pk_f16_f32 v26, v64, v65
    v_cvt_pk_f16_f32 v27, v66, v67
    v_pk_mul_f32 v[68:69], v[44:45], v[108:109]
    v_pk_mul_f32 v[72:73], v[48:49], v[108:109]
    v_pk_fma_f32 v[68:69], v[48:49], v[112:113], v[68:69] neg_lo:[1,0,0] neg_hi:[1,0,0]
    v_pk_fma_f32 v[72:73], v[44:45], v[112:113], v[72:73]
    v_pk_mul_f32 v[70:71], v[46:47], v[110:111]
    v_pk_mul_f32 v[74:75], v[50:51], v[110:111]
    v_pk_fma_f32 v[70:71], v[50:51], v[114:115], v[70:71] neg_lo:[1,0,0] neg_hi:[1,0,0]
    v_pk_fma_f32 v[74:75], v[46:47], v[114:115], v[74:75]
    v_cvt_pk_f16_f32 v28, v68, v69
    v_cvt_pk_f16_f32 v29, v70, v71
    v_cvt_pk_f16_f32 v30, v72, v73
    v_cvt_pk_f16_f32 v31, v74, v75
    v_pk_mul_f32 v[60:61], v[52:53], v[116:117]
    v_pk_mul_f32 v[64:65], v[56:57], v[116:117]
    v_pk_fma_f32 v[60:61], v[56:57], v[120:121], v[60:61] neg_lo:[1,0,0] neg_hi:[1,0,0]
    v_pk_fma_f32 v[64:65], v[52:53], v[120:121], v[64:65]
    v_pk_mul_f32 v[62:63], v[54:55], v[118:119]
    v_pk_mul_f32 v[66:67], v[58:59], v[118:119]
    v_pk_fma_f32 v[62:63], v[58:59], v[122:123], v[62:63] neg_lo:[1,0,0] neg_hi:[1,0,0]
    v_pk_fma_f32 v[66:67], v[54:55], v[122:123], v[66:67]
    v_cvt_pk_f16_f32 v32, v60, v61
    v_cvt_pk_f16_f32 v33, v62, v63
    v_cvt_pk_f16_f32 v34, v64, v65
    v_cvt_pk_f16_f32 v35, v66, v67
    s_nop 0
    v_mfma_f32_16x16x32_f16 v[36:39], v[24:27], v[78:81], 0
    v_mfma_f32_16x16x32_f16 v[40:43], v[24:27], v[76:79], 0
    v_mfma_f32_16x16x32_f16 v[44:47], v[28:31], v[78:81], 0
    v_mfma_f32_16x16x32_f16 v[48:51], v[28:31], v[76:79], 0
    v_mfma_f32_16x16x32_f16 v[52:55], v[32:35], v[78:81], 0
    v_mfma_f32_16x16x32_f16 v[56:59], v[32:35], v[76:79], 0
    buffer_load_dwordx4 v[240:243], v5, s[12:15], 0 offen
    buffer_load_dword v244, v6, s[12:15], 0 offen offset:1024
    s_nop 1
    v_pk_mul_f32 v[60:61], v[36:37], v[88:89]
    v_pk_mul_f32 v[64:65], v[40:41], v[88:89]
    v_pk_fma_f32 v[60:61], v[40:41], v[92:93], v[60:61] neg_lo:[1,0,0] neg_hi:[1,0,0]
    v_pk_fma_f32 v[64:65], v[36:37], v[92:93], v[64:65]
    v_pk_mul_f32 v[62:63], v[38:39], v[90:91]
    v_pk_mul_f32 v[66:67], v[42:43], v[90:91]
    v_pk_fma_f32 v[62:63], v[42:43], v[94:95], v[62:63] neg_lo:[1,0,0] neg_hi:[1,0,0]
    v_pk_fma_f32 v[66:67], v[38:39], v[94:95], v[66:67]
    v_cvt_pk_f16_f32 v24, v60, v61
    v_cvt_pk_f16_f32 v25, v62, v63
    v_cvt_pk_f16_f32 v26, v64, v65
    v_cvt_pk_f16_f32 v27, v66, v67
    v_pk_mul_f32 v[68:69], v[44:45], v[88:89]
    v_pk_mul_f32 v[72:73], v[48:49], v[88:89]
    v_pk_fma_f32 v[68:69], v[48:49], v[92:93], v[68:69] neg_lo:[1,0,0] neg_hi:[1,0,0]
    v_pk_fma_f32 v[72:73], v[44:45], v[92:93], v[72:73]
    v_pk_mul_f32 v[70:71], v[46:47], v[90:91]
    v_pk_mul_f32 v[74:75], v[50:51], v[90:91]
    v_pk_fma_f32 v[70:71], v[50:51], v[94:95], v[70:71] neg_lo:[1,0,0] neg_hi:[1,0,0]
    v_pk_fma_f32 v[74:75], v[46:47], v[94:95], v[74:75]
    v_cvt_pk_f16_f32 v28, v68, v69
    v_cvt_pk_f16_f32 v29, v70, v71
    v_cvt_pk_f16_f32 v30, v72, v73
    v_cvt_pk_f16_f32 v31, v74, v75
    v_pk_mul_f32 v[60:61], v[52:53], v[88:89]
    v_pk_mul_f32 v[64:65], v[56:57], v[88:89]
    v_pk_fma_f32 v[60:61], v[56:57], v[92:93], v[60:61] neg_lo:[1,0,0] neg_hi:[1,0,0]
    v_pk_fma_f32 v[64:65], v[52:53], v[92:93], v[64:65]
    v_pk_mul_f32 v[62:63], v[54:55], v[90:91]
    v_pk_mul_f32 v[66:67], v[58:59], v[90:91]
    v_pk_fma_f32 v[62:63], v[58:59], v[94:95], v[62:63] neg_lo:[1,0,0] neg_hi:[1,0,0]
    v_pk_fma_f32 v[66:67], v[54:55], v[94:95], v[66:67]
    v_cvt_pk_f16_f32 v32, v60, v61
    v_cvt_pk_f16_f32 v33, v62, v63
    v_cvt_pk_f16_f32 v34, v64, v65
    v_cvt_pk_f16_f32 v35, v66, v67
    s_nop 0
    v_mfma_f32_16x16x32_f16 v[36:39], v[78:81], v[24:27], 0
    v_mfma_f32_16x16x32_f16 v[40:43], v[76:79], v[24:27], 0
    v_mfma_f32_16x16x32_f16 v[44:47], v[78:81], v[28:31], 0
    v_mfma_f32_16x16x32_f16 v[48:51], v[76:79], v[28:31], 0
    v_mfma_f32_16x16x32_f16 v[52:55], v[78:81], v[32:35], 0
    v_mfma_f32_16x16x32_f16 v[56:59], v[76:79], v[32:35], 0
    s_setprio 0
    v_mov_b32 v63, v132
    v_mov_b32 v67, v132
    v_mov_b32 v71, v132
    v_mov_b32 v75, v132
    s_nop 5
    v_cvt_pk_f16_f32 v60, v36, v40
    v_cvt_pk_f16_f32 v61, v44, v48
    v_cvt_pk_f16_f32 v62, v52, v56
    ds_write_b128 v127, v[60:63] offset:16896
    v_cvt_pk_f16_f32 v64, v37, v41
    v_cvt_pk_f16_f32 v65, v45, v49
    v_cvt_pk_f16_f32 v66, v53, v57
    ds_write_b128 v127, v[64:67] offset:17920
    v_cvt_pk_f16_f32 v68, v38, v42
    v_cvt_pk_f16_f32 v69, v46, v50
    v_cvt_pk_f16_f32 v70, v54, v58
    ds_write_b128 v127, v[68:71] offset:18944
    v_cvt_pk_f16_f32 v72, v39, v43
    v_cvt_pk_f16_f32 v73, v47, v51
    v_cvt_pk_f16_f32 v74, v55, v59
    ds_write_b128 v127, v[72:75] offset:19968
phK_bs:
    s_waitcnt lgkmcnt(0)
    s_barrier
    ds_read_b128 v[8:11], v125 offset:16896
    ds_read_b128 v[12:15], v126 offset:17408
    ds_read_b128 v[16:19], v125 offset:17920
    ds_read_b128 v[20:23], v126 offset:18432
    s_waitcnt lgkmcnt(3)
    buffer_store_dwordx4 v[8:11], v5, s[24:27], s62 offen offset:0 sc1
    s_waitcnt lgkmcnt(2)
    buffer_store_dwordx4 v[12:15], v5, s[24:27], s62 offen offset:1024 sc1
    s_waitcnt lgkmcnt(1)
    buffer_store_dwordx4 v[16:19], v5, s[24:27], s62 offen offset:2048 sc1
    s_waitcnt lgkmcnt(0)
    buffer_store_dwordx4 v[20:23], v5, s[24:27], s62 offen offset:3072 sc1
    s_setprio 0
    s_waitcnt vmcnt(4)
    s_branch phK_nb2
phK_nb:
    s_cmp_lt_u32 s2, 112
    s_cbranch_scc1 phK_nb1
    s_cmp_lt_u32 s3, 4
    s_cbranch_scc1 phK_nb1
    s_mov_b32 s37, 1
    s_mov_b32 s12, s46
    s_and_b32 s13, s47, 0xffff
    s_mov_b32 s14, 5308416
    s_mov_b32 s15, 0x00020000
    s_mov_b32 s16, s48
    s_and_b32 s17, s49, 0xffff
    s_mov_b32 s18, 5308416
    s_mov_b32 s19, 0x00020000
    s_mov_b32 s20, s50
    s_and_b32 s21, s51, 0xffff
    s_mov_b32 s22, 5308416
    s_mov_b32 s23, 0x00020000
    s_mul_i32 s36, s32, 18
    s_sub_u32 s56, s33, 14
    s_add_u32 s36, s36, s56
    v_lshrrev_b32 v7, 2, v1
    v_and_b32 v8, 3, v1
    v_mul_u32_u24 v104, 9216, v7
    v_lshl_add_u32 v104, v8, 4, v104
    s_lshl_b32 s38, s36, 6
    s_mul_i32 s56, s34, 1327104
    s_add_u32 s38, s38, s56
    s_mov_b32 s39, s38
    s_mul_i32 s40, s34, 9216
    s_mov_b32 s41, 147456
    s_mul_i32 s42, s36, 36864
    s_mul_i32 s56, s34, 288
    s_add_u32 s42, s42, s56
    v_add_u32 v14, 0, v1
    v_mul_u32_u24 v15, 3641, v14
    v_lshrrev_b32 v15, 16, v15
    v_mul_u32_u24 v16, 18, v15
    v_sub_u32 v14, v14, v16
    v_mul_u32_u24 v15, 1152, v15
    v_lshl_add_u32 v105, v14, 4, v15
    v_add_u32 v14, 64, v1
    v_mul_u32_u24 v15, 3641, v14
    v_lshrrev_b32 v15, 16, v15
    v_mul_u32_u24 v16, 18, v15
    v_sub_u32 v14, v14, v16
    v_mul_u32_u24 v15, 1152, v15
    v_lshl_add_u32 v106, v14, 4, v15
    v_add_u32 v14, 128, v1
    v_mul_u32_u24 v15, 3641, v14
    v_lshrrev_b32 v15, 16, v15
    v_mul_u32_u24 v16, 18, v15
    v_sub_u32 v14, v14, v16
    v_mul_u32_u24 v15, 1152, v15
    v_lshl_add_u32 v107, v14, 4, v15
    v_add_u32 v14, 192, v1
    v_mul_u32_u24 v15, 3641, v14
    v_lshrrev_b32 v15, 16, v15
    v_mul_u32_u24 v16, 18, v15
    v_sub_u32 v14, v14, v16
    v_mul_u32_u24 v15, 1152, v15
    v_lshl_add_u32 v108, v14, 4, v15
    v_add_u32 v14, 256, v1
    v_mul_u32_u24 v15, 3641, v14
    v_lshrrev_b32 v15, 16, v15
    v_mul_u32_u24 v16, 18, v15
    v_sub_u32 v14, v14, v16
    v_mul_u32_u24 v15, 1152, v15
    v_lshl_add_u32 v109, v14, 4, v15
    v_add_u32 v14, 320, v1
    v_mul_u32_u24 v15, 3641, v14
    v_lshrrev_b32 v15, 16, v15
    v_mul_u32_u24 v16, 18, v15
    v_sub_u32 v14, v14, v16
    v_mul_u32_u24 v15, 1152, v15
    v_lshl_add_u32 v110, v14, 4, v15
    v_add_u32 v14, 384, v1
    v_mul_u32_u24 v15, 3641, v14
    v_lshrrev_b32 v15, 16, v15
    v_mul_u32_u24 v16, 18, v15
    v_sub_u32 v14, v14, v16
    v_mul_u32_u24 v15, 1152, v15
    v_lshl_add_u32 v111, v14, 4, v15
    v_add_u32 v14, 448, v1
    v_mul_u32_u24 v15, 3641, v14
    v_lshrrev_b32 v15, 16, v15
    v_mul_u32_u24 v16, 18, v15
    v_sub_u32 v14, v14, v16
    v_mul_u32_u24 v15, 1152, v15
    v_lshl_add_u32 v112, v14, 4, v15
    v_add_u32 v14, 512, v1
    v_mul_u32_u24 v15, 3641, v14
    v_lshrrev_b32 v15, 16, v15
    v_mul_u32_u24 v16, 18, v15
    v_sub_u32 v14, v14, v16
    v_mul_u32_u24 v15, 1152, v15
    v_lshl_add_u32 v113, v14, 4, v15
    v_lshlrev_b32 v118, 6, v3
    v_lshl_add_u32 v118, v4, 4, v118
    v_add_u32 v119, 4096, v118
    s_mul_i32 s45, s36, 18432
    s_mul_i32 s44, s34, 4608
    s_add_u32 s45, s45, s44
    s_add_u32 s45, s45, 13697024
    s_mul_i32 s44, s65, 0x85ebca6b
    s_not_b32 s44, s44
    v_mov_b32 v114, s44
    v_mov_b32 v115, s44
    v_mov_b32 v116, s44
    v_mov_b32 v117, s44
    v_lshlrev_b32 v120, 7, v1
    s_add_u32 m0, s40, 49664
    s_nop 0
    buffer_load_dwordx4 v104, s[12:15], s38 offen lds
    s_add_u32 s38, s38, s41
    s_add_u32 m0, s40, 50688
    s_nop 0
    buffer_load_dwordx4 v104, s[12:15], s38 offen lds
    s_add_u32 s38, s38, s41
    s_add_u32 m0, s40, 51712
    s_nop 0
    buffer_load_dwordx4 v104, s[12:15], s38 offen lds
    s_add_u32 s38, s38, s41
    s_add_u32 m0, s40, 52736
    s_nop 0
    buffer_load_dwordx4 v104, s[12:15], s38 offen lds
    s_add_u32 s38, s38, s41
    s_add_u32 m0, s40, 53760
    s_nop 0
    buffer_load_dwordx4 v104, s[12:15], s38 offen lds
    s_add_u32 s38, s38, s41
    s_add_u32 m0, s40, 54784
    s_nop 0
    buffer_load_dwordx4 v104, s[12:15], s38 offen lds
    s_add_u32 s38, s38, s41
    s_add_u32 m0, s40, 55808
    s_nop 0
    buffer_load_dwordx4 v104, s[12:15], s38 offen lds
    s_add_u32 s38, s38, s41
    s_add_u32 m0, s40, 56832
    s_nop 0
    buffer_load_dwordx4 v104, s[12:15], s38 offen lds
    s_add_u32 s38, s38, s41
    s_waitcnt vmcnt(8)
    s_branch phK_nb2
phK_nb1:
    s_waitcnt vmcnt(0)
phK_nb2:
    s_barrier
phK_cp2:
    v_add_u32 v32, s75, v5
    ds_read_b128 v[152:155], v32 offset:34816
    s_lshl_b32 s56, s35, 12
    v_add_u32 v33, s56, v32
    ds_read_b128 v[136:139], v33 offset:20480
    ds_read_b128 v[140:143], v33 offset:21504
    ds_read_b128 v[144:147], v33 offset:22528
    ds_read_b128 v[148:151], v33 offset:23552
    s_mul_i32 s56, s35, 3072
    s_sub_u32 s57, 3072, s56
    v_add_u32 v33, s57, v32
    ds_read_b128 v[216:219], v33 offset:36864
    ds_read_b128 v[220:223], v33 offset:37888
    ds_read_b128 v[224:227], v33 offset:38912
    v_add_u32 v33, s56, v32
    v_and_b32 v180, 0xffff, v228
    v_lshrrev_b32 v181, 16, v228
    v_and_b32 v182, 0xffff, v229
    v_lshrrev_b32 v183, 16, v229
    v_and_b32 v184, 0xffff, v230
    v_lshrrev_b32 v185, 16, v230
    v_and_b32 v186, 0xffff, v231
    v_lshrrev_b32 v187, 16, v231
    v_and_b32 v188, 0xffff, v232
    v_lshrrev_b32 v189, 16, v232
    v_and_b32 v190, 0xffff, v233
    v_lshrrev_b32 v191, 16, v233
    v_and_b32 v196, 0xffff, v234
    v_and_b32 v192, 0xffff0000, v234
    ds_read_b128 v[228:231], v33 offset:28672
    ds_read_b128 v[232:235], v33 offset:29696
    ds_read_b128 v[236:239], v33 offset:30720
    v_lshlrev_b32 v23, 1, v4
    v_mul_u32_u24 v22, s2, v23
    v_add_u32 v23, s2, v22
    v_cvt_f32_u32 v22, v22
    v_cvt_f32_u32 v23, v23
    s_waitcnt lgkmcnt(10)
    v_fmamk_f32 v28, v22, 0x3a000000, v152
    v_fmamk_f32 v29, v22, 0x3a000000, v153
    v_fmamk_f32 v30, v23, 0x3a000000, v154
    v_fmamk_f32 v31, v23, 0x3a000000, v155
    v_cos_f32 v28, v28
    v_cos_f32 v29, v29
    v_cos_f32 v30, v30
    v_cos_f32 v31, v31
    s_mov_b32 s28, s52
    s_and_b32 s29, s53, 0xffff
    s_mov_b32 s30, 2359296
    s_mov_b32 s31, 0x00020000
    v_pk_mul_f32 v[28:29], v[28:29], 0.5 op_sel_hi:[1,0]
    v_pk_mul_f32 v[30:31], v[30:31], 0.5 op_sel_hi:[1,0]
    v_cvt_pk_f16_f32 v194, v28, v29
    v_cvt_pk_f16_f32 v195, v30, v31
    s_or_b32 s67, s65, 0x80000000
    s_lshl_b32 s68, s2, 7
    s_add_u32 s69, s68, 425984
    v_lshrrev_b32 v22, 7, v191
    v_and_b32 v191, 0x70, v191
    v_lshl_add_u32 v191, v22, 15, v191
    s_cmp_lg_u32 s3, 7
    s_cbranch_scc1 phK_c0
    s_cmp_lt_u32 s2, 104
    s_cbranch_scc1 phK_c
    s_add_u32 s8, s33, 63
    s_cmp_ge_u32 s8, 81
    s_cselect_b64 s[4:5], s[48:49], s[46:47]
    s_cselect_b32 s9, 81, 0
    s_mul_i32 s10, s32, 1152
    s_and_b32 s5, s5, 0xffff
    s_mov_b32 s6, 5308416
    s_sub_u32 s9, s8, s9
    s_lshl_b32 s9, s9, 6
    v_add_u32 v246, s9, v1
    s_cmp_lt_u32 s8, 162
    s_cselect_b32 s9, -1, 0
    v_mul_u32_u24 v247, 7282, v246
    v_lshrrev_b32 v247, 16, v247
    v_lshlrev_b32 v246, 7, v246
    s_movk_i32 s11, 8064
    v_mad_u32_u24 v246, v247, s11, v246
    s_mov_b32 s11, 1179648
    v_bfe_u32 v245, v247, 4, 2
    v_mad_u32_u24 v246, v245, s11, v246
    s_mov_b32 s11, 442368
    v_lshrrev_b32 v245, 6, v247
    v_mul_u32_u24 v245, s11, v245
    v_sub_u32 v246, v246, v245
    v_and_b32 v246, s9, v246
Kw_6:
    s_memrealtime s[72:73]
    s_waitcnt lgkmcnt(0)
    s_sub_u32 s72, s72, s65
    s_cmp_ge_u32 s72, 420
    s_cbranch_scc1 Kx_7
    s_sleep 1
    s_branch Kw_6
Kx_7:
    buffer_load_dword v255, v246, s[4:7], s10 offen
    s_add_u32 s8, s8, 19
    s_cmp_ge_u32 s8, 81
    s_cselect_b64 s[4:5], s[48:49], s[46:47]
    s_cselect_b32 s9, 81, 0
    s_mul_i32 s10, s32, 1152
    s_and_b32 s5, s5, 0xffff
    s_mov_b32 s6, 5308416
    s_sub_u32 s9, s8, s9
    s_lshl_b32 s9, s9, 6
    v_add_u32 v246, s9, v1
    s_cmp_lt_u32 s8, 162
    s_cselect_b32 s9, -1, 0
    v_mul_u32_u24 v247, 7282, v246
    v_lshrrev_b32 v247, 16, v247
    v_lshlrev_b32 v246, 7, v246
    s_movk_i32 s11, 8064
    v_mad_u32_u24 v246, v247, s11, v246
    s_mov_b32 s11, 1179648
    v_bfe_u32 v245, v247, 4, 2
    v_mad_u32_u24 v246, v245, s11, v246
    s_mov_b32 s11, 442368
    v_lshrrev_b32 v245, 6, v247
    v_mul_u32_u24 v245, s11, v245
    v_sub_u32 v246, v246, v245
    v_and_b32 v246, s9, v246
    buffer_load_dword v255, v246, s[4:7], s10 offen
    s_add_u32 s8, s8, 19
    s_cmp_ge_u32 s8, 81
    s_cselect_b64 s[4:5], s[48:49], s[46:47]
    s_cselect_b32 s9, 81, 0
    s_mul_i32 s10, s32, 1152
    s_and_b32 s5, s5, 0xffff
    s_mov_b32 s6, 5308416
    s_sub_u32 s9, s8, s9
    s_lshl_b32 s9, s9, 6
    v_add_u32 v246, s9, v1
    s_cmp_lt_u32 s8, 162
    s_cselect_b32 s9, -1, 0
    v_mul_u32_u24 v247, 7282, v246
    v_lshrrev_b32 v247, 16, v247
    v_lshlrev_b32 v246, 7, v246
    s_movk_i32 s11, 8064
    v_mad_u32_u24 v246, v247, s11, v246
    s_mov_b32 s11, 1179648
    v_bfe_u32 v245, v247, 4, 2
    v_mad_u32_u24 v246, v245, s11, v246
    s_mov_b32 s11, 442368
    v_lshrrev_b32 v245, 6, v247
    v_mul_u32_u24 v245, s11, v245
    v_sub_u32 v246, v246, v245
    v_and_b32 v246, s9, v246
    buffer_load_dword v255, v246, s[4:7], s10 offen
    s_add_u32 s8, s8, 19
    s_cmp_ge_u32 s8, 81
    s_cselect_b64 s[4:5], s[48:49], s[46:47]
    s_cselect_b32 s9, 81, 0
    s_mul_i32 s10, s32, 1152
    s_and_b32 s5, s5, 0xffff
    s_mov_b32 s6, 5308416
    s_sub_u32 s9, s8, s9
    s_lshl_b32 s9, s9, 6
    v_add_u32 v246, s9, v1
    s_cmp_lt_u32 s8, 162
    s_cselect_b32 s9, -1, 0
    v_mul_u32_u24 v247, 7282, v246
    v_lshrrev_b32 v247, 16, v247
    v_lshlrev_b32 v246, 7, v246
    s_movk_i32 s11, 8064
    v_mad_u32_u24 v246, v247, s11, v246
    s_mov_b32 s11, 1179648
    v_bfe_u32 v245, v247, 4, 2
    v_mad_u32_u24 v246, v245, s11, v246
    s_mov_b32 s11, 442368
    v_lshrrev_b32 v245, 6, v247
    v_mul_u32_u24 v245, s11, v245
    v_sub_u32 v246, v246, v245
    v_and_b32 v246, s9, v246
    buffer_load_dword v255, v246, s[4:7], s10 offen
    s_add_u32 s8, s8, 19
    s_cmp_ge_u32 s8, 81
    s_cselect_b64 s[4:5], s[48:49], s[46:47]
    s_cselect_b32 s9, 81, 0
    s_mul_i32 s10, s32, 1152
    s_and_b32 s5, s5, 0xffff
    s_mov_b32 s6, 5308416
    s_sub_u32 s9, s8, s9
    s_lshl_b32 s9, s9, 6
    v_add_u32 v246, s9, v1
    s_cmp_lt_u32 s8, 162
    s_cselect_b32 s9, -1, 0
    v_mul_u32_u24 v247, 7282, v246
    v_lshrrev_b32 v247, 16, v247
    v_lshlrev_b32 v246, 7, v246
    s_movk_i32 s11, 8064
    v_mad_u32_u24 v246, v247, s11, v246
    s_mov_b32 s11, 1179648
    v_bfe_u32 v245, v247, 4, 2
    v_mad_u32_u24 v246, v245, s11, v246
    s_mov_b32 s11, 442368
    v_lshrrev_b32 v245, 6, v247
    v_mul_u32_u24 v245, s11, v245
    v_sub_u32 v246, v246, v245
    v_and_b32 v246, s9, v246
    buffer_load_dword v255, v246, s[4:7], s10 offen
    s_cmp_eq_u32 s37, 0
    s_cbranch_scc1 phK_c
Kw_8:
    s_memrealtime s[72:73]
    s_waitcnt lgkmcnt(0)
    s_sub_u32 s72, s72, s65
    s_cmp_ge_u32 s72, 455
    s_cbranch_scc1 Kx_9
    s_sleep 1
    s_branch Kw_8
Kx_9:
    v_lshlrev_b32 v246, 7, v1
    s_mul_i32 s10, s32, 663552
    s_add_u32 s8, s33, 4294967282
    s_min_u32 s9, s8, 80
    s_lshl_b32 s9, s9, 13
    s_add_u32 s9, s9, s10
    buffer_load_dword v255, v246, s[20:23], s9 offen
    s_add_u32 s8, s8, 18
    s_min_u32 s9, s8, 80
    s_lshl_b32 s9, s9, 13
    s_add_u32 s9, s9, s10
    buffer_load_dword v255, v246, s[20:23], s9 offen
    s_add_u32 s8, s8, 18
phK_c0:
    s_cmp_eq_u32 s37, 0
    s_cbranch_scc1 phK_c
Kw_10:
    s_memrealtime s[72:73]
    s_waitcnt lgkmcnt(0)
    s_sub_u32 s72, s72, s65
    s_cmp_ge_u32 s72, 536
    s_cbranch_scc1 Kx_11
    s_sleep 1
    s_branch Kw_10
Kx_11:
    s_add_u32 m0, s40, 57856
    s_nop 0
    buffer_load_dwordx4 v104, s[12:15], s38 offen lds
    s_add_u32 m0, s40, 86528
    s_nop 0
    buffer_load_dwordx4 v104, s[16:19], s39 offen lds
    s_add_u32 s39, s39, s41
    s_add_u32 m0, s40, 87552
    s_nop 0
    buffer_load_dwordx4 v104, s[16:19], s39 offen lds
    s_add_u32 s39, s39, s41
    s_add_u32 m0, s40, 88576
    s_nop 0
    buffer_load_dwordx4 v104, s[16:19], s39 offen lds
    s_add_u32 s39, s39, s41
    s_add_u32 m0, s40, 89600
    s_nop 0
    buffer_load_dwordx4 v104, s[16:19], s39 offen lds
    s_add_u32 s39, s39, s41
    s_cmp_lg_u32 s3, 7
    s_cbranch_scc1 phK_c
Kw_12:
    s_memrealtime s[72:73]
    s_waitcnt lgkmcnt(0)
    s_sub_u32 s72, s72, s65
    s_cmp_ge_u32 s72, 676
    s_cbranch_scc1 Kx_13
    s_sleep 1
    s_branch Kw_12
Kx_13:
    v_lshlrev_b32 v246, 7, v1
    s_mul_i32 s10, s32, 663552
    s_add_u32 s8, s33, 22
    s_min_u32 s9, s8, 80
    s_lshl_b32 s9, s9, 13
    s_add_u32 s9, s9, s10
    buffer_load_dword v255, v246, s[20:23], s9 offen
    s_add_u32 s8, s8, 18
    s_min_u32 s9, s8, 80
    s_lshl_b32 s9, s9, 13
    s_add_u32 s9, s9, s10
    buffer_load_dword v255, v246, s[20:23], s9 offen
    s_add_u32 s8, s8, 18
    s_min_u32 s9, s8, 80
    s_lshl_b32 s9, s9, 13
    s_add_u32 s9, s9, s10
    buffer_load_dword v255, v246, s[20:23], s9 offen
    s_add_u32 s8, s8, 18
phK_c:
    v_mov_b32 v32, 0
    v_mov_b32 v33, 0
    ds_write_b64 v196, v[32:33]
    v_mov_b32 v100, 0
    v_mov_b32 v101, 0
    s_cmp_eq_u32 s3, 7
    s_cbranch_scc1 phK_g7
Kw_14:
    s_memrealtime s[72:73]
    s_waitcnt lgkmcnt(0)
    s_sub_u32 s72, s72, s65
    s_cmp_ge_u32 s72, 636
    s_cbranch_scc1 Kx_15
    s_sleep 1
    s_branch Kw_14
Kx_15:
    s_mov_b32 s57, 0
phK_gl:
    buffer_load_dwordx4 v[8:11], v191, s[24:27], s68 offen sc1
    buffer_load_dwordx4 v[12:15], v191, s[24:27], s69 offen sc1
    s_add_u32 s57, s57, 1
    s_waitcnt vmcnt(0)
    v_xor_b32 v22, s67, v11
    v_bitop3_b32 v22, v15, v22, s67 bitop3:0xde
    v_cmp_lt_u32 vcc, 0x1ff, v22
    s_wqm_b64 exec, vcc
    s_cbranch_scc0 phK_gok
    s_sleep 2
    s_cmp_lt_u32 s57, 20000
    s_cbranch_scc1 phK_gl
phK_gok:
    s_mov_b32 exec_lo, 0x11111111
    s_mov_b32 exec_hi, 0x11111111
    v_max_u32 v22, v11, v15
    ds_max_u32 v248, v22 offset:292
    s_mov_b64 exec, -1
    s_memrealtime s[74:75]
phK_g7:
    s_setprio 2
    s_waitcnt lgkmcnt(0)
    s_barrier
    ds_read_b32 v22, v248 offset:292
    s_cmp_eq_u32 s37, 0
    s_cbranch_scc1 Ks_16
    s_add_u32 m0, s40, 90624
    s_nop 0
    buffer_load_dwordx4 v104, s[16:19], s39 offen lds
    s_add_u32 s39, s39, s41
    s_add_u32 m0, s40, 91648
    s_nop 0
    buffer_load_dwordx4 v104, s[16:19], s39 offen lds
    s_add_u32 s39, s39, s41
Ks_16:
    s_waitcnt lgkmcnt(0)
    v_and_b32 v22, 0x1ff, v22
    v_sub_u32 v23, 127, v22
    v_lshlrev_b32 v23, 23, v23
    v_lshl_add_u32 v24, v11, 23, v23
    v_lshl_add_u32 v25, v15, 23, v23
    v_max_i32 v24, 0, v24
    v_max_i32 v25, 0, v25
    v_cvt_pk_f16_f32 v24, v24, v24
    v_cvt_pk_f16_f32 v25, v25, v25
    v_pk_mul_f16 v16, v8, v24
    v_pk_mul_f16 v17, v12, v25
    v_pk_mul_f16 v18, v9, v24
    v_pk_mul_f16 v19, v13, v25
    v_pk_mul_f16 v20, v10, v24
    v_pk_mul_f16 v21, v14, v25
    v_add_u32 v22, 1, v22
    v_lshlrev_b32 v102, 23, v22
    v_lshlrev_b32 v103, 7, v22
    v_mfma_f32_16x16x16_f16 v[24:27], v[194:195], v[16:17], 0
    v_mfma_f32_16x16x16_f16 v[28:31], v[194:195], v[18:19], 0
    v_mfma_f32_16x16x16_f16 v[32:35], v[194:195], v[20:21], 0
    s_nop 3
    v_pk_mul_f32 v[24:25], v[24:25], v[192:193] op_sel_hi:[1,0]
    v_pk_mul_f32 v[26:27], v[26:27], v[192:193] op_sel_hi:[1,0]
    v_cvt_pk_f16_f32 v36, v24, v25
    v_cvt_pk_f16_f32 v37, v26, v27
    ds_write_b32 v180, v36
    ds_write_b32 v181, v37
    v_cvt_pk_f16_f32 v38, v28, v29
    v_cvt_pk_f16_f32 v39, v30, v31
    ds_write_b32 v182, v38
    ds_write_b32 v183, v39
    v_cvt_pk_f16_f32 v40, v32, v33
    v_cvt_pk_f16_f32 v41, v34, v35
    ds_write_b32 v184, v40
    ds_write_b32 v185, v41
    s_cmp_eq_u32 s37, 0
    s_cbranch_scc1 Ks_17
    s_add_u32 m0, s40, 92672
    s_nop 0
    buffer_load_dwordx4 v104, s[16:19], s39 offen lds
    s_add_u32 s39, s39, s41
    s_add_u32 m0, s40, 93696
    s_nop 0
    buffer_load_dwordx4 v104, s[16:19], s39 offen lds
    s_add_u32 s39, s39, s41
    s_add_u32 m0, s40, 94720
    s_nop 0
    buffer_load_dwordx4 v104, s[16:19], s39 offen lds
Ks_17:
    s_waitcnt lgkmcnt(0)
    s_barrier
    ds_read_b64 v[36:37], v186 offset:0
    ds_read_b64 v[38:39], v186 offset:32
    ds_read_b64 v[42:43], v186 offset:1280
    ds_read_b64 v[44:45], v186 offset:1312
    ds_read_b64 v[40:41], v187 offset:0
    ds_read_b64 v[46:47], v187 offset:1280
    s_cmp_eq_u32 s37, 0
    s_cbranch_scc1 Ks_18
    s_mov_b32 exec_hi, 15
    buffer_load_dword v255, v120, s[24:27], s45 offen
    s_mov_b32 exec_hi, -1
Ks_18:
    s_waitcnt lgkmcnt(4)
    v_mfma_f32_16x16x32_f16 v[52:55], v[36:39], v[228:231], 0
    v_mfma_f32_16x16x32_f16 v[56:59], v[36:39], v[232:235], 0
    s_waitcnt lgkmcnt(2)
    v_mfma_f32_16x16x32_f16 v[60:63], v[42:45], v[228:231], 0
    v_mfma_f32_16x16x32_f16 v[64:67], v[42:45], v[232:235], 0
    s_waitcnt lgkmcnt(0)
    v_mfma_f32_16x16x16_f16 v[52:55], v[40:41], v[236:237], v[52:55]
    v_mfma_f32_16x16x16_f16 v[56:59], v[40:41], v[238:239], v[56:59]
    v_mfma_f32_16x16x16_f16 v[60:63], v[46:47], v[236:237], v[60:63]
    v_mfma_f32_16x16x16_f16 v[64:67], v[46:47], v[238:239], v[64:67]
    s_nop 1
    v_pk_mul_f32 v[20:21], v[52:53], v[136:137]
    v_pk_mul_f32 v[22:23], v[56:57], v[136:137]
    v_pk_fma_f32 v[20:21], v[56:57], v[140:141], v[20:21] neg_lo:[1,0,0] neg_hi:[1,0,0]
    v_pk_fma_f32 v[22:23], v[52:53], v[140:141], v[22:23]
    v_cvt_pk_f16_f32 v68, v20, v21
    v_cvt_pk_f16_f32 v72, v22, v23
    v_pk_mul_f32 v[20:21], v[54:55], v[138:139]
    v_pk_mul_f32 v[22:23], v[58:59], v[138:139]
    v_pk_fma_f32 v[20:21], v[58:59], v[142:143], v[20:21] neg_lo:[1,0,0] neg_hi:[1,0,0]
    v_pk_fma_f32 v[22:23], v[54:55], v[142:143], v[22:23]
    v_cvt_pk_f16_f32 v69, v20, v21
    v_cvt_pk_f16_f32 v73, v22, v23
    v_pk_mul_f32 v[20:21], v[60:61], v[144:145]
    v_pk_mul_f32 v[22:23], v[64:65], v[144:145]
    v_pk_fma_f32 v[20:21], v[64:65], v[148:149], v[20:21] neg_lo:[1,0,0] neg_hi:[1,0,0]
    v_pk_fma_f32 v[22:23], v[60:61], v[148:149], v[22:23]
    v_cvt_pk_f16_f32 v70, v20, v21
    v_cvt_pk_f16_f32 v74, v22, v23
    v_pk_mul_f32 v[20:21], v[62:63], v[146:147]
    v_pk_mul_f32 v[22:23], v[66:67], v[146:147]
    v_pk_fma_f32 v[20:21], v[66:67], v[150:151], v[20:21] neg_lo:[1,0,0] neg_hi:[1,0,0]
    v_pk_fma_f32 v[22:23], v[62:63], v[150:151], v[22:23]
    v_cvt_pk_f16_f32 v71, v20, v21
    v_cvt_pk_f16_f32 v75, v22, v23
    s_nop 1
    v_mfma_f32_16x16x32_f16 v[76:79], v[68:71], v[204:207], 0
    v_mfma_f32_16x16x32_f16 v[80:83], v[68:71], v[208:211], 0
    v_mfma_f32_16x16x32_f16 v[84:87], v[68:71], v[216:219], 0
    v_mfma_f32_16x16x32_f16 v[88:91], v[68:71], v[220:223], 0
    v_mfma_f32_16x16x32_f16 v[76:79], v[72:75], v[212:215], v[76:79]
    v_mfma_f32_16x16x32_f16 v[80:83], v[72:75], v[204:207], v[80:83]
    v_mfma_f32_16x16x32_f16 v[84:87], v[72:75], v[224:227], v[84:87]
    v_mfma_f32_16x16x32_f16 v[88:91], v[72:75], v[216:219], v[88:91]
    v_lshlrev_b32 v20, 16, v250
    v_and_b32 v21, 0xffff0000, v250
    v_lshlrev_b32 v22, 16, v251
    v_and_b32 v23, 0xffff0000, v251
    v_lshlrev_b32 v24, 16, v252
    v_and_b32 v25, 0xffff0000, v252
    v_lshlrev_b32 v26, 16, v253
    v_and_b32 v27, 0xffff0000, v253
    v_lshlrev_b32 v28, 16, v254
    v_and_b32 v29, 0xffff0000, v254
    s_cmp_lg_u32 s35, 0
    s_cbranch_scc1 phK_y1
    ds_write2_b64 v188, v[76:77], v[78:79] offset0:0 offset1:1
    ds_write_b64 v188, v[80:81] offset:2304
    ds_write_b64 v188, v[82:83] offset:2312
    ds_write2_b64 v188, v[84:85], v[86:87] offset0:144 offset1:145
    ds_write_b64 v188, v[88:89] offset:3456
    ds_write_b64 v188, v[90:91] offset:3464
    s_branch phK_y2
phK_y1:
    s_mov_b64 exec, 0xffff
    ds_write_b64 v188, v[76:77] offset:1152
    ds_write_b64 v188, v[80:81] offset:3456
    ds_write_b64 v188, v[84:85] offset:0
    ds_write_b64 v188, v[88:89] offset:2304
    s_mov_b64 exec, -1
phK_y2:
    s_waitcnt lgkmcnt(0)
    s_barrier
    ds_read_b128 v[92:95], v189
    ds_read_b128 v[96:99], v189 offset:16
    s_mov_b32 exec_hi, 0
    ds_read_b64 v[100:101], v190
    s_mov_b32 exec_hi, -1
    v_lshlrev_b32 v12, 13, v1
    s_lshl_b32 s56, s2, 5
    v_add_u32 v12, s56, v12
    s_lshl_b32 s56, s3, 1
    v_mov_b32 v10, s56
    s_add_u32 s62, s61, 9699328
    s_mov_b32 s63, 6815744
    s_waitcnt lgkmcnt(2)
    v_cvt_pk_bf16_f32 v40, v92, v93
    v_dot2_f32_bf16 v92, v40, v103, v20
    v_dot2_f32_bf16 v93, v40, v102, v21
    v_cvt_pk_bf16_f32 v41, v94, v95
    v_dot2_f32_bf16 v94, v41, v103, v22
    v_dot2_f32_bf16 v95, v41, v102, v23
    s_waitcnt lgkmcnt(1)
    v_cvt_pk_bf16_f32 v42, v96, v97
    v_dot2_f32_bf16 v96, v42, v103, v24
    v_dot2_f32_bf16 v97, v42, v102, v25
    v_cvt_pk_bf16_f32 v43, v98, v99
    v_dot2_f32_bf16 v98, v43, v103, v26
    v_dot2_f32_bf16 v99, v43, v102, v27
    s_waitcnt lgkmcnt(0)
    v_cvt_pk_bf16_f32 v44, v100, v101
    v_dot2_f32_bf16 v100, v44, v103, v28
    v_dot2_f32_bf16 v101, v44, v102, v29
    v_cvt_pk_bf16_f32 v200, v92, v93
    v_cvt_pk_bf16_f32 v202, v94, v95
    v_cvt_pk_bf16_f32 v204, v96, v97
    v_cvt_pk_bf16_f32 v206, v98, v99
    s_nop 0
    v_cvt_pk_bf16_f32 v208, v100, v101
    v_dot2_f32_bf16 v48, v200, s43, 0
    v_dot2_f32_bf16 v50, v200, v200, 0
    v_dot2_f32_bf16 v48, v202, s43, v48
    v_dot2_f32_bf16 v50, v202, v202, v50
    v_dot2_f32_bf16 v48, v204, s43, v48
    v_dot2_f32_bf16 v50, v204, v204, v50
    v_dot2_f32_bf16 v48, v206, s43, v48
    v_dot2_f32_bf16 v50, v206, v206, v50
    v_dot2_f32_bf16 v48, v208, s43, v48
    v_dot2_f32_bf16 v50, v208, v208, v50
    v_mov_b32 v49, 0x3ae38e39
    s_nop 0
    s_nop 0
    v_add_f32_dpp v48, v48, v48 quad_perm:[1,0,3,2] row_mask:0xf bank_mask:0xf
    v_add_f32_dpp v50, v50, v50 quad_perm:[1,0,3,2] row_mask:0xf bank_mask:0xf
    s_nop 0
    v_add_f32_dpp v48, v48, v48 quad_perm:[2,3,0,1] row_mask:0xf bank_mask:0xf
    v_add_f32_dpp v50, v50, v50 quad_perm:[2,3,0,1] row_mask:0xf bank_mask:0xf
    s_nop 0
    v_add_f32_dpp v48, v48, v48 row_half_mirror row_mask:0xf bank_mask:0xf
    v_add_f32_dpp v50, v50, v50 row_half_mirror row_mask:0xf bank_mask:0xf
    s_nop 0
    v_add_f32_dpp v48, v48, v48 row_mirror row_mask:0xf bank_mask:0xf
    v_add_f32_dpp v50, v50, v50 row_mirror row_mask:0xf bank_mask:0xf
    s_nop 0
    v_add_f32_dpp v48, v48, v48 row_bcast:15 row_mask:0xa bank_mask:0xf
    v_add_f32_dpp v50, v50, v50 row_bcast:15 row_mask:0xa bank_mask:0xf
    s_nop 0
    v_add_f32_dpp v48, v48, v48 row_bcast:31 row_mask:0xc bank_mask:0xf
    v_add_f32_dpp v50, v50, v50 row_bcast:31 row_mask:0xc bank_mask:0xf
    s_nop 0
    v_readlane_b32 s58, v48, 63
    v_readlane_b32 s59, v50, 63
    s_nop 0
    v_mul_f32 v48, s58, v49
    v_mul_f32 v50, s59, v49
    v_fma_f32 v50, -v48, v48, v50
    v_cvt_pk_bf16_f32 v48, v48, v48
    v_and_b32 v48, 0xffff0000, v48
    v_max_f32 v50, 0, v50
    v_cvt_pk_bf16_f32 v50, v50, v50
    v_and_b32 v50, 0xffff0000, v50
    v_add_f32 v50, 0x3727c5ac, v50
    v_cvt_pk_bf16_f32 v50, v50, v50
    v_and_b32 v50, 0xffff0000, v50
    v_sqrt_f32 v50, v50
    v_dot2_f32_bf16 v92, v200, s54, v48 neg_lo:[0,0,1]
    v_dot2_f32_bf16 v93, v200, s55, v48 neg_lo:[0,0,1]
    v_dot2_f32_bf16 v94, v202, s54, v48 neg_lo:[0,0,1]
    v_dot2_f32_bf16 v95, v202, s55, v48 neg_lo:[0,0,1]
    v_dot2_f32_bf16 v96, v204, s54, v48 neg_lo:[0,0,1]
    v_dot2_f32_bf16 v97, v204, s55, v48 neg_lo:[0,0,1]
    v_dot2_f32_bf16 v98, v206, s54, v48 neg_lo:[0,0,1]
    v_dot2_f32_bf16 v99, v206, s55, v48 neg_lo:[0,0,1]
    v_dot2_f32_bf16 v100, v208, s54, v48 neg_lo:[0,0,1]
    v_dot2_f32_bf16 v101, v208, s55, v48 neg_lo:[0,0,1]
    v_cvt_pk_bf16_f32 v50, v50, v50
    v_and_b32 v50, 0xffff0000, v50
    v_rcp_f32 v50, v50
    v_cvt_pk_bf16_f32 v40, v92, v93
    v_cvt_pk_bf16_f32 v41, v94, v95
    v_cvt_pk_bf16_f32 v42, v96, v97
    v_cvt_pk_bf16_f32 v43, v98, v99
    v_cvt_pk_bf16_f32 v44, v100, v101
    v_lshlrev_b32 v92, 16, v40
    v_and_b32 v93, 0xffff0000, v40
    v_lshlrev_b32 v94, 16, v41
    v_and_b32 v95, 0xffff0000, v41
    v_lshlrev_b32 v96, 16, v42
    v_and_b32 v97, 0xffff0000, v42
    v_lshlrev_b32 v98, 16, v43
    v_and_b32 v99, 0xffff0000, v43
    v_lshlrev_b32 v100, 16, v44
    v_and_b32 v101, 0xffff0000, v44
    v_pk_mul_f32 v[92:93], v[92:93], v[50:51] op_sel_hi:[1,0]
    v_pk_mul_f32 v[94:95], v[94:95], v[50:51] op_sel_hi:[1,0]
    v_pk_mul_f32 v[96:97], v[96:97], v[50:51] op_sel_hi:[1,0]
    v_pk_mul_f32 v[98:99], v[98:99], v[50:51] op_sel_hi:[1,0]
    v_pk_mul_f32 v[100:101], v[100:101], v[50:51] op_sel_hi:[1,0]
    v_cvt_pk_bf16_f32 v40, v92, v93
    v_cvt_pk_bf16_f32 v41, v94, v95
    v_cvt_pk_bf16_f32 v42, v96, v97
    v_cvt_pk_bf16_f32 v43, v98, v99
    v_cvt_pk_bf16_f32 v44, v100, v101
    v_dot2_f32_bf16 v54, v40, v240, 0
    v_dot2_f32_bf16 v54, v41, v241, v54
    v_dot2_f32_bf16 v54, v42, v242, v54
    v_dot2_f32_bf16 v54, v43, v243, v54
    v_dot2_f32_bf16 v54, v44, v244, v54
    buffer_store_dwordx4 v[40:43], v5, s[24:27], s62 offen sc1
    s_mov_b32 exec_hi, 0
    buffer_store_dword v44, v6, s[24:27], s62 offen offset:1024 sc1
    s_mov_b32 exec_hi, -1
    v_add_f32_dpp v54, v54, v54 quad_perm:[1,0,3,2] row_mask:0xf bank_mask:0xf
    s_nop 1
    v_add_f32_dpp v54, v54, v54 quad_perm:[2,3,0,1] row_mask:0xf bank_mask:0xf
    s_nop 1
    v_add_f32_dpp v54, v54, v54 row_half_mirror row_mask:0xf bank_mask:0xf
    s_nop 1
    v_add_f32_dpp v54, v54, v54 row_mirror row_mask:0xf bank_mask:0xf
    s_nop 1
    v_add_f32_dpp v54, v54, v54 row_bcast:15 row_mask:0xa bank_mask:0xf
    s_nop 1
    v_add_f32_dpp v54, v54, v54 row_bcast:31 row_mask:0xc bank_mask:0xf
    v_cvt_pk_bf16_f32 v54, v54, v54
    v_and_b32 v54, 0xffff, v54
    v_cmp_lt_u32 vcc, 0x7fff, v54
    v_xor_b32 v52, 0xffff, v54
    v_or_b32 v53, 0x8000, v54
    v_max_u32 v52, 1, v52
    v_cndmask_b32 v54, v53, v52, vcc
    s_mov_b32 exec_lo, 0
    s_brev_b32 exec_hi, 1
    ds_write_b16 v10, v54 offset:208
    s_mov_b64 exec, 1
    ds_add_rtn_u32 v15, v248, v249 offset:200
    s_mov_b64 exec, 0xff
    ds_read_b128 v[60:63], v248 offset:208
    v_mov_b32 v53, s65
    s_waitcnt lgkmcnt(0)
    v_readfirstlane_b32 s59, v15
    v_mov_b32 v52, v63
    v_mov_b32 v63, s65
    s_nop 1
    s_cmp_lg_u32 s59, 7
    s_cbranch_scc1 phK_np
    buffer_store_dwordx4 v[60:63], v12, s[24:27], s63 offen sc1
    buffer_store_dwordx2 v[52:53], v12, s[24:27], s63 offen offset:16 sc1
    s_nop 1
phK_np:
    s_setprio 0
    s_mov_b64 exec, -1
    v_lshlrev_b32 v92, 16, v40
    v_and_b32 v93, 0xffff0000, v40
    v_lshlrev_b32 v94, 16, v41
    v_and_b32 v95, 0xffff0000, v41
    v_lshlrev_b32 v96, 16, v42
    v_and_b32 v97, 0xffff0000, v42
    v_lshlrev_b32 v98, 16, v43
    v_and_b32 v99, 0xffff0000, v43
    v_lshlrev_b32 v100, 16, v44
    v_and_b32 v101, 0xffff0000, v44
    v_dot2_f32_bf16 v92, v200, s54, v92
    v_dot2_f32_bf16 v93, v200, s55, v93
    v_dot2_f32_bf16 v94, v202, s54, v94
    v_dot2_f32_bf16 v95, v202, s55, v95
    v_dot2_f32_bf16 v96, v204, s54, v96
    v_dot2_f32_bf16 v97, v204, s55, v97
    v_dot2_f32_bf16 v98, v206, s54, v98
    v_dot2_f32_bf16 v99, v206, s55, v99
    v_dot2_f32_bf16 v100, v208, s54, v100
    v_dot2_f32_bf16 v101, v208, s55, v101
    v_mov_b32 v201, s65
    v_mov_b32 v203, s65
    v_mov_b32 v205, s65
    v_mov_b32 v207, s65
    v_mov_b32 v209, s65
    v_cvt_pk_bf16_f32 v210, v92, v93
    v_cvt_pk_bf16_f32 v211, v94, v95
    v_cvt_pk_bf16_f32 v212, v96, v97
    v_cvt_pk_bf16_f32 v213, v98, v99
    v_cvt_pk_bf16_f32 v214, v100, v101
    v_mov_b32 v76, s65
    s_mov_b32 s62, 6881280
    s_mov_b32 s64, 0
    s_sub_u32 s69, 0x7ff, s60
    v_and_b32 v20, 7, v3
    v_lshlrev_b32 v20, 2, v20
    s_cmp_ge_u32 s3, 4
    s_cbranch_scc1 phK_t4
    v_lshlrev_b32 v7, 5, v0
    s_and_b32 s41, s2, 7
    s_lshl_b32 s41, s41, 13
    s_add_u32 s38, s62, s41
    s_add_u32 s40, s63, s41
    v_sub_u32 v64, 0x7ff, v0
    v_lshl_or_b32 v64, v64, 5, 31
    v_subrev_u32 v65, 8192, v64
    v_subrev_u32 v66, 16384, v64
    v_subrev_u32 v67, 24576, v64
    v_subrev_u32 v68, 32768, v64
    v_subrev_u32 v69, 40960, v64
    v_subrev_u32 v70, 49152, v64
    v_subrev_u32 v71, 57344, v64
    s_mov_b32 s41, 0xffff0000
    s_mov_b32 s43, 9699328
    v_lshrrev_b32 v15, 3, v0
    v_lshlrev_b32 v16, 2, v15
    v_mul_u32_u24 v15, 1168, v15
    v_and_b32 v17, 7, v1
    v_lshlrev_b32 v17, 4, v17
    v_add_u32 v17, 1024, v17
    v_add_u32 v15, v15, v17
    v_add_u32 v15, 10752, v15
    s_mul_i32 s49, s3, 9344
    s_add_u32 s49, s49, 10752
    v_add_u32 v18, s49, v5
    s_lshl_b32 s50, s3, 5
    v_mov_b32 v19, s50
    s_lshl_b32 s50, s3, 3
    s_mov_b32 s51, 0
    v_bfe_u32 v80, v1, 0, 1
    v_bfe_u32 v81, v1, 1, 1
    v_bfe_u32 v82, v1, 2, 1
    v_add_u32 v85, v19, v6
    v_add_u32 v80, -1, v80
    v_add_u32 v81, -1, v81
    v_add_u32 v82, -1, v82
    v_and_b32 v83, 31, v16
    v_and_b32 v84, 7, v1
    v_add_u32 v84, s50, v84
    v_mov_b32 v86, -1152
    s_mov_b32 s43, 12057472
    s_cmp_lg_u32 s59, 7
    s_cbranch_scc1 phK_w0a
    s_waitcnt vmcnt(2)
    s_branch phK_w1a
phK_w0a:
    s_waitcnt vmcnt(0)
phK_w1a:
    s_mov_b64 exec, 1
    ds_add_rtn_u32 v13, v248, v249 offset:204
    s_mov_b64 exec, 0xff
    s_waitcnt lgkmcnt(0)
    v_readfirstlane_b32 s59, v13
    s_nop 3
    s_cmp_lg_u32 s59, 7
    s_cbranch_scc1 phK_nda
    buffer_store_dword v76, v12, s[24:27], s62 offen sc1
phK_nda:
    s_mov_b64 exec, -1
Kw_19:
    s_memrealtime s[72:73]
    s_waitcnt lgkmcnt(0)
    s_sub_u32 s72, s72, s65
    s_cmp_ge_u32 s72, 928
    s_cbranch_scc1 Kx_20
    s_sleep 1
    s_branch Kw_19
Kx_20:
    s_cmp_ge_u32 s2, 112
    s_cbranch_scc1 Fd_21
    s_sleep 18
Fd_21:
phK_poll:
    buffer_load_dwordx4 v[60:63], v7, s[24:27], s40 offen sc1
    buffer_load_dwordx2 v[74:75], v7, s[24:27], s40 offen offset:16 sc1
    s_add_u32 s51, s51, 1
    s_waitcnt vmcnt(0)
    v_xor_b32 v72, s65, v63
    v_bitop3_b32 v72, v75, v72, s65 bitop3:0xde
    v_cmpx_ne_u32 vcc, 0, v72
    s_cbranch_vccz phK_pok
    s_sleep 8
    s_cmp_lt_u32 s51, 20000
    s_cbranch_scc1 phK_poll
phK_pok:
    s_mov_b64 exec, -1
    v_lshl_or_b32 v40, v60, 16, v64
    v_and_or_b32 v41, v60, s41, v65
    v_lshl_or_b32 v42, v61, 16, v66
    v_and_or_b32 v43, v61, s41, v67
    v_lshl_or_b32 v44, v62, 16, v68
    v_and_or_b32 v45, v62, s41, v69
    v_lshl_or_b32 v46, v74, 16, v70
    v_and_or_b32 v47, v74, s41, v71
    v_max_u32 v48, v40, v41
    v_min_u32 v41, v40, v41
    v_max_u32 v40, v42, v43
    v_min_u32 v43, v42, v43
    v_max_u32 v42, v44, v45
    v_min_u32 v45, v44, v45
    v_max_u32 v44, v46, v47
    v_min_u32 v47, v46, v47
    v_max_u32 v46, v48, v40
    v_min_u32 v40, v48, v40
    v_max_u32 v48, v41, v43
    v_min_u32 v43, v41, v43
    v_max_u32 v41, v42, v44
    v_min_u32 v44, v42, v44
    v_max_u32 v42, v45, v47
    v_min_u32 v47, v45, v47
    v_max_u32 v45, v48, v40
    v_min_u32 v40, v48, v40
    v_max_u32 v48, v42, v44
    v_min_u32 v44, v42, v44
    v_max_u32 v42, v46, v41
    v_min_u32 v41, v46, v41
    v_max_u32 v46, v43, v47
    v_min_u32 v47, v43, v47
    v_max_u32 v43, v45, v48
    v_min_u32 v48, v45, v48
    v_max_u32 v45, v40, v44
    v_min_u32 v44, v40, v44
    v_max_u32 v40, v43, v41
    v_min_u32 v41, v43, v41
    v_max_u32 v43, v46, v44
    v_min_u32 v44, v46, v44
    v_max_u32 v46, v45, v41
    v_min_u32 v41, v45, v41
    v_max_u32 v45, v43, v48
    v_min_u32 v48, v43, v48
    v_max_u32 v43, v45, v41
    v_min_u32 v41, v45, v41
    buffer_load_dword v73, v7, s[24:27], s38 offen sc1
    v_mov_b32 v87, v42
    s_nop 0
    v_max_u32_dpp v60, v47, v42 quad_perm:[1,0,3,2] row_mask:0xf bank_mask:0xf
    v_max_u32_dpp v64, v43, v41 quad_perm:[1,0,3,2] row_mask:0xf bank_mask:0xf
    v_max_u32_dpp v61, v44, v40 quad_perm:[1,0,3,2] row_mask:0xf bank_mask:0xf
    v_max_u32_dpp v65, v46, v48 quad_perm:[1,0,3,2] row_mask:0xf bank_mask:0xf
    v_max_u32_dpp v62, v48, v46 quad_perm:[1,0,3,2] row_mask:0xf bank_mask:0xf
    v_max_u32_dpp v66, v40, v44 quad_perm:[1,0,3,2] row_mask:0xf bank_mask:0xf
    v_max_u32_dpp v63, v41, v43 quad_perm:[1,0,3,2] row_mask:0xf bank_mask:0xf
    v_max_u32_dpp v67, v42, v47 quad_perm:[1,0,3,2] row_mask:0xf bank_mask:0xf
    v_med3_u32 v40, v60, v64, v80
    v_med3_u32 v41, v61, v65, v80
    v_med3_u32 v42, v62, v66, v80
    v_med3_u32 v43, v63, v67, v80
    v_max_u32 v44, v40, v42
    v_min_u32 v42, v40, v42
    v_max_u32 v40, v41, v43
    v_min_u32 v43, v41, v43
    v_max_u32 v41, v44, v40
    v_min_u32 v40, v44, v40
    v_max_u32 v44, v42, v43
    v_min_u32 v43, v42, v43
    s_nop 1
    v_max_u32_dpp v63, v41, v43 quad_perm:[3,2,1,0] row_mask:0xf bank_mask:0xf
    v_max_u32_dpp v62, v40, v44 quad_perm:[3,2,1,0] row_mask:0xf bank_mask:0xf
    v_max_u32_dpp v61, v44, v40 quad_perm:[3,2,1,0] row_mask:0xf bank_mask:0xf
    v_max_u32_dpp v60, v43, v41 quad_perm:[3,2,1,0] row_mask:0xf bank_mask:0xf
    v_mov_b32_dpp v67, v63 quad_perm:[1,0,3,2] row_mask:0xf bank_mask:0xf
    v_mov_b32_dpp v66, v62 quad_perm:[1,0,3,2] row_mask:0xf bank_mask:0xf
    v_mov_b32_dpp v65, v61 quad_perm:[1,0,3,2] row_mask:0xf bank_mask:0xf
    v_mov_b32_dpp v64, v60 quad_perm:[1,0,3,2] row_mask:0xf bank_mask:0xf
    v_med3_u32 v63, v63, v67, v80
    v_med3_u32 v61, v61, v65, v80
    v_med3_u32 v62, v62, v66, v80
    v_med3_u32 v60, v60, v64, v80
    v_med3_u32 v41, v61, v63, v81
    v_med3_u32 v40, v60, v62, v81
    v_max_u32 v42, v40, v41
    v_min_u32 v43, v40, v41
    s_nop 1
    v_max_u32_dpp v60, v43, v42 row_half_mirror row_mask:0xf bank_mask:0xf
    v_max_u32_dpp v61, v42, v43 row_half_mirror row_mask:0xf bank_mask:0xf
    s_nop 0
    v_mov_b32_dpp v62, v60 quad_perm:[1,0,3,2] row_mask:0xf bank_mask:0xf
    v_mov_b32_dpp v63, v61 quad_perm:[1,0,3,2] row_mask:0xf bank_mask:0xf
    v_med3_u32 v60, v60, v62, v80
    v_med3_u32 v61, v61, v63, v80
    s_nop 0
    v_mov_b32_dpp v62, v60 quad_perm:[2,3,0,1] row_mask:0xf bank_mask:0xf
    v_mov_b32_dpp v63, v61 quad_perm:[2,3,0,1] row_mask:0xf bank_mask:0xf
    v_med3_u32 v60, v60, v62, v81
    v_med3_u32 v61, v61, v63, v81
    v_med3_u32 v40, v60, v61, v82
    s_nop 1
    v_max_u32_dpp v41, v40, v40 row_mirror row_mask:0xf bank_mask:0xf
    s_nop 1
    v_mov_b32_dpp v42, v41 quad_perm:[1,0,3,2] row_mask:0xf bank_mask:0xf
    v_med3_u32 v41, v41, v42, v80
    s_nop 1
    v_mov_b32_dpp v42, v41 quad_perm:[2,3,0,1] row_mask:0xf bank_mask:0xf
    v_med3_u32 v41, v41, v42, v81
    s_nop 1
    v_max_u32_dpp v40, v41, v41 row_shl:4 row_mask:0xf bank_mask:0x5
    v_min_u32_dpp v40, v41, v41 row_shr:4 row_mask:0xf bank_mask:0xa
    s_nop 1
    v_mov_b32_dpp v42, v40 row_half_mirror row_mask:0xf bank_mask:0xf
    s_nop 1
    v_permlane16_swap_b32 v42, v43
    s_nop 1
    v_max_u32 v41, v40, v43
    s_nop 1
    v_mov_b32_dpp v42, v41 quad_perm:[1,0,3,2] row_mask:0xf bank_mask:0xf
    v_med3_u32 v41, v41, v42, v80
    s_nop 1
    v_mov_b32_dpp v42, v41 quad_perm:[2,3,0,1] row_mask:0xf bank_mask:0xf
    v_med3_u32 v41, v41, v42, v81
    s_nop 1
    v_max_u32_dpp v40, v41, v41 row_shl:4 row_mask:0xf bank_mask:0x5
    v_min_u32_dpp v40, v41, v41 row_shr:4 row_mask:0xf bank_mask:0xa
    s_nop 1
    v_mov_b32_dpp v42, v40 row_half_mirror row_mask:0xf bank_mask:0xf
    s_nop 1
    v_permlane32_swap_b32 v42, v43
    s_nop 1
    v_max_u32 v41, v40, v43
    v_bfe_u32 v44, v41, 5, 11
    v_mad_i32_i24 v44, v44, v86, s43
    v_sub_u32 v41, v41, v84
    ds_bpermute_b32 v26, v83, v44
    v_readlane_b32 s52, v44, 0
    v_readlane_b32 s53, v44, 1
    v_readlane_b32 s54, v44, 2
    v_readlane_b32 s55, v44, 3
    v_readlane_b32 s56, v44, 4
    v_readlane_b32 s57, v44, 5
    v_readlane_b32 s58, v44, 6
    v_readlane_b32 s59, v44, 7
    s_nop 1
    v_mov_b32_dpp v42, v41 quad_perm:[1,0,3,2] row_mask:0xf bank_mask:0xf
    v_med3_u32 v41, v41, v42, v80
    s_nop 1
    v_mov_b32_dpp v42, v41 quad_perm:[2,3,0,1] row_mask:0xf bank_mask:0xf
    v_med3_u32 v41, v41, v42, v81
    s_nop 1
    v_max_u32_dpp v40, v41, v41 row_shl:4 row_mask:0xf bank_mask:0x5
    v_min_u32_dpp v40, v41, v41 row_shr:4 row_mask:0xf bank_mask:0xa
    s_mov_b64 exec, 0xff
    ds_write_b32 v85, v40 offset:0
    s_mov_b64 exec, 1
    ds_add_u32 v248, v249 offset:192
    s_mov_b64 exec, -1
    v_readlane_b32 s42, v40, 7
    s_nop 3
    v_cmpx_le_u32 vcc, s42, v87
    s_mov_b32 s51, 0
phK_dfp:
    s_waitcnt vmcnt(0)
    v_cmpx_ne_u32 vcc, s65, v73
    s_cbranch_vccz phK_dfk
    buffer_load_dword v73, v7, s[24:27], s38 offen sc1
    s_add_u32 s51, s51, 1
    s_cmp_lt_u32 s51, 20000
    s_cbranch_scc1 phK_dfp
    s_waitcnt vmcnt(0)
phK_dfk:
    s_mov_b64 exec, -1
    s_cmp_lt_u32 s2, 112
    s_cbranch_scc1 phK_sp0
    buffer_load_dwordx4 v[100:103], v5, s[24:27], s52 offen
    buffer_load_dwordx4 v[104:107], v5, s[24:27], s53 offen
    buffer_load_dwordx4 v[108:111], v5, s[24:27], s54 offen
    buffer_load_dwordx4 v[112:115], v5, s[24:27], s55 offen
    buffer_load_dwordx4 v[116:119], v5, s[24:27], s56 offen
    buffer_load_dwordx4 v[120:123], v5, s[24:27], s57 offen
    buffer_load_dwordx4 v[124:127], v5, s[24:27], s58 offen
    buffer_load_dwordx4 v[128:131], v5, s[24:27], s59 offen
    s_waitcnt lgkmcnt(0)
    v_add_u32 v26, v26, v17
    buffer_load_dwordx4 v[28:31], v26, s[24:27], 0 offen
phK_sp0:
phK_spin:
    ds_read_b32 v26, v248 offset:192
    s_waitcnt lgkmcnt(0)
    v_readfirstlane_b32 s42, v26
    s_add_u32 s51, s51, 1
    s_lshr_b32 s50, s51, 22
    s_nop 1
    s_or_b32 s42, s42, s50
    s_cmp_lt_u32 s42, 4
    s_cbranch_scc1 phK_spin
    ds_read_b32 v40, v6 offset:0
    s_waitcnt lgkmcnt(0)
    v_max_u32_dpp v41, v40, v40 row_mirror row_mask:0xf bank_mask:0xf
    s_nop 1
    v_mov_b32_dpp v42, v41 quad_perm:[1,0,3,2] row_mask:0xf bank_mask:0xf
    v_med3_u32 v41, v41, v42, v80
    s_nop 1
    v_mov_b32_dpp v42, v41 quad_perm:[2,3,0,1] row_mask:0xf bank_mask:0xf
    v_med3_u32 v41, v41, v42, v81
    s_nop 1
    v_max_u32_dpp v40, v41, v41 row_shl:4 row_mask:0xf bank_mask:0x5
    v_min_u32_dpp v40, v41, v41 row_shr:4 row_mask:0xf bank_mask:0xa
    s_nop 1
    v_mov_b32_dpp v42, v40 row_half_mirror row_mask:0xf bank_mask:0xf
    s_nop 1
    v_permlane16_swap_b32 v42, v43
    s_nop 1
    v_max_u32 v41, v40, v43
    s_mov_b64 exec, 0xff
    v_and_b32 v42, 31, v41
    ds_write_b32 v6, v41 offset:256
    s_cmp_lt_u32 s2, 112
    s_cbranch_scc1 phK_b2
    v_mul_u32_u24 v42, 1168, v42
    v_sub_u32 v42, 46960, v42
    ds_write_b32 v6, v42 offset:128
    s_mov_b64 exec, -1
    s_waitcnt vmcnt(8)
    ds_write_b128 v18, v[100:103] offset:0
    s_waitcnt vmcnt(7)
    ds_write_b128 v18, v[104:107] offset:1168
    s_waitcnt vmcnt(6)
    ds_write_b128 v18, v[108:111] offset:2336
    s_waitcnt vmcnt(5)
    ds_write_b128 v18, v[112:115] offset:3504
    s_waitcnt vmcnt(4)
    ds_write_b128 v18, v[116:119] offset:4672
    s_waitcnt vmcnt(3)
    ds_write_b128 v18, v[120:123] offset:5840
    s_waitcnt vmcnt(2)
    ds_write_b128 v18, v[124:127] offset:7008
    s_waitcnt vmcnt(1)
    ds_write_b128 v18, v[128:131] offset:8176
    s_waitcnt vmcnt(0)
    ds_write_b128 v15, v[28:31]
phK_b2:
    s_mov_b64 exec, -1
    s_waitcnt lgkmcnt(0)
    s_barrier
    ds_read_b32 v50, v20 offset:256
    s_waitcnt lgkmcnt(0)
    v_bfe_u32 v50, v50, 5, 11
    v_cmp_eq_u32 vcc, s69, v50
    s_cbranch_vccz Ko_22
    s_ff1_i32_b64 s64, vcc
    v_lshlrev_b32 v216, 1, v5
    v_lshlrev_b32 v217, 1, v6
    s_mul_i32 s64, s64, 2304
    s_add_u32 s64, s64, 7340032
    buffer_store_dwordx4 v[200:203], v216, s[24:27], s64 offen sc1
    buffer_store_dwordx4 v[204:207], v216, s[24:27], s64 offen offset:16 sc1
    s_mov_b32 exec_hi, 0
    buffer_store_dwordx2 v[208:209], v217, s[24:27], s64 offen offset:2048 sc1
    s_mov_b32 exec_hi, -1
Ko_22:
    s_cmp_lg_u32 s64, 0
    s_cbranch_scc1 Ko_23
    buffer_store_dwordx4 v[210:213], v5, s[28:31], s61 offen sc1
    s_mov_b32 exec_hi, 0
    buffer_store_dword v214, v6, s[28:31], s61 offen offset:1024 sc1
    s_mov_b32 exec_hi, -1
Ko_23:
    s_cmp_lt_u32 s2, 112
    s_cbranch_scc1 phK_out
    v_lshlrev_b32 v26, 2, v0
    v_lshrrev_b32 v25, 5, v0
    v_lshl_add_u32 v26, v25, 4, v26
    v_lshlrev_b32 v25, 1, v0
    s_barrier
    ds_read2st64_b32 v[54:55], v26 offset0:2 offset1:7
    ds_read2st64_b32 v[56:57], v26 offset0:12 offset1:17
    ds_read2st64_b32 v[58:59], v26 offset0:22 offset1:27
    ds_read2st64_b32 v[60:61], v26 offset0:32 offset1:37
    s_waitcnt lgkmcnt(0)
    v_pk_add_f32 v[54:55], v[54:55], v[56:57]
    v_pk_add_f32 v[58:59], v[58:59], v[60:61]
    v_pk_add_f32 v[54:55], v[54:55], v[58:59]
    v_cvt_pk_bf16_f32 v54, v54, v54
    v_and_b32 v54, 0xffff0000, v54
    v_cvt_pk_bf16_f32 v55, v55, v55
    v_and_b32 v55, 0xffff0000, v55
    v_mul_f32 v56, 0xbfb8aa3b, v54
    v_exp_f32 v56, v56
    s_nop 0
    v_add_f32 v56, 1.0, v56
    v_rcp_f32 v56, v56
    s_nop 0
    v_mul_f32 v56, v54, v56
    v_cvt_pk_bf16_f32 v56, v56, v56
    v_and_b32 v56, 0xffff0000, v56
    v_mul_f32 v56, v56, v55
    v_cvt_pk_bf16_f32 v56, v56, v56
    ds_write_b16 v25, v56 offset:48128
    s_waitcnt lgkmcnt(0)
    s_barrier
phK_out:
    s_cmp_lg_u32 s60, 0
    s_cbranch_scc1 phK_fin
    v_lshlrev_b32 v50, 7, v1
    v_mov_b32 v52, 0
    v_mov_b32 v53, 0
    s_mov_b32 s42, 6963200
    s_mov_b32 exec_lo, -1
    s_mov_b32 exec_hi, 0x0
    buffer_store_dwordx2 v[52:53], v50, s[24:27], s42 offen sc1
    s_mov_b64 exec, -1
    s_branch phK_fin
phK_t4:
    s_cmp_eq_u32 s37, 0
    s_cbranch_scc1 phK_e
    v_lshrrev_b32 v7, 2, v3
    v_lshl_add_u32 v8, v4, 3, v7
    v_lshl_add_u32 v9, v4, 2, v7
    v_and_b32 v10, 3, v3
    v_lshlrev_b32 v10, 3, v10
    s_add_u32 s44, s40, 123392
    v_mul_u32_u24 v15, 288, v8
    v_add3_u32 v15, v15, v10, s44
    s_mul_i32 s44, s65, 0x85ebca6b
    v_mov_b32 v26, s44
    v_not_b32 v32, v26
    v_not_b32 v33, v26
    v_not_b32 v34, v26
    v_not_b32 v35, v26
    s_mov_b32 s48, 0x7060500
    s_mov_b32 s49, 0x7060501
    s_mov_b32 s50, 0x7060502
    s_mov_b32 s51, 0x7060503
    s_add_u32 s44, s40, 49664
    v_lshl_add_u32 v11, v8, 6, v10
    v_add_u32 v11, s44, v11
    v_lshl_add_u32 v14, v9, 6, v10
    v_add_u32 v14, s44, v14
    s_mul_i32 s44, s34, 288
    v_lshl_add_u32 v21, v4, 4, s44
    v_lshl_add_u32 v22, v4, 3, s44
    v_mul_u32_u24 v23, 144, v3
    v_lshl_add_u32 v23, v4, 4, v23
    s_mul_i32 s44, s34, 2560
    s_add_u32 s44, s44, 512
    v_add_u32 v23, s44, v23
    v_and_b32 v25, 7, v3
    v_lshlrev_b32 v25, 6, v25
    v_lshl_add_u32 v25, v4, 4, v25
    v_lshlrev_b32 v24, 6, v3
    v_lshl_add_u32 v24, v4, 4, v24
    s_mul_i32 s46, s36, 18432
    s_mul_i32 s44, s34, 4608
    s_add_u32 s46, s46, s44
    s_add_u32 s46, s46, 13697024
    s_add_u32 s47, s46, 4096
    v_cmp_lt_u32 s[52:53], 7, v3
    s_cmp_lg_u32 s59, 7
    s_cbranch_scc1 phK_w0f
    s_waitcnt vmcnt(2)
    s_branch phK_w1f
phK_w0f:
    s_waitcnt vmcnt(0)
phK_w1f:
    s_mov_b64 exec, 1
    ds_add_rtn_u32 v13, v248, v249 offset:204
    s_mov_b64 exec, 0xff
    s_waitcnt lgkmcnt(0)
    v_readfirstlane_b32 s59, v13
    s_nop 3
    s_cmp_lg_u32 s59, 7
    s_cbranch_scc1 phK_ndf
    buffer_store_dword v76, v12, s[24:27], s62 offen sc1
phK_ndf:
    s_mov_b64 exec, -1
Kw_24:
    s_memrealtime s[72:73]
    s_waitcnt lgkmcnt(0)
    s_sub_u32 s72, s72, s65
    s_cmp_ge_u32 s72, 948
    s_cbranch_scc1 Kx_25
    s_sleep 1
    s_branch Kw_24
Kx_25:
    s_add_u32 m0, s40, 123392
    s_nop 0
    buffer_load_dwordx4 v105, s[20:23], s42 offen lds
    s_add_u32 m0, s40, 124416
    s_nop 0
    buffer_load_dwordx4 v106, s[20:23], s42 offen lds
    s_add_u32 m0, s40, 125440
    s_nop 0
    buffer_load_dwordx4 v107, s[20:23], s42 offen lds
    s_add_u32 m0, s40, 126464
    s_nop 0
    buffer_load_dwordx4 v108, s[20:23], s42 offen lds
    s_add_u32 m0, s40, 127488
    s_nop 0
    buffer_load_dwordx4 v109, s[20:23], s42 offen lds
    s_add_u32 m0, s40, 128512
    s_nop 0
    buffer_load_dwordx4 v110, s[20:23], s42 offen lds
    s_add_u32 m0, s40, 129536
    s_nop 0
    buffer_load_dwordx4 v111, s[20:23], s42 offen lds
    s_add_u32 m0, s40, 130560
    s_nop 0
    buffer_load_dwordx4 v112, s[20:23], s42 offen lds
    s_add_u32 m0, s40, 131584
    s_nop 0
    buffer_load_dwordx4 v113, s[20:23], s42 offen lds
    s_waitcnt vmcnt(0)
    ds_read_b64_tr_b16 v[84:85], v11 offset:0
    ds_read_b64_tr_b16 v[86:87], v11 offset:256
    ds_read_b64_tr_b16 v[88:89], v11 offset:32
    ds_read_b64_tr_b16 v[90:91], v11 offset:288
    ds_read_b64_tr_b16 v[120:121], v11 offset:36864
    ds_read_b64_tr_b16 v[122:123], v11 offset:37120
    ds_read_b64_tr_b16 v[124:125], v11 offset:36896
    ds_read_b64_tr_b16 v[126:127], v11 offset:37152
    ds_read_b64_tr_b16 v[92:93], v11 offset:2048
    ds_read_b64_tr_b16 v[94:95], v11 offset:2304
    ds_read_b64_tr_b16 v[96:97], v11 offset:2080
    ds_read_b64_tr_b16 v[98:99], v11 offset:2336
    ds_read_b64_tr_b16 v[128:129], v11 offset:38912
    ds_read_b64_tr_b16 v[130:131], v11 offset:39168
    ds_read_b64_tr_b16 v[132:133], v11 offset:38944
    ds_read_b64_tr_b16 v[134:135], v11 offset:39200
    ds_read_b64_tr_b16 v[100:101], v11 offset:4096
    ds_read_b64_tr_b16 v[102:103], v11 offset:4352
    ds_read_b64_tr_b16 v[104:105], v11 offset:4128
    ds_read_b64_tr_b16 v[106:107], v11 offset:4384
    ds_read_b64_tr_b16 v[136:137], v11 offset:40960
    ds_read_b64_tr_b16 v[138:139], v11 offset:41216
    ds_read_b64_tr_b16 v[140:141], v11 offset:40992
    ds_read_b64_tr_b16 v[142:143], v11 offset:41248
    ds_read_b64_tr_b16 v[108:109], v11 offset:6144
    ds_read_b64_tr_b16 v[110:111], v11 offset:6400
    ds_read_b64_tr_b16 v[112:113], v11 offset:6176
    ds_read_b64_tr_b16 v[114:115], v11 offset:6432
    ds_read_b64_tr_b16 v[144:145], v11 offset:43008
    ds_read_b64_tr_b16 v[146:147], v11 offset:43264
    ds_read_b64_tr_b16 v[148:149], v11 offset:43040
    ds_read_b64_tr_b16 v[150:151], v11 offset:43296
    ds_read_b64_tr_b16 v[116:117], v14 offset:8192
    ds_read_b64_tr_b16 v[118:119], v14 offset:8224
    ds_read_b64_tr_b16 v[152:153], v14 offset:45056
    ds_read_b64_tr_b16 v[154:155], v14 offset:45088
    ds_read_b64_tr_b16 v[160:161], v15 offset:0
    ds_read_b64_tr_b16 v[162:163], v15 offset:1152
    ds_read_b64_tr_b16 v[164:165], v15 offset:32
    ds_read_b64_tr_b16 v[166:167], v15 offset:1184
    ds_read_b64_tr_b16 v[168:169], v15 offset:64
    ds_read_b64_tr_b16 v[170:171], v15 offset:1216
    ds_read_b64_tr_b16 v[172:173], v15 offset:96
    ds_read_b64_tr_b16 v[174:175], v15 offset:1248
    ds_read_b64_tr_b16 v[176:177], v15 offset:128
    ds_read_b64_tr_b16 v[178:179], v15 offset:1280
    ds_read_b64_tr_b16 v[180:181], v15 offset:160
    ds_read_b64_tr_b16 v[182:183], v15 offset:1312
    ds_read_b64_tr_b16 v[184:185], v15 offset:192
    ds_read_b64_tr_b16 v[186:187], v15 offset:1344
    ds_read_b64_tr_b16 v[188:189], v15 offset:224
    ds_read_b64_tr_b16 v[190:191], v15 offset:1376
    ds_read_b64_tr_b16 v[192:193], v15 offset:256
    ds_read_b64_tr_b16 v[194:195], v15 offset:1408
    s_waitcnt lgkmcnt(0) vmcnt(0)
    s_barrier
    ds_read_b32 v40, v20 offset:128
    ds_read_b32 v41, v20 offset:256
    s_waitcnt lgkmcnt(1)
    v_add_u32 v21, v21, v40
    v_add_u32 v22, v22, v40
    ds_read_b128 v[44:47], v21 offset:0
    ds_read_b128 v[48:51], v21 offset:64
    ds_read_b128 v[52:55], v21 offset:128
    ds_read_b128 v[56:59], v21 offset:192
    ds_read_b64 v[60:61], v22 offset:256
    s_waitcnt lgkmcnt(4)
    v_mfma_f32_16x16x32_bf16 v[64:67], v[84:87], v[44:47], 0
    v_mfma_f32_16x16x32_bf16 v[68:71], v[88:91], v[44:47], 0
    v_mfma_f32_16x16x32_bf16 v[72:75], v[120:123], v[44:47], 0
    v_mfma_f32_16x16x32_bf16 v[76:79], v[124:127], v[44:47], 0
    s_waitcnt lgkmcnt(3)
    v_mfma_f32_16x16x32_bf16 v[64:67], v[92:95], v[48:51], v[64:67]
    v_mfma_f32_16x16x32_bf16 v[68:71], v[96:99], v[48:51], v[68:71]
    v_mfma_f32_16x16x32_bf16 v[72:75], v[128:131], v[48:51], v[72:75]
    v_mfma_f32_16x16x32_bf16 v[76:79], v[132:135], v[48:51], v[76:79]
    s_waitcnt lgkmcnt(2)
    v_mfma_f32_16x16x32_bf16 v[64:67], v[100:103], v[52:55], v[64:67]
    v_mfma_f32_16x16x32_bf16 v[68:71], v[104:107], v[52:55], v[68:71]
    v_mfma_f32_16x16x32_bf16 v[72:75], v[136:139], v[52:55], v[72:75]
    v_mfma_f32_16x16x32_bf16 v[76:79], v[140:143], v[52:55], v[76:79]
    s_waitcnt lgkmcnt(1)
    v_mfma_f32_16x16x32_bf16 v[64:67], v[108:111], v[56:59], v[64:67]
    v_mfma_f32_16x16x32_bf16 v[68:71], v[112:115], v[56:59], v[68:71]
    v_mfma_f32_16x16x32_bf16 v[72:75], v[144:147], v[56:59], v[72:75]
    v_mfma_f32_16x16x32_bf16 v[76:79], v[148:151], v[56:59], v[76:79]
    s_waitcnt lgkmcnt(0)
    v_mfma_f32_16x16x16_bf16 v[64:67], v[116:117], v[60:61], v[64:67]
    v_mfma_f32_16x16x16_bf16 v[68:71], v[118:119], v[60:61], v[68:71]
    v_mfma_f32_16x16x16_bf16 v[72:75], v[152:153], v[60:61], v[72:75]
    v_mfma_f32_16x16x16_bf16 v[76:79], v[154:155], v[60:61], v[76:79]
    s_mov_b32 exec_lo, 0x00ff00ff
    s_mov_b32 exec_hi, 0x00ff00ff
    s_nop 3
    ds_write_b128 v23, v[64:67] offset:0
    ds_write_b128 v23, v[68:71] offset:64
    ds_write_b128 v23, v[72:75] offset:1280
    s_nop 3
    ds_write_b128 v23, v[76:79] offset:1344
    s_mov_b64 exec, -1
    s_waitcnt lgkmcnt(0)
    s_barrier
    v_bfe_u32 v41, v41, 5, 11
    v_cmp_eq_u32 vcc, s69, v41
    s_cbranch_vccz Ko_26
    s_ff1_i32_b64 s64, vcc
    v_lshlrev_b32 v216, 1, v5
    v_lshlrev_b32 v217, 1, v6
    s_mul_i32 s64, s64, 2304
    s_add_u32 s64, s64, 7340032
    buffer_store_dwordx4 v[200:203], v216, s[24:27], s64 offen sc1
    buffer_store_dwordx4 v[204:207], v216, s[24:27], s64 offen offset:16 sc1
    s_mov_b32 exec_hi, 0
    buffer_store_dwordx2 v[208:209], v217, s[24:27], s64 offen offset:2048 sc1
    s_mov_b32 exec_hi, -1
Ko_26:
    s_barrier
    ds_read_b128 v[96:99], v25 offset:48128
    s_waitcnt lgkmcnt(0)
    v_mfma_f32_16x16x32_bf16 v[48:51], v[160:163], v[96:99], 0
    v_mfma_f32_16x16x32_bf16 v[52:55], v[164:167], v[96:99], 0
    v_mfma_f32_16x16x32_bf16 v[56:59], v[168:171], v[96:99], 0
    v_mfma_f32_16x16x32_bf16 v[60:63], v[172:175], v[96:99], 0
    v_mfma_f32_16x16x32_bf16 v[64:67], v[176:179], v[96:99], 0
    v_mfma_f32_16x16x32_bf16 v[68:71], v[180:183], v[96:99], 0
    v_mfma_f32_16x16x32_bf16 v[72:75], v[184:187], v[96:99], 0
    v_mfma_f32_16x16x32_bf16 v[76:79], v[188:191], v[96:99], 0
    v_mfma_f32_16x16x32_bf16 v[80:83], v[192:195], v[96:99], 0
    v_cndmask_b32 v48, v48, v52, s[52:53]
    v_cndmask_b32 v49, v49, v53, s[52:53]
    v_cndmask_b32 v50, v50, v54, s[52:53]
    v_cndmask_b32 v51, v51, v55, s[52:53]
    v_perm_b32 v48, v48, v26, s48
    v_perm_b32 v49, v49, v26, s49
    v_perm_b32 v50, v50, v26, s50
    v_perm_b32 v51, v51, v26, s51
    buffer_store_dwordx4 v[48:51], v24, s[24:27], s46 offen offset:0 sc1
    v_cndmask_b32 v56, v56, v60, s[52:53]
    v_cndmask_b32 v57, v57, v61, s[52:53]
    v_cndmask_b32 v58, v58, v62, s[52:53]
    v_cndmask_b32 v59, v59, v63, s[52:53]
    v_perm_b32 v56, v56, v26, s48
    v_perm_b32 v57, v57, v26, s49
    v_perm_b32 v58, v58, v26, s50
    v_perm_b32 v59, v59, v26, s51
    buffer_store_dwordx4 v[56:59], v24, s[24:27], s46 offen offset:1024 sc1
    v_cndmask_b32 v64, v64, v68, s[52:53]
    v_cndmask_b32 v65, v65, v69, s[52:53]
    v_cndmask_b32 v66, v66, v70, s[52:53]
    v_cndmask_b32 v67, v67, v71, s[52:53]
    v_perm_b32 v64, v64, v26, s48
    v_perm_b32 v65, v65, v26, s49
    v_perm_b32 v66, v66, v26, s50
    v_perm_b32 v67, v67, v26, s51
    buffer_store_dwordx4 v[64:67], v24, s[24:27], s46 offen offset:2048 sc1
    s_nop 1
    v_cndmask_b32 v72, v72, v76, s[52:53]
    v_cndmask_b32 v73, v73, v77, s[52:53]
    v_cndmask_b32 v74, v74, v78, s[52:53]
    v_cndmask_b32 v75, v75, v79, s[52:53]
    v_perm_b32 v72, v72, v26, s48
    v_perm_b32 v73, v73, v26, s49
    v_perm_b32 v74, v74, v26, s50
    v_perm_b32 v75, v75, v26, s51
    buffer_store_dwordx4 v[72:75], v24, s[24:27], s46 offen offset:3072 sc1
    s_mov_b32 exec_lo, 0x00ff00ff
    s_mov_b32 exec_hi, 0x00ff00ff
    v_perm_b32 v80, v80, v26, s48
    v_perm_b32 v81, v81, v26, s49
    v_perm_b32 v82, v82, v26, s50
    v_perm_b32 v83, v83, v26, s51
    buffer_store_dwordx4 v[80:83], v24, s[24:27], s47 offen sc1
    s_mov_b64 exec, -1
    s_cmp_lg_u32 s64, 0
    s_cbranch_scc1 Ko_27
    buffer_store_dwordx4 v[210:213], v5, s[28:31], s61 offen sc1
    s_mov_b32 exec_hi, 0
    buffer_store_dword v214, v6, s[28:31], s61 offen offset:1024 sc1
    s_mov_b32 exec_hi, -1
Ko_27:
    s_branch phK_fin
phK_e:
    v_subrev_u32 v29, 256, v0
    v_lshlrev_b32 v30, 4, v29
    v_lshrrev_b32 v2, 4, v29
    v_mul_u32_u24 v7, 165888, v2
    v_lshl_add_u32 v7, v3, 4, v7
    s_lshl_b32 s40, s2, 8
    s_add_u32 s40, s40, 13697024
    s_and_b32 s41, s2, 1
    s_lshl_b32 s41, s41, 2
    v_add_u32 v9, s41, v4
    v_lshlrev_b32 v8, 2, v9
    v_mul_u32_u24 v9, 2304, v9
    v_lshrrev_b32 v10, 1, v3
    v_lshl_add_u32 v9, v10, 3, v9
    s_lshr_b32 s42, s2, 1
    s_lshl_b32 s43, s42, 6
    s_add_u32 s43, s43, 7340032
    v_and_b32 v10, 1, v3
    v_lshlrev_b32 v10, 4, v10
    s_mul_i32 s49, s65, 0x85ebca6b
    s_and_b32 s46, s49, 0xff
    s_bfe_u32 s47, s49, 0x80008
    s_bfe_u32 s48, s49, 0x80010
    s_lshr_b32 s49, s49, 24
    v_mov_b32 v50, 0
    s_cmp_lg_u32 s59, 7
    s_cbranch_scc1 phK_w0e
    s_waitcnt vmcnt(2)
    s_branch phK_w1e
phK_w0e:
    s_waitcnt vmcnt(0)
phK_w1e:
    s_mov_b64 exec, 1
    ds_add_rtn_u32 v13, v248, v249 offset:204
    s_mov_b64 exec, 0xff
    s_waitcnt lgkmcnt(0)
    v_readfirstlane_b32 s59, v13
    s_nop 3
    s_cmp_lg_u32 s59, 7
    s_cbranch_scc1 phK_nde
    buffer_store_dword v76, v12, s[24:27], s62 offen sc1
phK_nde:
    s_mov_b64 exec, -1
    s_add_u32 s50, s40, 0
    s_add_u32 s51, s40, 18432
    s_add_u32 s52, s40, 36864
    s_add_u32 s53, s40, 55296
    s_add_u32 s54, s40, 73728
    s_add_u32 s55, s40, 92160
    s_add_u32 s56, s40, 110592
    s_add_u32 s57, s40, 129024
    s_add_u32 s58, s40, 147456
    s_barrier
    ds_read_b32 v41, v20 offset:256
    ds_read_b32 v40, v8 offset:256
    s_waitcnt lgkmcnt(1)
    v_bfe_u32 v41, v41, 5, 11
    v_cmp_eq_u32 vcc, s69, v41
    s_cbranch_vccz Ko_28
    s_ff1_i32_b64 s64, vcc
    v_lshlrev_b32 v216, 1, v5
    v_lshlrev_b32 v217, 1, v6
    s_mul_i32 s64, s64, 2304
    s_add_u32 s64, s64, 7340032
    buffer_store_dwordx4 v[200:203], v216, s[24:27], s64 offen sc1
    buffer_store_dwordx4 v[204:207], v216, s[24:27], s64 offen offset:16 sc1
    s_mov_b32 exec_hi, 0
    buffer_store_dwordx2 v[208:209], v217, s[24:27], s64 offen offset:2048 sc1
    s_mov_b32 exec_hi, -1
Ko_28:
    s_cmp_lg_u32 s64, 0
    s_cbranch_scc1 Ko_29
    buffer_store_dwordx4 v[210:213], v5, s[28:31], s61 offen sc1
    s_mov_b32 exec_hi, 0
    buffer_store_dword v214, v6, s[28:31], s61 offen offset:1024 sc1
    s_mov_b32 exec_hi, -1
Ko_29:
    s_cmp_ge_u32 s2, 72
    s_cbranch_scc1 phK_fin
    s_sleep 12
    s_cmp_lg_u32 s34, 0
    s_cbranch_scc1 phK_e2
    s_waitcnt lgkmcnt(0)
    v_bfe_u32 v50, v40, 5, 11
    v_sub_u32 v50, 0x7ff, v50
    v_mul_u32_u24 v50, 1152, v50
    v_lshl_add_u32 v50, v3, 1, v50
    s_lshl_b32 s42, s42, 5
    v_add_u32 v50, s42, v50
    s_mov_b32 s45, 9699328
    buffer_load_ushort v52, v50, s[24:27], s45 offen sc1
    s_mov_b32 s59, 0
    v_lshrrev_b32 v54, 16, v40
    v_and_b32 v55, 0x7fff, v54
    v_not_b32 v56, v54
    v_and_b32 v56, 0xffff, v56
    v_cmp_lt_u32 vcc, 0x7fff, v54
    v_cndmask_b32 v54, v56, v55, vcc
    v_lshlrev_b32 v54, 16, v54
    v_mul_f32 v54, 0xbfb8aa3b, v54
    v_exp_f32 v54, v54
    s_nop 0
    v_add_f32 v54, 1.0, v54
    v_rcp_f32 v54, v54
    s_nop 0
    v_cvt_pk_bf16_f32 v54, v54, v54
    v_and_b32 v54, 0xffff0000, v54
    s_branch phK_e3
phK_e2:
phK_e3:
    v_lshlrev_b32 v104, 2, v29
    v_add_u32 v104, 49664, v104
Kw_30:
    s_memrealtime s[72:73]
    s_waitcnt lgkmcnt(0)
    s_sub_u32 s72, s72, s65
    s_cmp_ge_u32 s72, 1202
    s_cbranch_scc1 Kx_31
    s_sleep 1
    s_branch Kw_30
Kx_31:
    s_mov_b32 s59, 0
phK_epoll:
    buffer_load_dwordx2 v[58:59], v9, s[24:27], s43 offen sc1
    buffer_load_dwordx4 v[64:67], v7, s[24:27], s50 offen sc1
    buffer_load_dwordx4 v[68:71], v7, s[24:27], s51 offen sc1
    buffer_load_dwordx4 v[72:75], v7, s[24:27], s52 offen sc1
    buffer_load_dwordx4 v[76:79], v7, s[24:27], s53 offen sc1
    buffer_load_dwordx4 v[80:83], v7, s[24:27], s54 offen sc1
    buffer_load_dwordx4 v[84:87], v7, s[24:27], s55 offen sc1
    buffer_load_dwordx4 v[88:91], v7, s[24:27], s56 offen sc1
    buffer_load_dwordx4 v[92:95], v7, s[24:27], s57 offen sc1
    buffer_load_dwordx4 v[96:99], v7, s[24:27], s58 offen sc1
    s_add_u32 s59, s59, 1
    s_waitcnt vmcnt(8)
    v_xor_b32 v64, s46, v64
    v_xor_b32 v65, s47, v65
    v_xor_b32 v66, s48, v66
    v_xor_b32 v67, s49, v67
    v_xor_b32 v62, s65, v59
    v_or_b32 v60, v64, v65
    v_or_b32 v61, v66, v67
    s_waitcnt vmcnt(7)
    v_xor_b32 v68, s46, v68
    v_xor_b32 v69, s47, v69
    v_xor_b32 v70, s48, v70
    v_xor_b32 v71, s49, v71
    v_or3_b32 v60, v60, v68, v69
    v_or3_b32 v61, v61, v70, v71
    v_pk_add_f32 v[100:101], v[64:65], v[68:69]
    v_pk_add_f32 v[102:103], v[66:67], v[70:71]
    s_waitcnt vmcnt(6)
    v_xor_b32 v72, s46, v72
    v_xor_b32 v73, s47, v73
    v_xor_b32 v74, s48, v74
    v_xor_b32 v75, s49, v75
    v_or3_b32 v60, v60, v72, v73
    v_or3_b32 v61, v61, v74, v75
    v_pk_add_f32 v[100:101], v[100:101], v[72:73]
    v_pk_add_f32 v[102:103], v[102:103], v[74:75]
    s_waitcnt vmcnt(5)
    v_xor_b32 v76, s46, v76
    v_xor_b32 v77, s47, v77
    v_xor_b32 v78, s48, v78
    v_xor_b32 v79, s49, v79
    v_or3_b32 v60, v60, v76, v77
    v_or3_b32 v61, v61, v78, v79
    v_pk_add_f32 v[100:101], v[100:101], v[76:77]
    v_pk_add_f32 v[102:103], v[102:103], v[78:79]
    s_waitcnt vmcnt(4)
    v_xor_b32 v80, s46, v80
    v_xor_b32 v81, s47, v81
    v_xor_b32 v82, s48, v82
    v_xor_b32 v83, s49, v83
    v_or3_b32 v60, v60, v80, v81
    v_or3_b32 v61, v61, v82, v83
    v_pk_add_f32 v[100:101], v[100:101], v[80:81]
    v_pk_add_f32 v[102:103], v[102:103], v[82:83]
    s_waitcnt vmcnt(3)
    v_xor_b32 v84, s46, v84
    v_xor_b32 v85, s47, v85
    v_xor_b32 v86, s48, v86
    v_xor_b32 v87, s49, v87
    v_or3_b32 v60, v60, v84, v85
    v_or3_b32 v61, v61, v86, v87
    v_pk_add_f32 v[100:101], v[100:101], v[84:85]
    v_pk_add_f32 v[102:103], v[102:103], v[86:87]
    s_waitcnt vmcnt(2)
    v_xor_b32 v88, s46, v88
    v_xor_b32 v89, s47, v89
    v_xor_b32 v90, s48, v90
    v_xor_b32 v91, s49, v91
    v_or3_b32 v60, v60, v88, v89
    v_or3_b32 v61, v61, v90, v91
    v_pk_add_f32 v[100:101], v[100:101], v[88:89]
    v_pk_add_f32 v[102:103], v[102:103], v[90:91]
    s_waitcnt vmcnt(1)
    v_xor_b32 v92, s46, v92
    v_xor_b32 v93, s47, v93
    v_xor_b32 v94, s48, v94
    v_xor_b32 v95, s49, v95
    v_or3_b32 v60, v60, v92, v93
    v_or3_b32 v61, v61, v94, v95
    v_pk_add_f32 v[100:101], v[100:101], v[92:93]
    v_pk_add_f32 v[102:103], v[102:103], v[94:95]
    s_waitcnt vmcnt(0)
    v_xor_b32 v96, s46, v96
    v_xor_b32 v97, s47, v97
    v_xor_b32 v98, s48, v98
    v_xor_b32 v99, s49, v99
    v_or3_b32 v60, v60, v96, v97
    v_or3_b32 v61, v61, v98, v99
    v_pk_add_f32 v[100:101], v[100:101], v[96:97]
    v_pk_add_f32 v[102:103], v[102:103], v[98:99]
    ds_write_b128 v30, v[100:103] offset:49664
    v_or_b32 v60, v60, v61
    v_lshl_or_b32 v60, v60, 24, v62
    v_cmpx_ne_u32 vcc, 0, v60
    s_cbranch_vccz phK_epok
    s_sleep 2
    s_cmp_lt_u32 s59, 20000
    s_cbranch_scc1 phK_epoll
phK_epok:
    s_mov_b64 exec, -1
    s_waitcnt lgkmcnt(0)
    s_barrier
    s_cmp_lg_u32 s34, 0
    s_cbranch_scc1 phK_fin
    ds_read2st64_b32 v[12:13], v104 offset0:0 offset1:1
    ds_read2st64_b32 v[14:15], v104 offset0:2 offset1:3
    ds_read2st64_b32 v[16:17], v104 offset0:4 offset1:5
    ds_read2st64_b32 v[18:19], v104 offset0:6 offset1:7
    ds_read2st64_b32 v[20:21], v104 offset0:8 offset1:9
    ds_read2st64_b32 v[22:23], v104 offset0:10 offset1:11
    ds_read2st64_b32 v[24:25], v104 offset0:12 offset1:13
    ds_read2st64_b32 v[26:27], v104 offset0:14 offset1:15
    v_lshrrev_b32 v53, v10, v58
    v_lshlrev_b32 v52, 16, v52
    v_lshlrev_b32 v53, 16, v53
    s_waitcnt lgkmcnt(0)
    v_pk_add_f32 v[12:13], v[12:13], v[20:21]
    v_pk_add_f32 v[14:15], v[14:15], v[22:23]
    v_pk_add_f32 v[16:17], v[16:17], v[24:25]
    v_pk_add_f32 v[18:19], v[18:19], v[26:27]
    v_pk_add_f32 v[12:13], v[12:13], v[16:17]
    v_pk_add_f32 v[14:15], v[14:15], v[18:19]
    v_pk_add_f32 v[12:13], v[12:13], v[14:15]
    v_add_f32 v8, v12, v13
    v_cvt_pk_bf16_f32 v8, v8, v8
    v_and_b32 v8, 0xffff0000, v8
    v_mul_f32 v8, v8, v54
    v_cvt_pk_bf16_f32 v8, v8, v8
    v_and_b32 v8, 0xffff0000, v8
    v_add_f32 v8, v8, v52
    v_cvt_pk_bf16_f32 v8, v8, v8
    v_and_b32 v8, 0xffff0000, v8
    v_add_f32 v8, v8, v53
    v_cvt_pk_bf16_f32 v8, v8, v8
    buffer_store_short v8, v50, s[28:31], 0 offen sc1
phK_fin:
phK_end:
    s_endpgm
.p2align 8
.type tblS,@object
tblS:
.long 0x3f800000,0x3f800000,0x3f800000,0x3f800000,0x3f800000,0x3f7ffc1a,0x3f7ff067,0x3f7fdce9
.long 0x3f800000,0x3f7ff067,0x3f7fc1a0,0x3f7f73af,0x3f800000,0x3f7fdce9,0x3f7f73af,0x3f7ec46d
.long 0x3f800000,0x3f7fc1a0,0x3f7f069e,0x3f7dcf55,0x3f800000,0x3f7f9e8c,0x3f7e7a7a,0x3f7c94a8
.long 0x3f800000,0x3f7f73af,0x3f7dcf55,0x3f7b14be,0x3f800000,0x3f7f4109,0x3f7d0543,0x3f795000
.long 0x3f800000,0x3f7f069e,0x3f7c1c5c,0x3f7746ea,0x3f800000,0x3f7ec46d,0x3f7b14be,0x3f74fa0b
.long 0x3f800000,0x3f7e7a7a,0x3f79ee89,0x3f726a03,0x3f800000,0x3f7e28c6,0x3f78a9e0,0x3f6f9788
.long 0x3f800000,0x3f7dcf55,0x3f7746ea,0x3f6c835e,0x3f800000,0x3f7d6e28,0x3f75c5d4,0x3f692e5f
.long 0x3f800000,0x3f7d0543,0x3f7426cb,0x3f659974,0x3f800000,0x3f7c94a8,0x3f726a03,0x3f61c598
.long 0x3f800000,0x3f800000,0x3f800000,0x3f800000,0x3f7f069e,0x3f7ec46d,0x3f7e7a7a,0x3f7e28c6
.long 0x3f7c1c5c,0x3f7b14be,0x3f79ee89,0x3f78a9e0,0x3f7746ea,0x3f74fa0b,0x3f726a03,0x3f6f9788
.long 0x3f708fb2,0x3f6c835e,0x3f6803ca,0x3f631324,0x3f6803ca,0x3f61c598,0x3f5adb81,0x3f534aca
.long 0x3f5db3d7,0x3f54db31,0x3f4b1934,0x3f407893,0x3f51b3f3,0x3f45e403,0x3f38ecd8,0x3f2ae1c9
.long 0x3f441b7d,0x3f3504f3,0x3f248dbb,0x3f12d5e8,0x3f3504f3,0x3f226799,0x3f0e39da,0x3ef15aea
.long 0x3f248dbb,0x3f0e39da,0x3eec6a50,0x3eb9917b,0x3f12d5e8,0x3ef15aea,0x3eb9917b,0x3e7e39c4
.long 0x3f000000,0x3ec3ef15,0x3e8483ee,0x3e05a8a8,0x3ed8616c,0x3e94a031,0x3e1bc63c,0x3c32b7da
.long 0x3eaf1d44,0x3e47c5c2,0x3d32aa3e,0xbddef599,0x3e8483ee,0x3dc8bd36,0xbd85f213,0xbe6886ae
.long 0x3f800000,0x3f800000,0x3f800000,0x3f800000,0x3f7c1c5c,0x3f7b9c62,0x3f7b14be,0x3f7a8575
.long 0x3f708fb2,0x3f6e9811,0x3f6c835e,0x3f6a51da,0x3f5db3d7,0x3f596550,0x3f54db31,0x3f5016b8
.long 0x3f441b7d,0x3f3cbe35,0x3f3504f3,0x3f2cf37b,0x3f248dbb,0x3f199e45,0x3f0e39da,0x3f026926
.long 0x3f000000,0x3ee273aa,0x3ec3ef15,0x3ea493b7,0x3eaf1d44,0x3e89e6f1,0x3e47c5c2,0x3df52731
.long 0x3e31d0d4,0x3db27eb6,0x248d3132,0xbdb27eb6,0x248d3132,0xbdc8bd36,0xbe47c5c2,0xbe94a031
.long 0xbe31d0d4,0xbe8f45c0,0xbec3ef15,0xbef64429,0xbeaf1d44,0xbee77284,0xbf0e39da,0xbf26aed9
.long 0xbf000000,0xbf1bd7ca,0xbf3504f3,0xbf4b1934,0xbf248dbb,0xbf3e9e4b,0xbf54db31,0xbf66d223
.long 0xbf441b7d,0xbf5adb81,0xbf6c835e,0xbf78a9e0,0xbf5db3d7,0xbf6f9788,0xbf7b14be,0xbf7fdce9
.long 0x3f800000,0x3f800000,0x3f800000,0x3f800000,0x3f7746ea,0x3f768a20,0x3f75c5d4,0x3f74fa0b
.long 0x3f5db3d7,0x3f5adb81,0x3f57e880,0x3f54db31,0x3f3504f3,0x3f2effe8,0x3f28cae3,0x3f226799
.long 0x3f000000,0x3eec6a50,0x3ed8616c,0x3ec3ef15,0x3e8483ee,0x3e52b743,0x3e1bc63c,0x3dc8bd36
.long 0x248d3132,0xbd85f213,0xbe05a8a8,0xbe47c5c2,0xbe8483ee,0xbea9db13,0xbece34d0,0xbef15aea
.long 0xbf000000,0xbf12d5e8,0xbf248dbb,0xbf3504f3,0xbf3504f3,0xbf45e403,0xbf54db31,0xbf61c598
.long 0xbf5db3d7,0xbf6a51da,0xbf7426cb,0xbf7b14be,0xbf7746ea,0xbf7d6e28,0xbf7ff067,0xbf7ec46d
.long 0xbf800000,0xbf7dcf55,0xbf7746ea,0xbf6c835e,0xbf7746ea,0xbf6b6e32,0xbf5adb81,0xbf45e403
.long 0xbf5db3d7,0xbf47a682,0xbf2cf37b,0xbf0e39da,0xbf3504f3,0xbf151d42,0xbee273aa,0xbe94a031
.long 0x0,0x0,0x0,0x0,0x0,0x3c32b7da,0x3cb2b521,0x3d060472
.long 0x0,0x3cb2b521,0x3d32aa3e,0x3d85f213,0x0,0x3d060472,0x3d85f213,0x3dc8bd36
.long 0x0,0x3d32aa3e,0x3db27eb6,0x3e05a8a8,0x0,0x3d5f4a99,0x3ddef599,0x3e26ce12
.long 0x0,0x3d85f213,0x3e05a8a8,0x3e47c5c2,0x0,0x3d9c3ac6,0x3e1bc63c,0x3e6886ae
.long 0x0,0x3db27eb6,0x3e31d0d4,0x3e8483ee,0x0,0x3dc8bd36,0x3e47c5c2,0x3e94a031
.long 0x0,0x3ddef599,0x3e5da259,0x3ea493b7,0x0,0x3df52731,0x3e7363ee,0x3eb45a1e
.long 0x0,0x3e05a8a8,0x3e8483ee,0x3ec3ef15,0x0,0x3e10b9a6,0x3e8f45c0,0x3ed34e56
.long 0x0,0x3e1bc63c,0x3e99f61c,0x3ee273aa,0x0,0x3e26ce12,0x3ea493b7,0x3ef15aea
.long 0x0,0x0,0x0,0x0,0x3db27eb6,0x3dc8bd36,0x3ddef599,0x3df52731
.long 0x3e31d0d4,0x3e47c5c2,0x3e5da259,0x3e7363ee,0x3e8483ee,0x3e94a031,0x3ea493b7,0x3eb45a1e
.long 0x3eaf1d44,0x3ec3ef15,0x3ed8616c,0x3eec6a50,0x3ed8616c,0x3ef15aea,0x3f04ce53,0x3f108a14
.long 0x3f000000,0x3f0e39da,0x3f1bd7ca,0x3f28cae3,0x3f12d5e8,0x3f226799,0x3f310700,0x3f3e9e4b
.long 0x3f248dbb,0x3f3504f3,0x3f441b7d,0x3f51b3f3,0x3f3504f3,0x3f45e403,0x3f54db31,0x3f61c598
.long 0x3f441b7d,0x3f54db31,0x3f631324,0x3f6e9811,0x3f51b3f3,0x3f61c598,0x3f6e9811,0x3f77fc2c
.long 0x3f5db3d7,0x3f6c835e,0x3f7746ea,0x3f7dcf55,0x3f6803ca,0x3f74fa0b,0x3f7d0543,0x3f7ffc1a
.long 0x3f708fb2,0x3f7b14be,0x3f7fc1a0,0x3f7e7a7a,0x3f7746ea,0x3f7ec46d,0x3f7f73af,0x3f795000
.long 0x0,0x0,0x0,0x0,0x3e31d0d4,0x3e3cce2b,0x3e47c5c2,0x3e52b743
.long 0x3eaf1d44,0x3eb9917b,0x3ec3ef15,0x3ece34d0,0x3f000000,0x3f072f74,0x3f0e39da,0x3f151d42
.long 0x3f248dbb,0x3f2cf37b,0x3f3504f3,0x3f3cbe35,0x3f441b7d,0x3f4cc94c,0x3f54db31,0x3f5c4b07
.long 0x3f5db3d7,0x3f659974,0x3f6c835e,0x3f726a03,0x3f708fb2,0x3f768a20,0x3f7b14be,0x3f7e28c6
.long 0x3f7c1c5c,0x3f7f069e,0x3f800000,0x3f7f069e,0x3f800000,0x3f7ec46d,0x3f7b14be,0x3f74fa0b
.long 0x3f7c1c5c,0x3f75c5d4,0x3f6c835e,0x3f60712a,0x3f708fb2,0x3f6459c6,0x3f54db31,0x3f424cfe
.long 0x3f5db3d7,0x3f4b1934,0x3f3504f3,0x3f1bd7ca,0x3f441b7d,0x3f2ae1c9,0x3f0e39da,0x3edd6dea
.long 0x3f248dbb,0x3f04ce53,0x3ec3ef15,0x3e7363ee,0x3f000000,0x3eb45a1e,0x3e47c5c2,0x3d060472
.long 0x0,0x0,0x0,0x0,0x3e8483ee,0x3e89e6f1,0x3e8f45c0,0x3e94a031
.long 0x3f000000,0x3f04ce53,0x3f098c78,0x3f0e39da,0x3f3504f3,0x3f3ad85f,0x3f407893,0x3f45e403
.long 0x3f5db3d7,0x3f631324,0x3f6803ca,0x3f6c835e,0x3f7746ea,0x3f7a8575,0x3f7d0543,0x3f7ec46d
.long 0x3f800000,0x3f7f73af,0x3f7dcf55,0x3f7b14be,0x3f7746ea,0x3f718088,0x3f6a51da,0x3f61c598
.long 0x3f5db3d7,0x3f51b3f3,0x3f441b7d,0x3f3504f3,0x3f3504f3,0x3f226799,0x3f0e39da,0x3ef15aea
.long 0x3f000000,0x3ece34d0,0x3e99f61c,0x3e47c5c2,0x3e8483ee,0x3e10b9a6,0x3cb2b521,0xbdc8bd36
.long 0x250d3132,0xbe05a8a8,0xbe8483ee,0xbec3ef15,0xbe8483ee,0xbec91503,0xbf04ce53,0xbf226799
.long 0xbf000000,0xbf203c85,0xbf3cbe35,0xbf54db31,0xbf3504f3,0xbf5016b8,0xbf659974,0xbf74fa0b
.long 0x3f800000,0x3f800000,0x3f800000,0x3f800000,0x3f7fc1a0,0x3f7f9e8c,0x3f7f73af,0x3f7f4109
.long 0x3f7f069e,0x3f7e7a7a,0x3f7dcf55,0x3f7d0543,0x3f7dcf55,0x3f7c94a8,0x3f7b14be,0x3f795000
.long 0x3f7c1c5c,0x3f79ee89,0x3f7746ea,0x3f7426cb,0x3f79ee89,0x3f768a20,0x3f726a03,0x3f6d9156
.long 0x3f7746ea,0x3f726a03,0x3f6c835e,0x3f659974,0x3f7426cb,0x3f6d9156,0x3f659974,0x3f5c4b07
.long 0x3f708fb2,0x3f6803ca,0x3f5db3d7,0x3f51b3f3,0x3f6c835e,0x3f61c598,0x3f54db31,0x3f45e403
.long 0x3f6803ca,0x3f5adb81,0x3f4b1934,0x3f38ecd8,0x3f631324,0x3f534aca,0x3f407893,0x3f2ae1c9
.long 0x3f5db3d7,0x3f4b1934,0x3f3504f3,0x3f1bd7ca,0x3f57e880,0x3f424cfe,0x3f28cae3,0x3f0be54a
.long 0x3f51b3f3,0x3f38ecd8,0x3f1bd7ca,0x3ef64429,0x3f4b1934,0x3f2effe8,0x3f0e39da,0x3ed34e56
.long 0x3f800000,0x3f800000,0x3f800000,0x3f800000,0x3f7dcf55,0x3f7d6e28,0x3f7d0543,0x3f7c94a8
.long 0x3f7746ea,0x3f75c5d4,0x3f7426cb,0x3f726a03,0x3f6c835e,0x3f692e5f,0x3f659974,0x3f61c598
.long 0x3f5db3d7,0x3f57e880,0x3f51b3f3,0x3f4b1934,0x3f4b1934,0x3f424cfe,0x3f38ecd8,0x3f2effe8
.long 0x3f3504f3,0x3f28cae3,0x3f1bd7ca,0x3f0e39da,0x3f1bd7ca,0x3f0be54a,0x3ef64429,0x3ed34e56
.long 0x3f000000,0x3ed8616c,0x3eaf1d44,0x3e8483ee,0x3ec3ef15,0x3e94a031,0x3e47c5c2,0x3dc8bd36
.long 0x3e8483ee,0x3e1bc63c,0x3d32aa3e,0xbd85f213,0x3e05a8a8,0x3c32b7da,0xbddef599,0xbe6886ae
.long 0x248d3132,0xbe05a8a8,0xbe8483ee,0xbec3ef15,0xbe05a8a8,0xbe89e6f1,0xbece34d0,0xbf072f74
.long 0xbe8483ee,0xbece34d0,0xbf098c78,0xbf28cae3,0xbec3ef15,0xbf072f74,0xbf28cae3,0xbf45e403
.long 0x3f800000,0x3f800000,0x3f800000,0x3f800000,0x3f79ee89,0x3f795000,0x3f78a9e0,0x3f77fc2c
.long 0x3f6803ca,0x3f659974,0x3f631324,0x3f60712a,0x3f4b1934,0x3f45e403,0x3f407893,0x3f3ad85f
.long 0x3f248dbb,0x3f1bd7ca,0x3f12d5e8,0x3f098c78,0x3eec6a50,0x3ed34e56,0x3eb9917b,0x3e9f4757
.long 0x3e8483ee,0x3e47c5c2,0x3e05a8a8,0x3d85f213,0x3d32aa3e,0xbd060472,0xbddef599,0xbe3cce2b
.long 0xbe31d0d4,0xbe8483ee,0xbeaf1d44,0xbed8616c,0xbec3ef15,0xbef15aea,0xbf0e39da,0xbf226799
.long 0xbf12d5e8,0xbf28cae3,0xbf3cbe35,0xbf4e7327,0xbf3cbe35,0xbf5016b8,0xbf60712a,0xbf6d9156
.long 0xbf5db3d7,0xbf6c835e,0xbf7746ea,0xbf7dcf55,0xbf7426cb,0xbf7c94a8,0xbf7ff067,0xbf7e28c6
.long 0xbf7f069e,0xbf7f73af,0xbf79ee89,0xbf6e9811,0xbf7dcf55,0xbf74fa0b,0xbf659974,0xbf5016b8
.long 0x3f800000,0x3f800000,0x3f800000,0x3f800000,0x3f7426cb,0x3f734c1c,0x3f726a03,0x3f718088
.long 0x3f51b3f3,0x3f4e7327,0x3f4b1934,0x3f47a682,0x3f1bd7ca,0x3f151d42,0x3f0e39da,0x3f072f74
.long 0x3eaf1d44,0x3e99f61c,0x3e8483ee,0x3e5da259,0x3d32aa3e,0xbc32b7da,0xbd85f213,0xbdf52731
.long 0xbe8483ee,0xbea493b7,0xbec3ef15,0xbee273aa,0xbf098c78,0xbf199e45,0xbf28cae3,0xbf36fbaf
.long 0xbf441b7d,0xbf51b3f3,0xbf5db3d7,0xbf6803ca,0xbf6c835e,0xbf74fa0b,0xbf7b14be,0xbf7ec46d
.long 0xbf7f069e,0xbf7ff067,0xbf7dcf55,0xbf78a9e0,0xbf79ee89,0xbf718088,0xbf659974,0xbf56651d
.long 0xbf5db3d7,0xbf4b1934,0xbf3504f3,0xbf1bd7ca,0xbf2cf37b,0xbf108a14,0xbee273aa,0xbe9f4757
.long 0xbed8616c,0xbe8f45c0,0xbe05a8a8,0x3cb2b521,0xbe05a8a8,0x3d060472,0x3e47c5c2,0x3eb45a1e
.long 0x0,0x0,0x0,0x0,0x3d32aa3e,0x3d5f4a99,0x3d85f213,0x3d9c3ac6
.long 0x3db27eb6,0x3ddef599,0x3e05a8a8,0x3e1bc63c,0x3e05a8a8,0x3e26ce12,0x3e47c5c2,0x3e6886ae
.long 0x3e31d0d4,0x3e5da259,0x3e8483ee,0x3e99f61c,0x3e5da259,0x3e89e6f1,0x3ea493b7,0x3ebec330
.long 0x3e8483ee,0x3ea493b7,0x3ec3ef15,0x3ee273aa,0x3e99f61c,0x3ebec330,0x3ee273aa,0x3f026926
.long 0x3eaf1d44,0x3ed8616c,0x3f000000,0x3f12d5e8,0x3ec3ef15,0x3ef15aea,0x3f0e39da,0x3f226799
.long 0x3ed8616c,0x3f04ce53,0x3f1bd7ca,0x3f310700,0x3eec6a50,0x3f108a14,0x3f28cae3,0x3f3e9e4b
.long 0x3f000000,0x3f1bd7ca,0x3f3504f3,0x3f4b1934,0x3f098c78,0x3f26aed9,0x3f407893,0x3f56651d
.long 0x3f12d5e8,0x3f310700,0x3f4b1934,0x3f60712a,0x3f1bd7ca,0x3f3ad85f,0x3f54db31,0x3f692e5f
.long 0x0,0x0,0x0,0x0,0x3e05a8a8,0x3e10b9a6,0x3e1bc63c,0x3e26ce12
.long 0x3e8483ee,0x3e8f45c0,0x3e99f61c,0x3ea493b7,0x3ec3ef15,0x3ed34e56,0x3ee273aa,0x3ef15aea
.long 0x3f000000,0x3f098c78,0x3f12d5e8,0x3f1bd7ca,0x3f1bd7ca,0x3f26aed9,0x3f310700,0x3f3ad85f
.long 0x3f3504f3,0x3f407893,0x3f4b1934,0x3f54db31,0x3f4b1934,0x3f56651d,0x3f60712a,0x3f692e5f
.long 0x3f5db3d7,0x3f6803ca,0x3f708fb2,0x3f7746ea,0x3f6c835e,0x3f74fa0b,0x3f7b14be,0x3f7ec46d
.long 0x3f7746ea,0x3f7d0543,0x3f7fc1a0,0x3f7f73af,0x3f7dcf55,0x3f7ffc1a,0x3f7e7a7a,0x3f795000
.long 0x3f800000,0x3f7dcf55,0x3f7746ea,0x3f6c835e,0x3f7dcf55,0x3f768a20,0x3f6a51da,0x3f596550
.long 0x3f7746ea,0x3f6a51da,0x3f57e880,0x3f407893,0x3f6c835e,0x3f596550,0x3f407893,0x3f226799
.long 0x0,0x0,0x0,0x0,0x3e5da259,0x3e6886ae,0x3e7363ee,0x3e7e39c4
.long 0x3ed8616c,0x3ee273aa,0x3eec6a50,0x3ef64429,0x3f1bd7ca,0x3f226799,0x3f28cae3,0x3f2effe8
.long 0x3f441b7d,0x3f4b1934,0x3f51b3f3,0x3f57e880,0x3f631324,0x3f692e5f,0x3f6e9811,0x3f734c1c
.long 0x3f7746ea,0x3f7b14be,0x3f7dcf55,0x3f7f73af,0x3f7fc1a0,0x3f7fdce9,0x3f7e7a7a,0x3f7b9c62
.long 0x3f7c1c5c,0x3f7746ea,0x3f708fb2,0x3f6803ca,0x3f6c835e,0x3f61c598,0x3f54db31,0x3f45e403
.long 0x3f51b3f3,0x3f407893,0x3f2cf37b,0x3f176012,0x3f2cf37b,0x3f151d42,0x3ef64429,0x3ebec330
.long 0x3f000000,0x3ec3ef15,0x3e8483ee,0x3e05a8a8,0x3e99f61c,0x3e26ce12,0x3cb2b521,0xbdf52731
.long 0x3db27eb6,0xbd85f213,0xbe5da259,0xbeb9917b,0xbe05a8a8,0xbe94a031,0xbee273aa,0xbf151d42
.long 0x0,0x0,0x0,0x0,0x3e99f61c,0x3e9f4757,0x3ea493b7,0x3ea9db13
.long 0x3f12d5e8,0x3f176012,0x3f1bd7ca,0x3f203c85,0x3f4b1934,0x3f5016b8,0x3f54db31,0x3f596550
.long 0x3f708fb2,0x3f7426cb,0x3f7746ea,0x3f79ee89,0x3f7fc1a0,0x3f7ffc1a,0x3f7f73af,0x3f7e28c6
.long 0x3f7746ea,0x3f726a03,0x3f6c835e,0x3f659974,0x3f57e880,0x3f4cc94c,0x3f407893,0x3f3308b4
.long 0x3f248dbb,0x3f12d5e8,0x3f000000,0x3ed8616c,0x3ec3ef15,0x3e94a031,0x3e47c5c2,0x3dc8bd36
.long 0x3db27eb6,0xbcb2b521,0xbe05a8a8,0xbe7363ee,0xbe5da259,0xbea9db13,0xbee273aa,0xbf0be54a
.long 0xbf000000,0xbf1bd7ca,0xbf3504f3,0xbf4b1934,0xbf3cbe35,0xbf534aca,0xbf659974,0xbf734c1c
.long 0xbf6803ca,0xbf75c5d4,0xbf7dcf55,0xbf7ff067,0xbf7dcf55,0xbf7fdce9,0xbf7b14be,0xbf6f9788
.long 0x3f800000,0x3f7c1c5c,0x3f708fb2,0x3f5db3d7,0x3f800000,0x3f7b9c62,0x3f6e9811,0x3f596550
.long 0x3f800000,0x3f7b14be,0x3f6c835e,0x3f54db31,0x3f800000,0x3f7a8575,0x3f6a51da,0x3f5016b8
.long 0x3f800000,0x3f79ee89,0x3f6803ca,0x3f4b1934,0x3f800000,0x3f795000,0x3f659974,0x3f45e403
.long 0x3f800000,0x3f78a9e0,0x3f631324,0x3f407893,0x3f800000,0x3f77fc2c,0x3f60712a,0x3f3ad85f
.long 0x3f800000,0x3f7746ea,0x3f5db3d7,0x3f3504f3,0x3f800000,0x3f768a20,0x3f5adb81,0x3f2effe8
.long 0x3f800000,0x3f75c5d4,0x3f57e880,0x3f28cae3,0x3f800000,0x3f74fa0b,0x3f54db31,0x3f226799
.long 0x3f800000,0x3f7426cb,0x3f51b3f3,0x3f1bd7ca,0x3f800000,0x3f734c1c,0x3f4e7327,0x3f151d42
.long 0x3f800000,0x3f726a03,0x3f4b1934,0x3f0e39da,0x3f800000,0x3f718088,0x3f47a682,0x3f072f74
.long 0x3e31d0d4,0x248d3132,0xbe31d0d4,0xbeaf1d44,0x3db27eb6,0xbdc8bd36,0xbe8f45c0,0xbee77284
.long 0x248d3132,0xbe47c5c2,0xbec3ef15,0xbf0e39da,0xbdb27eb6,0xbe94a031,0xbef64429,0xbf26aed9
.long 0xbe31d0d4,0xbec3ef15,0xbf12d5e8,0xbf3cbe35,0xbe8483ee,0xbef15aea,0xbf28cae3,0xbf5016b8
.long 0xbeaf1d44,0xbf0e39da,0xbf3cbe35,0xbf60712a,0xbed8616c,0xbf226799,0xbf4e7327,0xbf6d9156
.long 0xbf000000,0xbf3504f3,0xbf5db3d7,0xbf7746ea,0xbf12d5e8,0xbf45e403,0xbf6a51da,0xbf7d6e28
.long 0xbf248dbb,0xbf54db31,0xbf7426cb,0xbf7ff067,0xbf3504f3,0xbf61c598,0xbf7b14be,0xbf7ec46d
.long 0xbf441b7d,0xbf6c835e,0xbf7f069e,0xbf79ee89,0xbf51b3f3,0xbf74fa0b,0xbf7ff067,0xbf718088
.long 0xbf5db3d7,0xbf7b14be,0xbf7dcf55,0xbf659974,0xbf6803ca,0xbf7ec46d,0xbf78a9e0,0xbf56651d
.long 0xbf708fb2,0xbf7c1c5c,0xbf800000,0xbf7c1c5c,0xbf7c1c5c,0xbf7ffc1a,0xbf7b14be,0xbf6d9156
.long 0xbf800000,0xbf7b14be,0xbf6c835e,0xbf54db31,0xbf7c1c5c,0xbf6d9156,0xbf54db31,0xbf3308b4
.long 0xbf708fb2,0xbf57e880,0xbf3504f3,0xbf098c78,0xbf5db3d7,0xbf3ad85f,0xbf0e39da,0xbeb45a1e
.long 0xbf441b7d,0xbf176012,0xbec3ef15,0xbe1bc63c,0xbf248dbb,0xbedd6dea,0xbe47c5c2,0x3d5f4a99
.long 0xbf000000,0xbe8483ee,0xa553c9ca,0x3e8483ee,0xbeaf1d44,0xbd9c3ac6,0x3e47c5c2,0x3ee77284
.long 0xbe31d0d4,0x3ddef599,0x3ec3ef15,0x3f203c85,0xa553c9ca,0x3e94a031,0x3f0e39da,0x3f45e403
.long 0x3e31d0d4,0x3eec6a50,0x3f3504f3,0x3f631324,0x3eaf1d44,0x3f1e0c90,0x3f54db31,0x3f768a20
.long 0x3f000000,0x3f407893,0x3f6c835e,0x3f7f73af,0x3f248dbb,0x3f5c4b07,0x3f7b14be,0x3f7d6e28
.long 0xbf000000,0xbeaf1d44,0xbe31d0d4,0xa553c9ca,0xbe8483ee,0xbd9c3ac6,0x3ddef599,0x3e94a031
.long 0xa553c9ca,0x3e47c5c2,0x3ec3ef15,0x3f0e39da,0x3e8483ee,0x3ee77284,0x3f203c85,0x3f45e403
.long 0x3f000000,0x3f2cf37b,0x3f51b3f3,0x3f6c835e,0x3f3504f3,0x3f596550,0x3f726a03,0x3f7ec46d
.long 0x3f5db3d7,0x3f75c5d4,0x3f7fc1a0,0x3f7b14be,0x3f7746ea,0x3f7ffc1a,0x3f78a9e0,0x3f61c598
.long 0x3f800000,0x3f7746ea,0x3f5db3d7,0x3f3504f3,0x3f7746ea,0x3f5c4b07,0x3f310700,0x3ef15aea
.long 0x3f5db3d7,0x3f310700,0x3eec6a50,0x3e47c5c2,0x3f3504f3,0x3ef15aea,0x3e47c5c2,0xbdc8bd36
.long 0x3f000000,0x3e5da259,0xbdb27eb6,0xbec3ef15,0x3e8483ee,0xbd5f4a99,0xbeb9917b,0xbf226799
.long 0x248d3132,0xbea493b7,0xbf1bd7ca,0xbf54db31,0xbe8483ee,0xbf108a14,0xbf4e7327,0xbf74fa0b
.long 0x0,0x3e31d0d4,0x3eaf1d44,0x3f000000,0x0,0x3e3cce2b,0x3eb9917b,0x3f072f74
.long 0x0,0x3e47c5c2,0x3ec3ef15,0x3f0e39da,0x0,0x3e52b743,0x3ece34d0,0x3f151d42
.long 0x0,0x3e5da259,0x3ed8616c,0x3f1bd7ca,0x0,0x3e6886ae,0x3ee273aa,0x3f226799
.long 0x0,0x3e7363ee,0x3eec6a50,0x3f28cae3,0x0,0x3e7e39c4,0x3ef64429,0x3f2effe8
.long 0x0,0x3e8483ee,0x3f000000,0x3f3504f3,0x0,0x3e89e6f1,0x3f04ce53,0x3f3ad85f
.long 0x0,0x3e8f45c0,0x3f098c78,0x3f407893,0x0,0x3e94a031,0x3f0e39da,0x3f45e403
.long 0x0,0x3e99f61c,0x3f12d5e8,0x3f4b1934,0x0,0x3e9f4757,0x3f176012,0x3f5016b8
.long 0x0,0x3ea493b7,0x3f1bd7ca,0x3f54db31,0x0,0x3ea9db13,0x3f203c85,0x3f596550
.long 0x3f7c1c5c,0x3f800000,0x3f7c1c5c,0x3f708fb2,0x3f7f069e,0x3f7ec46d,0x3f75c5d4,0x3f6459c6
.long 0x3f800000,0x3f7b14be,0x3f6c835e,0x3f54db31,0x3f7f069e,0x3f74fa0b,0x3f60712a,0x3f424cfe
.long 0x3f7c1c5c,0x3f6c835e,0x3f51b3f3,0x3f2cf37b,0x3f7746ea,0x3f61c598,0x3f407893,0x3f151d42
.long 0x3f708fb2,0x3f54db31,0x3f2cf37b,0x3ef64429,0x3f6803ca,0x3f45e403,0x3f176012,0x3ebec330
.long 0x3f5db3d7,0x3f3504f3,0x3f000000,0x3e8483ee,0x3f51b3f3,0x3f226799,0x3ece34d0,0x3e10b9a6
.long 0x3f441b7d,0x3f0e39da,0x3e99f61c,0x3cb2b521,0x3f3504f3,0x3ef15aea,0x3e47c5c2,0xbdc8bd36
.long 0x3f248dbb,0x3ec3ef15,0x3db27eb6,0xbe5da259,0x3f12d5e8,0x3e94a031,0xbcb2b521,0xbea9db13
.long 0x3f000000,0x3e47c5c2,0xbe05a8a8,0xbee273aa,0x3ed8616c,0x3dc8bd36,0xbe7363ee,0xbf0be54a
.long 0x3eaf1d44,0x3e31d0d4,0x250d3132,0xbe31d0d4,0x3e31d0d4,0xbc32b7da,0xbe47c5c2,0xbebec330
.long 0x250d3132,0xbe47c5c2,0xbec3ef15,0xbf0e39da,0xbe31d0d4,0xbebec330,0xbf0e39da,0xbf36fbaf
.long 0xbeaf1d44,0xbf098c78,0xbf3504f3,0xbf57e880,0xbf000000,0xbf2effe8,0xbf54db31,0xbf6f9788
.long 0xbf248dbb,0xbf4e7327,0xbf6c835e,0xbf7d0543,0xbf441b7d,0xbf66d223,0xbf7b14be,0xbf7f9e8c
.long 0xbf5db3d7,0xbf7746ea,0xbf800000,0xbf7746ea,0xbf708fb2,0xbf7f4109,0xbf7b14be,0xbf6459c6
.long 0xbf7c1c5c,0xbf7e7a7a,0xbf6c835e,0xbf47a682,0xbf800000,0xbf74fa0b,0xbf54db31,0xbf226799
.long 0xbf7c1c5c,0xbf631324,0xbf3504f3,0xbeec6a50,0xbf708fb2,0xbf4962ed,0xbf0e39da,0xbe89e6f1
.long 0xbf5db3d7,0xbf28cae3,0xbec3ef15,0xbd85f213,0xbf441b7d,0xbf026926,0xbe47c5c2,0x3e10b9a6
.long 0xbf5db3d7,0xbf708fb2,0xbf7c1c5c,0xbf800000,0xbf7746ea,0xbf7f4109,0xbf7e7a7a,0xbf74fa0b
.long 0xbf800000,0xbf7b14be,0xbf6c835e,0xbf54db31,0xbf7746ea,0xbf6459c6,0xbf47a682,0xbf226799
.long 0xbf5db3d7,0xbf3cbe35,0xbf12d5e8,0xbec3ef15,0xbf3504f3,0xbf072f74,0xbea493b7,0xbdc8bd36
.long 0xbf000000,0xbe8f45c0,0xbd32aa3e,0x3e47c5c2,0xbe8483ee,0xbc32b7da,0x3e7363ee,0x3ef15aea
.long 0x0,0x3e8483ee,0x3f000000,0x3f3504f3,0x3e8483ee,0x3f026926,0x3f38ecd8,0x3f61c598
.long 0x3f000000,0x3f38ecd8,0x3f631324,0x3f7b14be,0x3f3504f3,0x3f61c598,0x3f7b14be,0x3f7ec46d
.long 0x3f5db3d7,0x3f79ee89,0x3f7f069e,0x3f6c835e,0x3f7746ea,0x3f7f9e8c,0x3f6e9811,0x3f45e403
.long 0x3f800000,0x3f726a03,0x3f4b1934,0x3f0e39da,0x3f7746ea,0x3f534aca,0x3f176012,0x3e94a031
.long 0x3f441b7d,0x3f248dbb,0x3f000000,0x3eaf1d44,0x3f3cbe35,0x3f199e45,0x3ee273aa,0x3e89e6f1
.long 0x3f3504f3,0x3f0e39da,0x3ec3ef15,0x3e47c5c2,0x3f2cf37b,0x3f026926,0x3ea493b7,0x3df52731
.long 0x3f248dbb,0x3eec6a50,0x3e8483ee,0x3d32aa3e,0x3f1bd7ca,0x3ed34e56,0x3e47c5c2,0xbd060472
.long 0x3f12d5e8,0x3eb9917b,0x3e05a8a8,0xbddef599,0x3f098c78,0x3e9f4757,0x3d85f213,0xbe3cce2b
.long 0x3f000000,0x3e8483ee,0x248d3132,0xbe8483ee,0x3eec6a50,0x3e52b743,0xbd85f213,0xbea9db13
.long 0x3ed8616c,0x3e1bc63c,0xbe05a8a8,0xbece34d0,0x3ec3ef15,0x3dc8bd36,0xbe47c5c2,0xbef15aea
.long 0x3eaf1d44,0x3d32aa3e,0xbe8483ee,0xbf098c78,0x3e99f61c,0xbc32b7da,0xbea493b7,0xbf199e45
.long 0x3e8483ee,0xbd85f213,0xbec3ef15,0xbf28cae3,0x3e5da259,0xbdf52731,0xbee273aa,0xbf36fbaf
.long 0xbf000000,0xbf248dbb,0xbf441b7d,0xbf5db3d7,0xbf1bd7ca,0xbf3e9e4b,0xbf5adb81,0xbf6f9788
.long 0xbf3504f3,0xbf54db31,0xbf6c835e,0xbf7b14be,0xbf4b1934,0xbf66d223,0xbf78a9e0,0xbf7fdce9
.long 0xbf5db3d7,0xbf7426cb,0xbf7f069e,0xbf7dcf55,0xbf6c835e,0xbf7c94a8,0xbf7f73af,0xbf74fa0b
.long 0xbf7746ea,0xbf7ff067,0xbf79ee89,0xbf659974,0xbf7dcf55,0xbf7e28c6,0xbf6e9811,0xbf5016b8
.long 0xbf800000,0xbf7746ea,0xbf5db3d7,0xbf3504f3,0xbf7dcf55,0xbf6b6e32,0xbf47a682,0xbf151d42
.long 0xbf7746ea,0xbf5adb81,0xbf2cf37b,0xbee273aa,0xbf6c835e,0xbf45e403,0xbf0e39da,0xbe94a031
.long 0xbf5db3d7,0xbf2cf37b,0xbed8616c,0xbe05a8a8,0xbf4b1934,0xbf108a14,0xbe8f45c0,0x3d060472
.long 0xbf3504f3,0xbee273aa,0xbe05a8a8,0x3e47c5c2,0xbf1bd7ca,0xbe9f4757,0x3cb2b521,0x3eb45a1e
.long 0xbf708fb2,0xbf5db3d7,0xbf441b7d,0xbf248dbb,0xbf57e880,0xbf3ad85f,0xbf176012,0xbedd6dea
.long 0xbf3504f3,0xbf0e39da,0xbec3ef15,0xbe47c5c2,0xbf098c78,0xbeb45a1e,0xbe1bc63c,0x3d5f4a99
.long 0xbeaf1d44,0xbe05a8a8,0x3db27eb6,0x3e99f61c,0xbe05a8a8,0x3dc8bd36,0x3ea493b7,0x3f072f74
.long 0x3db27eb6,0x3ea493b7,0x3f098c78,0x3f38ecd8,0x3e99f61c,0x3f072f74,0x3f38ecd8,0x3f5f15e7
.long 0x3f000000,0x3f3504f3,0x3f5db3d7,0x3f7746ea,0x3f2cf37b,0x3f596550,0x3f75c5d4,0x3f7ffc1a
.long 0x3f51b3f3,0x3f726a03,0x3f7fc1a0,0x3f78a9e0,0x3f6c835e,0x3f7ec46d,0x3f7b14be,0x3f61c598
.long 0x3f7c1c5c,0x3f7dcf55,0x3f6803ca,0x3f3cbe35,0x3f7fc1a0,0x3f6f9788,0x3f47a682,0x3f0be54a
.long 0x3f7746ea,0x3f54db31,0x3f1bd7ca,0x3ea493b7,0x3f631324,0x3f2effe8,0x3ece34d0,0x3d9c3ac6
.long 0x3e31d0d4,0x3eaf1d44,0x3f000000,0x3f248dbb,0x3eec6a50,0x3f1e0c90,0x3f407893,0x3f5c4b07
.long 0x3f3504f3,0x3f54db31,0x3f6c835e,0x3f7b14be,0x3f631324,0x3f768a20,0x3f7f73af,0x3f7d6e28
.long 0x3f7c1c5c,0x3f7fc1a0,0x3f7746ea,0x3f631324,0x3f7dcf55,0x3f6f9788,0x3f54db31,0x3f2effe8
.long 0x3f6803ca,0x3f47a682,0x3f1bd7ca,0x3ece34d0,0x3f3cbe35,0x3f0be54a,0x3ea493b7,0x3d9c3ac6
.long 0x3f000000,0x3e8483ee,0x248d3132,0xbe8483ee,0x3e5da259,0xbd5f4a99,0xbea493b7,0xbf108a14
.long 0xbdb27eb6,0xbeb9917b,0xbf1bd7ca,0xbf4e7327,0xbec3ef15,0xbf226799,0xbf54db31,0xbf74fa0b
.long 0xbf248dbb,0xbf57e880,0xbf7746ea,0xbf7fc1a0,0xbf57e880,0xbf77fc2c,0xbf7f73af,0xbf6d9156
.long 0xbf7746ea,0xbf7f73af,0xbf6c835e,0xbf407893,0xbf7fc1a0,0xbf6d9156,0xbf407893,0xbefb25e8
.long 0x3f248dbb,0x3f441b7d,0x3f5db3d7,0x3f708fb2,0x3f2cf37b,0x3f4cc94c,0x3f659974,0x3f768a20
.long 0x3f3504f3,0x3f54db31,0x3f6c835e,0x3f7b14be,0x3f3cbe35,0x3f5c4b07,0x3f726a03,0x3f7e28c6
.long 0x3f441b7d,0x3f631324,0x3f7746ea,0x3f7fc1a0,0x3f4b1934,0x3f692e5f,0x3f7b14be,0x3f7fdce9
.long 0x3f51b3f3,0x3f6e9811,0x3f7dcf55,0x3f7e7a7a,0x3f57e880,0x3f734c1c,0x3f7f73af,0x3f7b9c62
.long 0x3f5db3d7,0x3f7746ea,0x3f800000,0x3f7746ea,0x3f631324,0x3f7a8575,0x3f7f73af,0x3f718088
.long 0x3f6803ca,0x3f7d0543,0x3f7dcf55,0x3f6a51da,0x3f6c835e,0x3f7ec46d,0x3f7b14be,0x3f61c598
.long 0x3f708fb2,0x3f7fc1a0,0x3f7746ea,0x3f57e880,0x3f7426cb,0x3f7ffc1a,0x3f726a03,0x3f4cc94c
.long 0x3f7746ea,0x3f7f73af,0x3f6c835e,0x3f407893,0x3f79ee89,0x3f7e28c6,0x3f659974,0x3f3308b4
.long 0x3f5db3d7,0x3f441b7d,0x3f248dbb,0x3f000000,0x3f4b1934,0x3f2ae1c9,0x3f04ce53,0x3eb45a1e
.long 0x3f3504f3,0x3f0e39da,0x3ec3ef15,0x3e47c5c2,0x3f1bd7ca,0x3edd6dea,0x3e7363ee,0x3d060472
.long 0x3f000000,0x3e99f61c,0x3db27eb6,0xbe05a8a8,0x3ec3ef15,0x3e26ce12,0xbd85f213,0xbe94a031
.long 0x3e8483ee,0x3cb2b521,0xbe5da259,0xbee273aa,0x3e05a8a8,0xbdf52731,0xbeb9917b,0xbf151d42
.long 0x250d3132,0xbe8483ee,0xbf000000,0xbf3504f3,0xbe05a8a8,0xbec91503,0xbf203c85,0xbf5016b8
.long 0xbe8483ee,0xbf04ce53,0xbf3cbe35,0xbf659974,0xbec3ef15,0xbf226799,0xbf54db31,0xbf74fa0b
.long 0xbf000000,0xbf3cbe35,0xbf6803ca,0xbf7dcf55,0xbf1bd7ca,0xbf534aca,0xbf75c5d4,0xbf7fdce9
.long 0xbf3504f3,0xbf659974,0xbf7dcf55,0xbf7b14be,0xbf4b1934,0xbf734c1c,0xbf7ff067,0xbf6f9788
.long 0xbeaf1d44,0xbf000000,0xbf248dbb,0xbf441b7d,0xbf098c78,0xbf2effe8,0xbf4e7327,0xbf66d223
.long 0xbf3504f3,0xbf54db31,0xbf6c835e,0xbf7b14be,0xbf57e880,0xbf6f9788,0xbf7d0543,0xbf7f9e8c
.long 0xbf708fb2,0xbf7dcf55,0xbf7f069e,0xbf7426cb,0xbf7dcf55,0xbf7ec46d,0xbf726a03,0xbf596550
.long 0xbf7f069e,0xbf726a03,0xbf57e880,0xbf310700,0xbf7426cb,0xbf596550,0xbf310700,0xbefb25e8
.long 0xbf5db3d7,0xbf3504f3,0xbf000000,0xbe8483ee,0xbf3cbe35,0xbf072f74,0xbe8f45c0,0xbc32b7da
.long 0xbf12d5e8,0xbea493b7,0xbd32aa3e,0x3e7363ee,0xbec3ef15,0xbdc8bd36,0x3e47c5c2,0x3ef15aea
.long 0xbe31d0d4,0x3e05a8a8,0x3ed8616c,0x3f2cf37b,0x3d32aa3e,0x3eb45a1e,0x3f203c85,0x3f56651d
.long 0x3e8483ee,0x3f0e39da,0x3f4b1934,0x3f726a03,0x3eec6a50,0x3f3ad85f,0x3f6a51da,0x3f7f4109
.long 0xbf7c1c5c,0xbf708fb2,0xbf5db3d7,0xbf441b7d,0xbf631324,0xbf4962ed,0xbf28cae3,0xbf026926
.long 0xbf3504f3,0xbf0e39da,0xbec3ef15,0xbe47c5c2,0xbeec6a50,0xbe89e6f1,0xbd85f213,0x3e10b9a6
.long 0xbe31d0d4,0x3d32aa3e,0x3e8483ee,0x3eec6a50,0x3e05a8a8,0x3eb45a1e,0x3f0e39da,0x3f3ad85f
.long 0x3ed8616c,0x3f203c85,0x3f4b1934,0x3f6a51da,0x3f2cf37b,0x3f56651d,0x3f726a03,0x3f7f4109
.long 0x3f5db3d7,0x3f7746ea,0x3f800000,0x3f7746ea,0x3f79ee89,0x3f7f9e8c,0x3f726a03,0x3f534aca
.long 0x3f7f069e,0x3f6e9811,0x3f4b1934,0x3f176012,0x3f6c835e,0x3f45e403,0x3f0e39da,0x3e94a031
.long 0x3f441b7d,0x3f098c78,0x3e8483ee,0xbd32aa3e,0x3f098c78,0x3e7e39c4,0xbd85f213,0xbebec330
.long 0x3e8483ee,0xbd85f213,0xbec3ef15,0xbf28cae3,0xbd32aa3e,0xbebec330,0xbf28cae3,0xbf5f15e7
.long 0x8000338b,0x8000338b,0x8000338b,0x8000338b,0x8000338b,0xad293316,0xad29b316,0x8000b38b
.long 0x8000338b,0xb0d931c7,0x30d931c7,0x8000338b,0x8000338b,0xb2882f8b,0xb288af8b,0x8000b38b
.long 0x8000338b,0xb36e293d,0x336e293d,0x8000338b,0x8000338b,0xb36ea93d,0xb36e293d,0x8000b38b
.long 0x8000338b,0xb288af8b,0x3288af8b,0x8000338b,0x8000338b,0xb0d9b1c7,0xb0d931c7,0x8000b38b
.long 0x8000338b,0xad29b316,0x2d29b316,0x8000338b,0x8000338b,0x8000b38b,0x8000338b,0x8000b38b
.long 0x8000338b,0x2d29b316,0xad29b316,0x8000338b,0x8000338b,0x30d9b1c7,0x30d931c7,0x8000b38b
.long 0x8000338b,0x3288af8b,0xb288af8b,0x8000338b,0x8000338b,0x336ea93d,0x336e293d,0x8000b38b
.long 0x8000338b,0x336e293d,0xb36e293d,0x8000338b,0x8000338b,0x32882f8b,0x3288af8b,0x8000b38b
.long 0x8000338b,0x8000338b,0x8000338b,0x8000338b,0xb0d931c7,0xb2882f8b,0x2d29b316,0x30d9b1c7
.long 0xb36e293d,0xb288af8b,0xb0d931c7,0xb36e293d,0xb288af8b,0x8000b38b,0x3288af8b,0x32882f8b
.long 0xad29b316,0x3288af8b,0xb36e293d,0xad29b316,0x2d29b316,0x32882f8b,0x336e293d,0xad293316
.long 0x3288af8b,0x8000338b,0xb288af8b,0x3288af8b,0x336e293d,0xb2882f8b,0x30d931c7,0xb36ea93d
.long 0x30d931c7,0xb288af8b,0xad29b316,0x30d931c7,0x8000338b,0x8000b38b,0x8000338b,0x8000b38b
.long 0xb0d931c7,0x3288af8b,0x2d29b316,0xb0d931c7,0xb36e293d,0x32882f8b,0xb0d931c7,0x336ea93d
.long 0xb288af8b,0x8000338b,0x3288af8b,0xb288af8b,0xad29b316,0xb2882f8b,0xb36e293d,0x2d293316
.long 0x2d29b316,0xb288af8b,0x336e293d,0x2d29b316,0x3288af8b,0x8000b38b,0xb288af8b,0xb2882f8b
.long 0x8000338b,0x8000338b,0x8000338b,0x8000338b,0xb36e293d,0xb36ea93d,0x3288af8b,0x336ea93d
.long 0xad29b316,0x2d29b316,0xb288af8b,0xad29b316,0x3288af8b,0x32882f8b,0x8000338b,0xb2882f8b
.long 0x30d931c7,0xb0d931c7,0x3288af8b,0x30d931c7,0xb0d931c7,0xb0d9b1c7,0xb288af8b,0x30d9b1c7
.long 0xb288af8b,0x3288af8b,0x8000338b,0xb288af8b,0x2d29b316,0x2d293316,0x3288af8b,0xad293316
.long 0x336e293d,0xb36e293d,0xb288af8b,0x336e293d,0x8000338b,0x8000b38b,0x8000338b,0x8000b38b
.long 0xb36e293d,0x336e293d,0x3288af8b,0xb36e293d,0xad29b316,0xad293316,0xb288af8b,0x2d293316
.long 0x3288af8b,0xb288af8b,0x8000338b,0x3288af8b,0x30d931c7,0x30d9b1c7,0x3288af8b,0xb0d9b1c7
.long 0xb0d931c7,0x30d931c7,0xb288af8b,0xb0d931c7,0xb288af8b,0xb2882f8b,0x8000338b,0x32882f8b
.long 0x8000338b,0x8000338b,0x8000338b,0x8000338b,0xb288af8b,0xb0d9b1c7,0x336e293d,0x32882f8b
.long 0x3288af8b,0x336e293d,0x2d29b316,0x3288af8b,0x8000338b,0xb2882f8b,0xb288af8b,0x8000b38b
.long 0xb288af8b,0x2d29b316,0xb0d931c7,0xb288af8b,0x3288af8b,0x2d293316,0x30d931c7,0xb2882f8b
.long 0x8000338b,0xb288af8b,0x3288af8b,0x8000338b,0xb288af8b,0x336ea93d,0xad29b316,0x32882f8b
.long 0x3288af8b,0xb0d931c7,0xb36e293d,0x3288af8b,0x8000338b,0x8000b38b,0x8000338b,0x8000b38b
.long 0xb288af8b,0x30d931c7,0x336e293d,0xb288af8b,0x3288af8b,0xb36ea93d,0x2d29b316,0xb2882f8b
.long 0x8000338b,0x3288af8b,0xb288af8b,0x8000338b,0xb288af8b,0xad293316,0xb0d931c7,0x32882f8b
.long 0x3288af8b,0xad29b316,0x30d931c7,0x3288af8b,0x8000338b,0x32882f8b,0x3288af8b,0x8000b38b
.long 0x338b0000,0x338b0000,0x338b0000,0x338b0000,0x338b0000,0x33162d29,0xb3162d29,0xb38b0000
.long 0x338b0000,0x31c730d9,0x31c7b0d9,0x338b0000,0x338b0000,0x2f8b3288,0xaf8b3288,0xb38b0000
.long 0x338b0000,0x293d336e,0x293db36e,0x338b0000,0x338b0000,0xa93d336e,0x293d336e,0xb38b0000
.long 0x338b0000,0xaf8b3288,0xaf8bb288,0x338b0000,0x338b0000,0xb1c730d9,0x31c730d9,0xb38b0000
.long 0x338b0000,0xb3162d29,0xb316ad29,0x338b0000,0x338b0000,0xb38b0000,0x338b0000,0xb38b0000
.long 0x338b0000,0xb316ad29,0xb3162d29,0x338b0000,0x338b0000,0xb1c7b0d9,0x31c7b0d9,0xb38b0000
.long 0x338b0000,0xaf8bb288,0xaf8b3288,0x338b0000,0x338b0000,0xa93db36e,0x293db36e,0xb38b0000
.long 0x338b0000,0x293db36e,0x293d336e,0x338b0000,0x338b0000,0x2f8bb288,0xaf8bb288,0xb38b0000
.long 0x338b0000,0x338b0000,0x338b0000,0x338b0000,0x31c730d9,0x2f8b3288,0xb316ad29,0xb1c7b0d9
.long 0x293d336e,0xaf8b3288,0x31c730d9,0x293d336e,0xaf8b3288,0xb38b0000,0xaf8bb288,0x2f8bb288
.long 0xb3162d29,0xaf8bb288,0x293d336e,0xb3162d29,0xb316ad29,0x2f8bb288,0x293db36e,0x33162d29
.long 0xaf8bb288,0x338b0000,0xaf8b3288,0xaf8bb288,0x293db36e,0x2f8b3288,0x31c7b0d9,0xa93d336e
.long 0x31c7b0d9,0xaf8b3288,0xb3162d29,0x31c7b0d9,0x338b0000,0xb38b0000,0x338b0000,0xb38b0000
.long 0x31c730d9,0xaf8bb288,0xb316ad29,0x31c730d9,0x293d336e,0x2f8bb288,0x31c730d9,0xa93db36e
.long 0xaf8b3288,0x338b0000,0xaf8bb288,0xaf8b3288,0xb3162d29,0x2f8b3288,0x293d336e,0x3316ad29
.long 0xb316ad29,0xaf8b3288,0x293db36e,0xb316ad29,0xaf8bb288,0xb38b0000,0xaf8b3288,0x2f8b3288
.long 0x338b0000,0x338b0000,0x338b0000,0x338b0000,0x293d336e,0xa93d336e,0xaf8bb288,0xa93db36e
.long 0xb3162d29,0xb316ad29,0xaf8b3288,0xb3162d29,0xaf8bb288,0x2f8bb288,0x338b0000,0x2f8b3288
.long 0x31c7b0d9,0x31c730d9,0xaf8bb288,0x31c7b0d9,0x31c730d9,0xb1c730d9,0xaf8b3288,0xb1c7b0d9
.long 0xaf8b3288,0xaf8bb288,0x338b0000,0xaf8b3288,0xb316ad29,0x3316ad29,0xaf8bb288,0x33162d29
.long 0x293db36e,0x293d336e,0xaf8b3288,0x293db36e,0x338b0000,0xb38b0000,0x338b0000,0xb38b0000
.long 0x293d336e,0x293db36e,0xaf8bb288,0x293d336e,0xb3162d29,0x33162d29,0xaf8b3288,0x3316ad29
.long 0xaf8bb288,0xaf8b3288,0x338b0000,0xaf8bb288,0x31c7b0d9,0xb1c7b0d9,0xaf8bb288,0xb1c730d9
.long 0x31c730d9,0x31c7b0d9,0xaf8b3288,0x31c730d9,0xaf8b3288,0x2f8b3288,0x338b0000,0x2f8bb288
.long 0x338b0000,0x338b0000,0x338b0000,0x338b0000,0xaf8b3288,0xb1c730d9,0x293db36e,0x2f8bb288
.long 0xaf8bb288,0x293db36e,0xb316ad29,0xaf8bb288,0x338b0000,0x2f8b3288,0xaf8b3288,0xb38b0000
.long 0xaf8b3288,0xb316ad29,0x31c730d9,0xaf8b3288,0xaf8bb288,0x3316ad29,0x31c7b0d9,0x2f8b3288
.long 0x338b0000,0xaf8b3288,0xaf8bb288,0x338b0000,0xaf8b3288,0xa93db36e,0xb3162d29,0x2f8bb288
.long 0xaf8bb288,0x31c730d9,0x293d336e,0xaf8bb288,0x338b0000,0xb38b0000,0x338b0000,0xb38b0000
.long 0xaf8b3288,0x31c7b0d9,0x293db36e,0xaf8b3288,0xaf8bb288,0xa93d336e,0xb316ad29,0x2f8b3288
.long 0x338b0000,0xaf8bb288,0xaf8b3288,0x338b0000,0xaf8b3288,0x33162d29,0x31c730d9,0x2f8bb288
.long 0xaf8bb288,0xb3162d29,0x31c7b0d9,0xaf8bb288,0x338b0000,0x2f8bb288,0xaf8bb288,0xb38b0000
.long 0x8000338b,0x8000338b,0x338b0000,0x338b0000,0x30d931c7,0x2d293316,0x31c7b0d9,0x3316ad29
.long 0x336e293d,0x30d931c7,0x293db36e,0x31c7b0d9,0x3288af8b,0x32882f8b,0xaf8bb288,0x2f8bb288
.long 0x2d29b316,0x336e293d,0xb316ad29,0x293db36e,0xad29b316,0x336ea93d,0xb3162d29,0xa93db36e
.long 0xb288af8b,0x3288af8b,0xaf8b3288,0xaf8bb288,0xb36e293d,0x30d9b1c7,0x293d336e,0xb1c7b0d9
.long 0xb0d931c7,0x2d29b316,0x31c730d9,0xb316ad29,0x8000338b,0x8000b38b,0x338b0000,0xb38b0000
.long 0x30d931c7,0xad29b316,0x31c7b0d9,0xb3162d29,0x336e293d,0xb0d9b1c7,0x293db36e,0xb1c730d9
.long 0x3288af8b,0xb288af8b,0xaf8bb288,0xaf8b3288,0x2d29b316,0xb36ea93d,0xb316ad29,0xa93d336e
.long 0xad29b316,0xb36e293d,0xb3162d29,0x293d336e,0xb288af8b,0xb2882f8b,0xaf8b3288,0x2f8b3288
.long 0x8000338b,0x8000338b,0x338b0000,0x338b0000,0x8000338b,0x8000b38b,0x338b0000,0xb38b0000
.long 0x8000338b,0x8000338b,0x338b0000,0x338b0000,0x8000338b,0x8000b38b,0x338b0000,0xb38b0000
.long 0x8000338b,0x8000338b,0x338b0000,0x338b0000,0x8000338b,0x8000b38b,0x338b0000,0xb38b0000
.long 0x8000338b,0x8000338b,0x338b0000,0x338b0000,0x8000338b,0x8000b38b,0x338b0000,0xb38b0000
.long 0x8000338b,0x8000338b,0x338b0000,0x338b0000,0x8000338b,0x8000b38b,0x338b0000,0xb38b0000
.long 0x8000338b,0x8000338b,0x338b0000,0x338b0000,0x8000338b,0x8000b38b,0x338b0000,0xb38b0000
.long 0x8000338b,0x8000338b,0x338b0000,0x338b0000,0x8000338b,0x8000b38b,0x338b0000,0xb38b0000
.long 0x8000338b,0x8000338b,0x338b0000,0x338b0000,0x8000338b,0x8000b38b,0x338b0000,0xb38b0000
.long 0x0,0x0,0x0,0x0,0x0,0x0,0x0,0x0
.long 0x0,0x0,0x0,0x0,0x0,0x0,0x0,0x0
.long 0x0,0x0,0x0,0x0,0x0,0x0,0x0,0x0
.long 0x0,0x0,0x0,0x0,0x0,0x0,0x0,0x0
.long 0x0,0x0,0x0,0x0,0x0,0x0,0x0,0x0
.long 0x0,0x0,0x0,0x0,0x0,0x0,0x0,0x0
.long 0x0,0x0,0x0,0x0,0x0,0x0,0x0,0x0
.long 0x0,0x0,0x0,0x0,0x0,0x0,0x0,0x0
.long 0x0,0x0,0x0,0x0,0x0,0x0,0x0,0x0
.long 0x0,0x0,0x0,0x0,0x0,0x0,0x0,0x0
.long 0x0,0x0,0x0,0x0,0x0,0x0,0x0,0x0
.long 0x0,0x0,0x0,0x0,0x0,0x0,0x0,0x0
.long 0x0,0x0,0x0,0x0,0x0,0x0,0x0,0x0
.long 0x0,0x0,0x0,0x0,0x0,0x0,0x0,0x0
.long 0x0,0x0,0x0,0x0,0x0,0x0,0x0,0x0
.long 0x0,0x0,0x0,0x0,0x0,0x0,0x0,0x0
.long 0x8000338b,0x30d931c7,0xb0d931c7,0x8000338b,0x8000338b,0x2d293316,0x2d29b316,0x8000b38b
.long 0x0,0x0,0x0,0x0,0x0,0x0,0x0,0x0
.long 0x0,0x0,0x0,0x0,0x0,0x0,0x0,0x0
.long 0x0,0x0,0x0,0x0,0x0,0x0,0x0,0x0
.long 0x0,0x0,0x0,0x0,0x0,0x0,0x0,0x0
.long 0x0,0x0,0x0,0x0,0x0,0x0,0x0,0x0
.long 0x0,0x0,0x0,0x0,0x0,0x0,0x0,0x0
.long 0x0,0x0,0x0,0x0,0x0,0x0,0x0,0x0
.long 0x336e293d,0x3288af8b,0x30d931c7,0x336e293d,0x30d931c7,0x32882f8b,0xad29b316,0xb0d9b1c7
.long 0x0,0x0,0x0,0x0,0x0,0x0,0x0,0x0
.long 0x0,0x0,0x0,0x0,0x0,0x0,0x0,0x0
.long 0x0,0x0,0x0,0x0,0x0,0x0,0x0,0x0
.long 0x0,0x0,0x0,0x0,0x0,0x0,0x0,0x0
.long 0x0,0x0,0x0,0x0,0x0,0x0,0x0,0x0
.long 0x0,0x0,0x0,0x0,0x0,0x0,0x0,0x0
.long 0x0,0x0,0x0,0x0,0x0,0x0,0x0,0x0
.long 0x2d29b316,0xad29b316,0x3288af8b,0x2d29b316,0x336e293d,0x336ea93d,0xb288af8b,0xb36ea93d
.long 0x0,0x0,0x0,0x0,0x0,0x0,0x0,0x0
.long 0x0,0x0,0x0,0x0,0x0,0x0,0x0,0x0
.long 0x0,0x0,0x0,0x0,0x0,0x0,0x0,0x0
.long 0x0,0x0,0x0,0x0,0x0,0x0,0x0,0x0
.long 0x0,0x0,0x0,0x0,0x0,0x0,0x0,0x0
.long 0x0,0x0,0x0,0x0,0x0,0x0,0x0,0x0
.long 0x0,0x0,0x0,0x0,0x0,0x0,0x0,0x0
.long 0xb288af8b,0xb36e293d,0xad29b316,0xb288af8b,0x3288af8b,0x30d9b1c7,0xb36e293d,0xb2882f8b
.long 0x0,0x0,0x0,0x0,0x0,0x0,0x0,0x0
.long 0x0,0x0,0x0,0x0,0x0,0x0,0x0,0x0
.long 0x0,0x0,0x0,0x0,0x0,0x0,0x0,0x0
.long 0x0,0x0,0x0,0x0,0x0,0x0,0x0,0x0
.long 0x0,0x0,0x0,0x0,0x0,0x0,0x0,0x0
.long 0x0,0x0,0x0,0x0,0x0,0x0,0x0,0x0
.long 0x0,0x0,0x0,0x0,0x0,0x0,0x0,0x0
.long 0x338b0000,0x31c7b0d9,0x31c730d9,0x338b0000,0x338b0000,0x3316ad29,0xb316ad29,0xb38b0000
.long 0x0,0x0,0x0,0x0,0x0,0x0,0x0,0x0
.long 0x0,0x0,0x0,0x0,0x0,0x0,0x0,0x0
.long 0x0,0x0,0x0,0x0,0x0,0x0,0x0,0x0
.long 0x0,0x0,0x0,0x0,0x0,0x0,0x0,0x0
.long 0x0,0x0,0x0,0x0,0x0,0x0,0x0,0x0
.long 0x0,0x0,0x0,0x0,0x0,0x0,0x0,0x0
.long 0x0,0x0,0x0,0x0,0x0,0x0,0x0,0x0
.long 0x293db36e,0xaf8bb288,0x31c7b0d9,0x293db36e,0x31c7b0d9,0x2f8bb288,0xb3162d29,0xb1c730d9
.long 0x0,0x0,0x0,0x0,0x0,0x0,0x0,0x0
.long 0x0,0x0,0x0,0x0,0x0,0x0,0x0,0x0
.long 0x0,0x0,0x0,0x0,0x0,0x0,0x0,0x0
.long 0x0,0x0,0x0,0x0,0x0,0x0,0x0,0x0
.long 0x0,0x0,0x0,0x0,0x0,0x0,0x0,0x0
.long 0x0,0x0,0x0,0x0,0x0,0x0,0x0,0x0
.long 0x0,0x0,0x0,0x0,0x0,0x0,0x0,0x0
.long 0xb316ad29,0xb3162d29,0xaf8bb288,0xb316ad29,0x293db36e,0xa93db36e,0xaf8b3288,0xa93d336e
.long 0x0,0x0,0x0,0x0,0x0,0x0,0x0,0x0
.long 0x0,0x0,0x0,0x0,0x0,0x0,0x0,0x0
.long 0x0,0x0,0x0,0x0,0x0,0x0,0x0,0x0
.long 0x0,0x0,0x0,0x0,0x0,0x0,0x0,0x0
.long 0x0,0x0,0x0,0x0,0x0,0x0,0x0,0x0
.long 0x0,0x0,0x0,0x0,0x0,0x0,0x0,0x0
.long 0x0,0x0,0x0,0x0,0x0,0x0,0x0,0x0
.long 0xaf8b3288,0x293d336e,0xb3162d29,0xaf8b3288,0xaf8bb288,0xb1c7b0d9,0x293d336e,0x2f8b3288
.long 0x0,0x0,0x0,0x0,0x0,0x0,0x0,0x0
.long 0x0,0x0,0x0,0x0,0x0,0x0,0x0,0x0
.long 0x0,0x0,0x0,0x0,0x0,0x0,0x0,0x0
.long 0x0,0x0,0x0,0x0,0x0,0x0,0x0,0x0
.long 0x0,0x0,0x0,0x0,0x0,0x0,0x0,0x0
.long 0x0,0x0,0x0,0x0,0x0,0x0,0x0,0x0
.long 0x0,0x0,0x0,0x0,0x0,0x0,0x0,0x0
.long 0xb36e293d,0xb0d931c7,0x293d336e,0x31c730d9,0xb0d931c7,0xad293316,0x31c730d9,0x33162d29
.long 0x0,0x0,0x0,0x0,0x0,0x0,0x0,0x0
.long 0x0,0x0,0x0,0x0,0x0,0x0,0x0,0x0
.long 0x0,0x0,0x0,0x0,0x0,0x0,0x0,0x0
.long 0x0,0x0,0x0,0x0,0x0,0x0,0x0,0x0
.long 0x0,0x0,0x0,0x0,0x0,0x0,0x0,0x0
.long 0x0,0x0,0x0,0x0,0x0,0x0,0x0,0x0
.long 0x0,0x0,0x0,0x0,0x0,0x0,0x0,0x0
.long 0x8000338b,0x8000338b,0x338b0000,0x338b0000,0x8000338b,0x8000b38b,0x338b0000,0xb38b0000
.long 0x0,0x0,0x0,0x0,0x0,0x0,0x0,0x0
.long 0x0,0x0,0x0,0x0,0x0,0x0,0x0,0x0
.long 0x0,0x0,0x0,0x0,0x0,0x0,0x0,0x0
.long 0x0,0x0,0x0,0x0,0x0,0x0,0x0,0x0
.long 0x0,0x0,0x0,0x0,0x0,0x0,0x0,0x0
.long 0x0,0x0,0x0,0x0,0x0,0x0,0x0,0x0
.long 0x0,0x0,0x0,0x0,0x0,0x0,0x0,0x0
.long 0x0,0x0,0x0,0x0,0x0,0x0,0x0,0x0
.long 0x0,0x0,0x0,0x0,0x0,0x0,0x0,0x0
.long 0x0,0x0,0x0,0x0,0x0,0x0,0x0,0x0
.long 0x0,0x0,0x0,0x0,0x0,0x0,0x0,0x0
.long 0x0,0x0,0x0,0x0,0x0,0x0,0x0,0x0
.long 0x0,0x0,0x0,0x0,0x0,0x0,0x0,0x0
.long 0x0,0x0,0x0,0x0,0x0,0x0,0x0,0x0
.long 0x0,0x0,0x0,0x0,0x0,0x0,0x0,0x0
.long 0x0,0x0,0x0,0x0,0x0,0x0,0x0,0x0
.long 0x0,0x0,0x0,0x0,0x0,0x0,0x0,0x0
.long 0x0,0x0,0x0,0x0,0x0,0x0,0x0,0x0
.long 0x0,0x0,0x0,0x0,0x0,0x0,0x0,0x0
.long 0x0,0x0,0x0,0x0,0x0,0x0,0x0,0x0
.long 0x0,0x0,0x0,0x0,0x0,0x0,0x0,0x0
.long 0x0,0x0,0x0,0x0,0x0,0x0,0x0,0x0
.long 0x0,0x0,0x0,0x0,0x0,0x0,0x0,0x0
.long 0x3e000000,0x3ec00000,0x3f600000,0x3e000000,0x3f600000,0x3e000000,0x3f200000,0x3f600000
.long 0x3f600000,0x3e000000,0x3e000000,0x3ec00000,0x3e000000,0x3ec00000,0x3ec00000,0x3f200000
.long 0x3e000000,0x3ec00000,0x0,0x3e800000,0x3f600000,0x3e000000,0x3f400000,0x0
.long 0x3f600000,0x3e000000,0x3e800000,0x3f000000,0x3e000000,0x3ec00000,0x3f000000,0x3f400000
.long 0x3e000000,0x3ec00000,0x3e000000,0x3ec00000,0x3f600000,0x3e000000,0x3f600000,0x3e000000
.long 0x3f600000,0x3e000000,0x3ec00000,0x3f200000,0x3e000000,0x3ec00000,0x3f200000,0x3f600000
.long 0x3e000000,0x3ec00000,0x3e800000,0x3f000000,0x3f600000,0x3e000000,0x0,0x3e800000
.long 0x3f600000,0x3e000000,0x3f000000,0x3f400000,0x3e000000,0x3ec00000,0x3f400000,0x0
.long 0x3e000000,0x3ec00000,0x3f600000,0x3e000000,0x3f600000,0x3e000000,0x3f200000,0x3f600000
.long 0x3f600000,0x3e000000,0x3e000000,0x3ec00000,0x3e000000,0x3ec00000,0x3ec00000,0x3f200000
.long 0x3ec00000,0x3f200000,0x3e800000,0x3f000000,0x3e000000,0x3ec00000,0x0,0x3e800000
.long 0x3e000000,0x3ec00000,0x3f000000,0x3f400000,0x3ec00000,0x3f200000,0x3f400000,0x0
.long 0x3f200000,0x3f600000,0x3f200000,0x3f600000,0x3ec00000,0x3f200000,0x3ec00000,0x3f200000
.long 0x3ec00000,0x3f200000,0x3f600000,0x3e000000,0x3f200000,0x3f600000,0x3e000000,0x3ec00000
.long 0x3f600000,0x3e000000,0x0,0x3e800000,0x3f200000,0x3f600000,0x3f400000,0x0
.long 0x3f200000,0x3f600000,0x3e800000,0x3f000000,0x3f600000,0x3e000000,0x3f000000,0x3f400000
.long 0x3e000000,0x3ec00000,0x3f600000,0x3e000000,0x3f600000,0x3e000000,0x3f200000,0x3f600000
.long 0x3f600000,0x3e000000,0x3e000000,0x3ec00000,0x3e000000,0x3ec00000,0x3ec00000,0x3f200000
.long 0x3f200000,0x3f600000,0x3f000000,0x3f400000,0x3ec00000,0x3f200000,0x3e800000,0x3f000000
.long 0x3ec00000,0x3f200000,0x3f400000,0x0,0x3f200000,0x3f600000,0x0,0x3e800000
.long 0x3e000000,0x3ec00000,0x3e000000,0x3ec00000,0x3f600000,0x3e000000,0x3f600000,0x3e000000
.long 0x3f600000,0x3e000000,0x3ec00000,0x3f200000,0x3e000000,0x3ec00000,0x3f200000,0x3f600000
.long 0x3f200000,0x3f600000,0x3f400000,0x0,0x3ec00000,0x3f200000,0x3f000000,0x3f400000
.long 0x3ec00000,0x3f200000,0x0,0x3e800000,0x3f200000,0x3f600000,0x3e800000,0x3f000000
.long 0x3e000000,0x3ec00000,0x3f600000,0x3e000000,0x3f600000,0x3e000000,0x3f200000,0x3f600000
.long 0x3f600000,0x3e000000,0x3e000000,0x3ec00000,0x3e000000,0x3ec00000,0x3ec00000,0x3f200000
.long 0x3f600000,0x3e000000,0x3f400000,0x0,0x3f200000,0x3f600000,0x3f000000,0x3f400000
.long 0x3f200000,0x3f600000,0x0,0x3e800000,0x3f600000,0x3e000000,0x3e800000,0x3f000000
.long 0x3f200000,0x3f600000,0x3f200000,0x3f600000,0x3ec00000,0x3f200000,0x3ec00000,0x3f200000
.long 0x3ec00000,0x3f200000,0x3f600000,0x3e000000,0x3f200000,0x3f600000,0x3e000000,0x3ec00000
.long 0x3ec00000,0x3f200000,0x3f000000,0x3f400000,0x3e000000,0x3ec00000,0x3e800000,0x3f000000
.long 0x3e000000,0x3ec00000,0x3f400000,0x0,0x3ec00000,0x3f200000,0x0,0x3e800000
.long 0x0,0x0,0x0,0x0,0x0,0x0,0x0,0x0
.long 0x0,0x0,0x0,0x0,0x0,0x0,0x0,0x0
.long 0x0,0x0,0x0,0x0,0x0,0x0,0x0,0x0
.long 0x0,0x0,0x0,0x0,0x0,0x0,0x0,0x0
.long 0x0,0x0,0x0,0x0,0x0,0x0,0x0,0x0
.long 0x0,0x0,0x0,0x0,0x0,0x0,0x0,0x0
.long 0x0,0x0,0x0,0x0,0x0,0x0,0x0,0x0
.long 0x0,0x0,0x0,0x0,0x0,0x0,0x0,0x0
.long 0x0,0x0,0x0,0x0,0x0,0x0,0x0,0x0
.long 0x0,0x0,0x0,0x0,0x0,0x0,0x0,0x0
.long 0x0,0x0,0x0,0x0,0x0,0x0,0x0,0x0
.long 0x0,0x0,0x0,0x0,0x0,0x0,0x0,0x0
.long 0x0,0x0,0x0,0x0,0x0,0x0,0x0,0x0
.long 0x0,0x0,0x0,0x0,0x0,0x0,0x0,0x0
.long 0x0,0x0,0x0,0x0,0x0,0x0,0x0,0x0
.long 0x0,0x0,0x0,0x0,0x0,0x0,0x0,0x0
.long 0x0,0x0,0x0,0x0,0x0,0x0,0x0,0x0
.long 0x0,0x0,0x0,0x0,0x0,0x0,0x0,0x0
.long 0x0,0x0,0x0,0x0,0x0,0x0,0x0,0x0
.long 0x0,0x0,0x0,0x0,0x0,0x0,0x0,0x0
.long 0x0,0x0,0x0,0x0,0x0,0x0,0x0,0x0
.long 0x0,0x0,0x0,0x0,0x0,0x0,0x0,0x0
.long 0x0,0x0,0x0,0x0,0x0,0x0,0x0,0x0
.long 0x0,0x0,0x0,0x0,0x0,0x0,0x0,0x0
.long 0x0,0x0,0x0,0x0,0x0,0x0,0x0,0x0
.long 0x0,0x0,0x0,0x0,0x0,0x0,0x0,0x0
.long 0x0,0x0,0x0,0x0,0x0,0x0,0x0,0x0
.long 0x0,0x0,0x0,0x0,0x0,0x0,0x0,0x0
.long 0x0,0x0,0x0,0x0,0x0,0x0,0x0,0x0
.long 0x0,0x0,0x0,0x0,0x0,0x0,0x0,0x0
.long 0x0,0x0,0x0,0x0,0x0,0x0,0x0,0x0
.long 0x0,0x0,0x0,0x0,0x0,0x0,0x0,0x0
.long 0x31a831a8,0x31a831a8,0x31a831a8,0x31a831a8,0x318c31a8,0x30b4313a,0x2e493000,0x286a2c54
.long 0x313a31a8,0x2c543000,0xac540000,0xb13ab000,0x30b431a8,0xa86a2c54,0xb18cb000,0xae49b13a
.long 0x300031a8,0xb0000000,0xb000b1a8,0x30008000,0x2e4931a8,0xb18cac54,0x286ab000,0x30b4313a
.long 0x2c5431a8,0xb13ab000,0x313a8000,0xac543000,0x286a31a8,0xae49b13a,0x30b43000,0xb18cac54
.long 0x31a8,0x8000b1a8,0x31a8,0x8000b1a8,0xa86a31a8,0x2e49b13a,0xb0b43000,0x318cac54
.long 0xac5431a8,0x313ab000,0xb13a0000,0x2c543000,0xae4931a8,0x318cac54,0xa86ab000,0xb0b4313a
.long 0xb00031a8,0x30008000,0x3000b1a8,0xb0000000,0xb0b431a8,0x286a2c54,0x318cb000,0x2e49b13a
.long 0xb13a31a8,0xac543000,0x2c548000,0x313ab000,0xb18c31a8,0xb0b4313a,0xae493000,0xa86a2c54
.long 0x31a831a8,0x31a831a8,0x31a831a8,0x31a831a8,0xa86a0000,0xae49ac54,0xb0b4b000,0xb18cb13a
.long 0xb13ab1a8,0xac54b000,0x2c548000,0x313a3000,0x2e498000,0x318c313a,0x286a3000,0xb0b4ac54
.long 0x300031a8,0xb0000000,0xb000b1a8,0x30008000,0xb0b40000,0xa86ab13a,0x318c3000,0xae492c54
.long 0xac54b1a8,0x313a3000,0xb13a0000,0x2c54b000,0x318c8000,0xb0b42c54,0x2e49b000,0xa86a313a
.long 0x31a8,0x8000b1a8,0x31a8,0x8000b1a8,0xb18c0000,0x30b42c54,0xae49b000,0x286a313a
.long 0x2c54b1a8,0xb13a3000,0x313a8000,0xac54b000,0x30b48000,0x286ab13a,0xb18c3000,0x2e492c54
.long 0xb00031a8,0x30008000,0x3000b1a8,0xb0000000,0xae490000,0xb18c313a,0xa86a3000,0x30b4ac54
.long 0x313ab1a8,0x2c54b000,0xac540000,0xb13a3000,0x286a8000,0x2e49ac54,0x30b4b000,0x318cb13a
.long 0x31a831a8,0x31a831a8,0x31a831a8,0x31a831a8,0xb18cb1a8,0xb0b4b13a,0xae49b000,0xa86aac54
.long 0x313a31a8,0x2c543000,0xac540000,0xb13ab000,0xb0b4b1a8,0x286aac54,0x318c3000,0x2e49313a
.long 0x300031a8,0xb0000000,0xb000b1a8,0x30008000,0xae49b1a8,0x318c2c54,0xa86a3000,0xb0b4b13a
.long 0x2c5431a8,0xb13ab000,0x313a8000,0xac543000,0xa86ab1a8,0x2e49313a,0xb0b4b000,0x318c2c54
.long 0x31a8,0x8000b1a8,0x31a8,0x8000b1a8,0x286ab1a8,0xae49313a,0x30b4b000,0xb18c2c54
.long 0xac5431a8,0x313ab000,0xb13a0000,0x2c543000,0x2e49b1a8,0xb18c2c54,0x286a3000,0x30b4b13a
.long 0xb00031a8,0x30008000,0x3000b1a8,0xb0000000,0x30b4b1a8,0xa86aac54,0xb18c3000,0xae49313a
.long 0xb13a31a8,0xac543000,0x2c548000,0x313ab000,0x318cb1a8,0x30b4b13a,0x2e49b000,0x286aac54
.long 0x31a831a8,0x31a831a8,0x31a831a8,0x31a831a8,0x286a8000,0x2e492c54,0x30b43000,0x318c313a
.long 0xb13ab1a8,0xac54b000,0x2c548000,0x313a3000,0xae490000,0xb18cb13a,0xa86ab000,0x30b42c54
.long 0x300031a8,0xb0000000,0xb000b1a8,0x30008000,0x30b48000,0x286a313a,0xb18cb000,0x2e49ac54
.long 0xac54b1a8,0x313a3000,0xb13a0000,0x2c54b000,0xb18c0000,0x30b4ac54,0xae493000,0x286ab13a
.long 0x31a8,0x8000b1a8,0x31a8,0x8000b1a8,0x318c8000,0xb0b4ac54,0x2e493000,0xa86ab13a
.long 0x2c54b1a8,0xb13a3000,0x313a8000,0xac54b000,0xb0b40000,0xa86a313a,0x318cb000,0xae49ac54
.long 0xb00031a8,0x30008000,0x3000b1a8,0xb0000000,0x2e498000,0x318cb13a,0x286ab000,0xb0b42c54
.long 0x313ab1a8,0x2c54b000,0xac540000,0xb13a3000,0xa86a0000,0xae492c54,0xb0b43000,0xb18c313a
.long 0x0,0x0,0x0,0x0,0x286a0000,0x2e492c54,0x30b43000,0x318c313a
.long 0x2c540000,0x313a3000,0x313a31a8,0x2c543000,0x2e490000,0x318c313a,0x286a3000,0xb0b4ac54
.long 0x30000000,0x300031a8,0xb0000000,0xb000b1a8,0x30b40000,0x286a313a,0xb18cb000,0x2e49ac54
.long 0x313a0000,0xac543000,0xac54b1a8,0x313a3000,0x318c0000,0xb0b42c54,0x2e49b000,0xa86a313a
.long 0x31a80000,0xb1a80000,0x31a80000,0xb1a80000,0x318c0000,0xb0b4ac54,0x2e493000,0xa86ab13a
.long 0x313a0000,0xac54b000,0xac5431a8,0x313ab000,0x30b40000,0x286ab13a,0xb18c3000,0x2e492c54
.long 0x30000000,0x3000b1a8,0xb0000000,0xb00031a8,0x2e490000,0x318cb13a,0x286ab000,0xb0b42c54
.long 0x2c540000,0x313ab000,0x313ab1a8,0x2c54b000,0x286a0000,0x2e49ac54,0x30b4b000,0x318cb13a
.long 0x0,0x0,0x0,0x0,0x318c31a8,0x30b4313a,0x2e493000,0x286a2c54
.long 0xac540000,0xb13ab000,0xb13ab1a8,0xac54b000,0xb0b4b1a8,0x286aac54,0x318c3000,0x2e49313a
.long 0x30000000,0x300031a8,0xb0000000,0xb000b1a8,0x2e4931a8,0xb18cac54,0x286ab000,0x30b4313a
.long 0xb13a0000,0x2c54b000,0x2c5431a8,0xb13ab000,0xa86ab1a8,0x2e49313a,0xb0b4b000,0x318c2c54
.long 0x31a80000,0xb1a80000,0x31a80000,0xb1a80000,0xa86a31a8,0x2e49b13a,0xb0b43000,0x318cac54
.long 0xb13a0000,0x2c543000,0x2c54b1a8,0xb13a3000,0x2e49b1a8,0xb18c2c54,0x286a3000,0x30b4b13a
.long 0x30000000,0x3000b1a8,0xb0000000,0xb00031a8,0xb0b431a8,0x286a2c54,0x318cb000,0x2e49b13a
.long 0xac540000,0xb13a3000,0xb13a31a8,0xac543000,0x318cb1a8,0x30b4b13a,0x2e49b000,0x286aac54
.long 0x0,0x0,0x0,0x0,0xa86a0000,0xae49ac54,0xb0b4b000,0xb18cb13a
.long 0x2c540000,0x313a3000,0x313a31a8,0x2c543000,0xae490000,0xb18cb13a,0xa86ab000,0x30b42c54
.long 0x30000000,0x300031a8,0xb0000000,0xb000b1a8,0xb0b40000,0xa86ab13a,0x318c3000,0xae492c54
.long 0x313a0000,0xac543000,0xac54b1a8,0x313a3000,0xb18c0000,0x30b4ac54,0xae493000,0x286ab13a
.long 0x31a80000,0xb1a80000,0x31a80000,0xb1a80000,0xb18c0000,0x30b42c54,0xae49b000,0x286a313a
.long 0x313a0000,0xac54b000,0xac5431a8,0x313ab000,0xb0b40000,0xa86a313a,0x318cb000,0xae49ac54
.long 0x30000000,0x3000b1a8,0xb0000000,0xb00031a8,0xae490000,0xb18c313a,0xa86a3000,0x30b4ac54
.long 0x2c540000,0x313ab000,0x313ab1a8,0x2c54b000,0xa86a0000,0xae492c54,0xb0b43000,0xb18c313a
.long 0x0,0x0,0x0,0x0,0xb18cb1a8,0xb0b4b13a,0xae49b000,0xa86aac54
.long 0xac540000,0xb13ab000,0xb13ab1a8,0xac54b000,0x30b431a8,0xa86a2c54,0xb18cb000,0xae49b13a
.long 0x30000000,0x300031a8,0xb0000000,0xb000b1a8,0xae49b1a8,0x318c2c54,0xa86a3000,0xb0b4b13a
.long 0xb13a0000,0x2c54b000,0x2c5431a8,0xb13ab000,0x286a31a8,0xae49b13a,0x30b43000,0xb18cac54
.long 0x31a80000,0xb1a80000,0x31a80000,0xb1a80000,0x286ab1a8,0xae49313a,0x30b4b000,0xb18c2c54
.long 0xb13a0000,0x2c543000,0x2c54b1a8,0xb13a3000,0xae4931a8,0x318cac54,0xa86ab000,0xb0b4313a
.long 0x30000000,0x3000b1a8,0xb0000000,0xb00031a8,0x30b4b1a8,0xa86aac54,0xb18c3000,0xae49313a
.long 0xac540000,0xb13a3000,0xb13a31a8,0xac543000,0xb18c31a8,0xb0b4313a,0xae493000,0xa86a2c54
.long 0x80008000,0x80008000,0x80008000,0x80008000,0xa86a8000,0xae49ac54,0xb0b4b000,0xb18cb13a
.long 0xac548000,0xb13ab000,0xb13ab1a8,0xac54b000,0xae498000,0xb18cb13a,0xa86ab000,0x30b42c54
.long 0xb0008000,0xb000b1a8,0x30008000,0x300031a8,0xb0b48000,0xa86ab13a,0x318c3000,0xae492c54
.long 0xb13a8000,0x2c54b000,0x2c5431a8,0xb13ab000,0xb18c8000,0x30b4ac54,0xae493000,0x286ab13a
.long 0xb1a88000,0x31a88000,0xb1a88000,0x31a88000,0xb18c8000,0x30b42c54,0xae49b000,0x286a313a
.long 0xb13a8000,0x2c543000,0x2c54b1a8,0xb13a3000,0xb0b48000,0xa86a313a,0x318cb000,0xae49ac54
.long 0xb0008000,0xb00031a8,0x30008000,0x3000b1a8,0xae498000,0xb18c313a,0xa86a3000,0x30b4ac54
.long 0xac548000,0xb13a3000,0xb13a31a8,0xac543000,0xa86a8000,0xae492c54,0xb0b43000,0xb18c313a
.long 0x80008000,0x80008000,0x80008000,0x80008000,0xb18cb1a8,0xb0b4b13a,0xae49b000,0xa86aac54
.long 0x2c548000,0x313a3000,0x313a31a8,0x2c543000,0x30b431a8,0xa86a2c54,0xb18cb000,0xae49b13a
.long 0xb0008000,0xb000b1a8,0x30008000,0x300031a8,0xae49b1a8,0x318c2c54,0xa86a3000,0xb0b4b13a
.long 0x313a8000,0xac543000,0xac54b1a8,0x313a3000,0x286a31a8,0xae49b13a,0x30b43000,0xb18cac54
.long 0xb1a88000,0x31a88000,0xb1a88000,0x31a88000,0x286ab1a8,0xae49313a,0x30b4b000,0xb18c2c54
.long 0x313a8000,0xac54b000,0xac5431a8,0x313ab000,0xae4931a8,0x318cac54,0xa86ab000,0xb0b4313a
.long 0xb0008000,0xb00031a8,0x30008000,0x3000b1a8,0x30b4b1a8,0xa86aac54,0xb18c3000,0xae49313a
.long 0x2c548000,0x313ab000,0x313ab1a8,0x2c54b000,0xb18c31a8,0xb0b4313a,0xae493000,0xa86a2c54
.long 0x80008000,0x80008000,0x80008000,0x80008000,0x286a8000,0x2e492c54,0x30b43000,0x318c313a
.long 0xac548000,0xb13ab000,0xb13ab1a8,0xac54b000,0x2e498000,0x318c313a,0x286a3000,0xb0b4ac54
.long 0xb0008000,0xb000b1a8,0x30008000,0x300031a8,0x30b48000,0x286a313a,0xb18cb000,0x2e49ac54
.long 0xb13a8000,0x2c54b000,0x2c5431a8,0xb13ab000,0x318c8000,0xb0b42c54,0x2e49b000,0xa86a313a
.long 0xb1a88000,0x31a88000,0xb1a88000,0x31a88000,0x318c8000,0xb0b4ac54,0x2e493000,0xa86ab13a
.long 0xb13a8000,0x2c543000,0x2c54b1a8,0xb13a3000,0x30b48000,0x286ab13a,0xb18c3000,0x2e492c54
.long 0xb0008000,0xb00031a8,0x30008000,0x3000b1a8,0x2e498000,0x318cb13a,0x286ab000,0xb0b42c54
.long 0xac548000,0xb13a3000,0xb13a31a8,0xac543000,0x286a8000,0x2e49ac54,0x30b4b000,0x318cb13a
.long 0x80008000,0x80008000,0x80008000,0x80008000,0x318c31a8,0x30b4313a,0x2e493000,0x286a2c54
.long 0x2c548000,0x313a3000,0x313a31a8,0x2c543000,0xb0b4b1a8,0x286aac54,0x318c3000,0x2e49313a
.long 0xb0008000,0xb000b1a8,0x30008000,0x300031a8,0x2e4931a8,0xb18cac54,0x286ab000,0x30b4313a
.long 0x313a8000,0xac543000,0xac54b1a8,0x313a3000,0xa86ab1a8,0x2e49313a,0xb0b4b000,0x318c2c54
.long 0xb1a88000,0x31a88000,0xb1a88000,0x31a88000,0xa86a31a8,0x2e49b13a,0xb0b43000,0x318cac54
.long 0x313a8000,0xac54b000,0xac5431a8,0x313ab000,0x2e49b1a8,0xb18c2c54,0x286a3000,0x30b4b13a
.long 0xb0008000,0xb00031a8,0x30008000,0x3000b1a8,0xb0b431a8,0x286a2c54,0x318cb000,0x2e49b13a
.long 0x2c548000,0x313ab000,0x313ab1a8,0x2c54b000,0x318cb1a8,0x30b4b13a,0x2e49b000,0x286aac54
.long 0xb1a831a8,0xb1a831a8,0xb1a831a8,0xb1a831a8,0xb18c31a8,0xb0b4313a,0xae493000,0xa86a2c54
.long 0xb13a31a8,0xac543000,0x2c540000,0x313ab000,0xb0b431a8,0x286a2c54,0x318cb000,0x2e49b13a
.long 0xb00031a8,0x30000000,0x3000b1a8,0xb0008000,0xae4931a8,0x318cac54,0xa86ab000,0xb0b4313a
.long 0xac5431a8,0x313ab000,0xb13a8000,0x2c543000,0xa86a31a8,0x2e49b13a,0xb0b43000,0x318cac54
.long 0x800031a8,0xb1a8,0x800031a8,0xb1a8,0x286a31a8,0xae49b13a,0x30b43000,0xb18cac54
.long 0x2c5431a8,0xb13ab000,0x313a0000,0xac543000,0x2e4931a8,0xb18cac54,0x286ab000,0x30b4313a
.long 0x300031a8,0xb0008000,0xb000b1a8,0x30000000,0x30b431a8,0xa86a2c54,0xb18cb000,0xae49b13a
.long 0x313a31a8,0x2c543000,0xac548000,0xb13ab000,0x318c31a8,0x30b4313a,0x2e493000,0x286a2c54
.long 0xb1a831a8,0xb1a831a8,0xb1a831a8,0xb1a831a8,0x286a0000,0x2e49ac54,0x30b4b000,0x318cb13a
.long 0x313ab1a8,0x2c54b000,0xac548000,0xb13a3000,0xae498000,0xb18c313a,0xa86a3000,0x30b4ac54
.long 0xb00031a8,0x30000000,0x3000b1a8,0xb0008000,0x30b40000,0x286ab13a,0xb18c3000,0x2e492c54
.long 0x2c54b1a8,0xb13a3000,0x313a0000,0xac54b000,0xb18c8000,0x30b42c54,0xae49b000,0x286a313a
.long 0x800031a8,0xb1a8,0x800031a8,0xb1a8,0x318c0000,0xb0b42c54,0x2e49b000,0xa86a313a
.long 0xac54b1a8,0x313a3000,0xb13a8000,0x2c54b000,0xb0b48000,0xa86ab13a,0x318c3000,0xae492c54
.long 0x300031a8,0xb0008000,0xb000b1a8,0x30000000,0x2e490000,0x318c313a,0x286a3000,0xb0b4ac54
.long 0xb13ab1a8,0xac54b000,0x2c540000,0x313a3000,0xa86a8000,0xae49ac54,0xb0b4b000,0xb18cb13a
.long 0xb1a831a8,0xb1a831a8,0xb1a831a8,0xb1a831a8,0x318cb1a8,0x30b4b13a,0x2e49b000,0x286aac54
.long 0xb13a31a8,0xac543000,0x2c540000,0x313ab000,0x30b4b1a8,0xa86aac54,0xb18c3000,0xae49313a
.long 0xb00031a8,0x30000000,0x3000b1a8,0xb0008000,0x2e49b1a8,0xb18c2c54,0x286a3000,0x30b4b13a
.long 0xac5431a8,0x313ab000,0xb13a8000,0x2c543000,0x286ab1a8,0xae49313a,0x30b4b000,0xb18c2c54
.long 0x800031a8,0xb1a8,0x800031a8,0xb1a8,0xa86ab1a8,0x2e49313a,0xb0b4b000,0x318c2c54
.long 0x2c5431a8,0xb13ab000,0x313a0000,0xac543000,0xae49b1a8,0x318c2c54,0xa86a3000,0xb0b4b13a
.long 0x300031a8,0xb0008000,0xb000b1a8,0x30000000,0xb0b4b1a8,0x286aac54,0x318c3000,0x2e49313a
.long 0x313a31a8,0x2c543000,0xac548000,0xb13ab000,0xb18cb1a8,0xb0b4b13a,0xae49b000,0xa86aac54
.long 0xb1a831a8,0xb1a831a8,0xb1a831a8,0xb1a831a8,0xa86a8000,0xae492c54,0xb0b43000,0xb18c313a
.long 0x313ab1a8,0x2c54b000,0xac548000,0xb13a3000,0x2e490000,0x318cb13a,0x286ab000,0xb0b42c54
.long 0xb00031a8,0x30000000,0x3000b1a8,0xb0008000,0xb0b48000,0xa86a313a,0x318cb000,0xae49ac54
.long 0x2c54b1a8,0xb13a3000,0x313a0000,0xac54b000,0x318c0000,0xb0b4ac54,0x2e493000,0xa86ab13a
.long 0x800031a8,0xb1a8,0x800031a8,0xb1a8,0xb18c8000,0x30b4ac54,0xae493000,0x286ab13a
.long 0xac54b1a8,0x313a3000,0xb13a8000,0x2c54b000,0x30b40000,0x286a313a,0xb18cb000,0x2e49ac54
.long 0x300031a8,0xb0008000,0xb000b1a8,0x30000000,0xae498000,0xb18cb13a,0xa86ab000,0x30b42c54
.long 0xb13ab1a8,0xac54b000,0x2c540000,0x313a3000,0x286a0000,0x2e492c54,0x30b43000,0x318c313a
.long 0x0,0x0,0x0,0x0,0xa86a0000,0xae492c54,0xb0b43000,0xb18c313a
.long 0xac540000,0xb13a3000,0xb13a31a8,0xac543000,0xae490000,0xb18c313a,0xa86a3000,0x30b4ac54
.long 0xb0000000,0xb00031a8,0x30000000,0x3000b1a8,0xb0b40000,0xa86a313a,0x318cb000,0xae49ac54
.long 0xb13a0000,0x2c543000,0x2c54b1a8,0xb13a3000,0xb18c0000,0x30b42c54,0xae49b000,0x286a313a
.long 0xb1a80000,0x31a80000,0xb1a80000,0x31a80000,0xb18c0000,0x30b4ac54,0xae493000,0x286ab13a
.long 0xb13a0000,0x2c54b000,0x2c5431a8,0xb13ab000,0xb0b40000,0xa86ab13a,0x318c3000,0xae492c54
.long 0xb0000000,0xb000b1a8,0x30000000,0x300031a8,0xae490000,0xb18cb13a,0xa86ab000,0x30b42c54
.long 0xac540000,0xb13ab000,0xb13ab1a8,0xac54b000,0xa86a0000,0xae49ac54,0xb0b4b000,0xb18cb13a
.long 0x0,0x0,0x0,0x0,0xb18c31a8,0xb0b4313a,0xae493000,0xa86a2c54
.long 0x2c540000,0x313ab000,0x313ab1a8,0x2c54b000,0x30b4b1a8,0xa86aac54,0xb18c3000,0xae49313a
.long 0xb0000000,0xb00031a8,0x30000000,0x3000b1a8,0xae4931a8,0x318cac54,0xa86ab000,0xb0b4313a
.long 0x313a0000,0xac54b000,0xac5431a8,0x313ab000,0x286ab1a8,0xae49313a,0x30b4b000,0xb18c2c54
.long 0xb1a80000,0x31a80000,0xb1a80000,0x31a80000,0x286a31a8,0xae49b13a,0x30b43000,0xb18cac54
.long 0x313a0000,0xac543000,0xac54b1a8,0x313a3000,0xae49b1a8,0x318c2c54,0xa86a3000,0xb0b4b13a
.long 0xb0000000,0xb000b1a8,0x30000000,0x300031a8,0x30b431a8,0xa86a2c54,0xb18cb000,0xae49b13a
.long 0x2c540000,0x313a3000,0x313a31a8,0x2c543000,0xb18cb1a8,0xb0b4b13a,0xae49b000,0xa86aac54
.long 0x0,0x0,0x0,0x0,0x286a0000,0x2e49ac54,0x30b4b000,0x318cb13a
.long 0xac540000,0xb13a3000,0xb13a31a8,0xac543000,0x2e490000,0x318cb13a,0x286ab000,0xb0b42c54
.long 0xb0000000,0xb00031a8,0x30000000,0x3000b1a8,0x30b40000,0x286ab13a,0xb18c3000,0x2e492c54
.long 0xb13a0000,0x2c543000,0x2c54b1a8,0xb13a3000,0x318c0000,0xb0b4ac54,0x2e493000,0xa86ab13a
.long 0xb1a80000,0x31a80000,0xb1a80000,0x31a80000,0x318c0000,0xb0b42c54,0x2e49b000,0xa86a313a
.long 0xb13a0000,0x2c54b000,0x2c5431a8,0xb13ab000,0x30b40000,0x286a313a,0xb18cb000,0x2e49ac54
.long 0xb0000000,0xb000b1a8,0x30000000,0x300031a8,0x2e490000,0x318c313a,0x286a3000,0xb0b4ac54
.long 0xac540000,0xb13ab000,0xb13ab1a8,0xac54b000,0x286a0000,0x2e492c54,0x30b43000,0x318c313a
.long 0x0,0x0,0x0,0x0,0x318cb1a8,0x30b4b13a,0x2e49b000,0x286aac54
.long 0x2c540000,0x313ab000,0x313ab1a8,0x2c54b000,0xb0b431a8,0x286a2c54,0x318cb000,0x2e49b13a
.long 0xb0000000,0xb00031a8,0x30000000,0x3000b1a8,0x2e49b1a8,0xb18c2c54,0x286a3000,0x30b4b13a
.long 0x313a0000,0xac54b000,0xac5431a8,0x313ab000,0xa86a31a8,0x2e49b13a,0xb0b43000,0x318cac54
.long 0xb1a80000,0x31a80000,0xb1a80000,0x31a80000,0xa86ab1a8,0x2e49313a,0xb0b4b000,0x318c2c54
.long 0x313a0000,0xac543000,0xac54b1a8,0x313a3000,0x2e4931a8,0xb18cac54,0x286ab000,0x30b4313a
.long 0xb0000000,0xb000b1a8,0x30000000,0x300031a8,0xb0b4b1a8,0x286aac54,0x318c3000,0x2e49313a
.long 0x2c540000,0x313a3000,0x313a31a8,0x2c543000,0x318c31a8,0x30b4313a,0x2e493000,0x286a2c54
.long 0x80008000,0x80008000,0x80008000,0x80008000,0x286a8000,0x2e49ac54,0x30b4b000,0x318cb13a
.long 0x2c548000,0x313ab000,0x313ab1a8,0x2c54b000,0x2e498000,0x318cb13a,0x286ab000,0xb0b42c54
.long 0x30008000,0x3000b1a8,0xb0008000,0xb00031a8,0x30b48000,0x286ab13a,0xb18c3000,0x2e492c54
.long 0x313a8000,0xac54b000,0xac5431a8,0x313ab000,0x318c8000,0xb0b4ac54,0x2e493000,0xa86ab13a
.long 0x31a88000,0xb1a88000,0x31a88000,0xb1a88000,0x318c8000,0xb0b42c54,0x2e49b000,0xa86a313a
.long 0x313a8000,0xac543000,0xac54b1a8,0x313a3000,0x30b48000,0x286a313a,0xb18cb000,0x2e49ac54
.long 0x30008000,0x300031a8,0xb0008000,0xb000b1a8,0x2e498000,0x318c313a,0x286a3000,0xb0b4ac54
.long 0x2c548000,0x313a3000,0x313a31a8,0x2c543000,0x286a8000,0x2e492c54,0x30b43000,0x318c313a
.long 0x80008000,0x80008000,0x80008000,0x80008000,0x318cb1a8,0x30b4b13a,0x2e49b000,0x286aac54
.long 0xac548000,0xb13a3000,0xb13a31a8,0xac543000,0xb0b431a8,0x286a2c54,0x318cb000,0x2e49b13a
.long 0x30008000,0x3000b1a8,0xb0008000,0xb00031a8,0x2e49b1a8,0xb18c2c54,0x286a3000,0x30b4b13a
.long 0xb13a8000,0x2c543000,0x2c54b1a8,0xb13a3000,0xa86a31a8,0x2e49b13a,0xb0b43000,0x318cac54
.long 0x31a88000,0xb1a88000,0x31a88000,0xb1a88000,0xa86ab1a8,0x2e49313a,0xb0b4b000,0x318c2c54
.long 0xb13a8000,0x2c54b000,0x2c5431a8,0xb13ab000,0x2e4931a8,0xb18cac54,0x286ab000,0x30b4313a
.long 0x30008000,0x300031a8,0xb0008000,0xb000b1a8,0xb0b4b1a8,0x286aac54,0x318c3000,0x2e49313a
.long 0xac548000,0xb13ab000,0xb13ab1a8,0xac54b000,0x318c31a8,0x30b4313a,0x2e493000,0x286a2c54
.long 0x80008000,0x80008000,0x80008000,0x80008000,0xa86a8000,0xae492c54,0xb0b43000,0xb18c313a
.long 0x2c548000,0x313ab000,0x313ab1a8,0x2c54b000,0xae498000,0xb18c313a,0xa86a3000,0x30b4ac54
.long 0x30008000,0x3000b1a8,0xb0008000,0xb00031a8,0xb0b48000,0xa86a313a,0x318cb000,0xae49ac54
.long 0x313a8000,0xac54b000,0xac5431a8,0x313ab000,0xb18c8000,0x30b42c54,0xae49b000,0x286a313a
.long 0x31a88000,0xb1a88000,0x31a88000,0xb1a88000,0xb18c8000,0x30b4ac54,0xae493000,0x286ab13a
.long 0x313a8000,0xac543000,0xac54b1a8,0x313a3000,0xb0b48000,0xa86ab13a,0x318c3000,0xae492c54
.long 0x30008000,0x300031a8,0xb0008000,0xb000b1a8,0xae498000,0xb18cb13a,0xa86ab000,0x30b42c54
.long 0x2c548000,0x313a3000,0x313a31a8,0x2c543000,0xa86a8000,0xae49ac54,0xb0b4b000,0xb18cb13a
.long 0x80008000,0x80008000,0x80008000,0x80008000,0xb18c31a8,0xb0b4313a,0xae493000,0xa86a2c54
.long 0xac548000,0xb13a3000,0xb13a31a8,0xac543000,0x30b4b1a8,0xa86aac54,0xb18c3000,0xae49313a
.long 0x30008000,0x3000b1a8,0xb0008000,0xb00031a8,0xae4931a8,0x318cac54,0xa86ab000,0xb0b4313a
.long 0xb13a8000,0x2c543000,0x2c54b1a8,0xb13a3000,0x286ab1a8,0xae49313a,0x30b4b000,0xb18c2c54
.long 0x31a88000,0xb1a88000,0x31a88000,0xb1a88000,0x286a31a8,0xae49b13a,0x30b43000,0xb18cac54
.long 0xb13a8000,0x2c54b000,0x2c5431a8,0xb13ab000,0xae49b1a8,0x318c2c54,0xa86a3000,0xb0b4b13a
.long 0x30008000,0x300031a8,0xb0008000,0xb000b1a8,0x30b431a8,0xa86a2c54,0xb18cb000,0xae49b13a
.long 0xac548000,0xb13ab000,0xb13ab1a8,0xac54b000,0xb18cb1a8,0xb0b4b13a,0xae49b000,0xa86aac54
.long 0x3e000000,0x3e000000,0x3e000000,0x3e000000,0x3f600000,0x0,0x3e000000,0x3e800000
.long 0x3e000000,0x3ec00000,0x3f200000,0x3f600000,0x3f600000,0x3e800000,0x3f200000,0x0
.long 0x3e000000,0x3f200000,0x3e000000,0x3f200000,0x3f600000,0x3f000000,0x3e000000,0x3f400000
.long 0x3e000000,0x3f600000,0x3f200000,0x3ec00000,0x3f600000,0x3f400000,0x3f200000,0x3f000000
.long 0x3ec00000,0x3ec00000,0x3ec00000,0x3ec00000,0x3e000000,0x3e800000,0x3ec00000,0x3f000000
.long 0x3ec00000,0x3f200000,0x3f600000,0x3e000000,0x3e000000,0x3f000000,0x3f600000,0x3e800000
.long 0x3ec00000,0x3f600000,0x3ec00000,0x3f600000,0x3e000000,0x3f400000,0x3ec00000,0x0
.long 0x3ec00000,0x3e000000,0x3f600000,0x3f200000,0x3e000000,0x0,0x3f600000,0x3f400000
.long 0x3f600000,0x3f600000,0x3f600000,0x3f600000,0x3f200000,0x3f400000,0x3f600000,0x0
.long 0x3f600000,0x3e000000,0x3ec00000,0x3f200000,0x3f200000,0x0,0x3ec00000,0x3f400000
.long 0x3f600000,0x3ec00000,0x3f600000,0x3ec00000,0x3f200000,0x3e800000,0x3f600000,0x3f000000
.long 0x3f600000,0x3f200000,0x3ec00000,0x3e000000,0x3f200000,0x3f000000,0x3ec00000,0x3e800000
.long 0x3e000000,0x3e000000,0x3e000000,0x3e000000,0x3f600000,0x0,0x3e000000,0x3e800000
.long 0x3e000000,0x3ec00000,0x3f200000,0x3f600000,0x3f600000,0x3e800000,0x3f200000,0x0
.long 0x3e000000,0x3f200000,0x3e000000,0x3f200000,0x3f600000,0x3f000000,0x3e000000,0x3f400000
.long 0x3e000000,0x3f600000,0x3f200000,0x3ec00000,0x3f600000,0x3f400000,0x3f200000,0x3f000000
.long 0x3f600000,0x3f600000,0x3f600000,0x3f600000,0x3e000000,0x3e800000,0x3ec00000,0x3f000000
.long 0x3f600000,0x3e000000,0x3ec00000,0x3f200000,0x3e000000,0x3f000000,0x3f600000,0x3e800000
.long 0x3f600000,0x3ec00000,0x3f600000,0x3ec00000,0x3e000000,0x3f400000,0x3ec00000,0x0
.long 0x3f600000,0x3f200000,0x3ec00000,0x3e000000,0x3e000000,0x0,0x3f600000,0x3f400000
.long 0x3e000000,0x3e000000,0x3e000000,0x3e000000,0x3ec00000,0x3f000000,0x3f200000,0x3f400000
.long 0x3e000000,0x3ec00000,0x3f200000,0x3f600000,0x3ec00000,0x3f400000,0x3e000000,0x3f000000
.long 0x3e000000,0x3f200000,0x3e000000,0x3f200000,0x3ec00000,0x0,0x3f200000,0x3e800000
.long 0x3e000000,0x3f600000,0x3f200000,0x3ec00000,0x3ec00000,0x3e800000,0x3e000000,0x0
.long 0x3e000000,0x3e000000,0x3e000000,0x3e000000,0x3ec00000,0x3f000000,0x3f200000,0x3f400000
.long 0x3e000000,0x3ec00000,0x3f200000,0x3f600000,0x3ec00000,0x3f400000,0x3e000000,0x3f000000
.long 0x3e000000,0x3f200000,0x3e000000,0x3f200000,0x3ec00000,0x0,0x3f200000,0x3e800000
.long 0x3e000000,0x3f600000,0x3f200000,0x3ec00000,0x3ec00000,0x3e800000,0x3e000000,0x0
.long 0x3ec00000,0x3ec00000,0x3ec00000,0x3ec00000,0x3f200000,0x3f400000,0x3f600000,0x0
.long 0x3ec00000,0x3f200000,0x3f600000,0x3e000000,0x3f200000,0x0,0x3ec00000,0x3f400000
.long 0x3ec00000,0x3f600000,0x3ec00000,0x3f600000,0x3f200000,0x3e800000,0x3f600000,0x3f000000
.long 0x3ec00000,0x3e000000,0x3f600000,0x3f200000,0x3f200000,0x3f000000,0x3ec00000,0x3e800000
.long 0x0,0x0,0x0,0x0,0x0,0x0,0x0,0x0
.long 0x0,0x0,0x0,0x0,0x0,0x0,0x0,0x0
.long 0x0,0x0,0x0,0x0,0x0,0x0,0x0,0x0
.long 0x0,0x0,0x0,0x0,0x0,0x0,0x0,0x0
.long 0x0,0x0,0x0,0x0,0x0,0x0,0x0,0x0
.long 0x0,0x0,0x0,0x0,0x0,0x0,0x0,0x0
.long 0x0,0x0,0x0,0x0,0x0,0x0,0x0,0x0
.long 0x0,0x0,0x0,0x0,0x0,0x0,0x0,0x0
.long 0x0,0x0,0x0,0x0,0x0,0x0,0x0,0x0
.long 0x0,0x0,0x0,0x0,0x0,0x0,0x0,0x0
.long 0x0,0x0,0x0,0x0,0x0,0x0,0x0,0x0
.long 0x0,0x0,0x0,0x0,0x0,0x0,0x0,0x0
.long 0x0,0x0,0x0,0x0,0x0,0x0,0x0,0x0
.long 0x0,0x0,0x0,0x0,0x0,0x0,0x0,0x0
.long 0x0,0x0,0x0,0x0,0x0,0x0,0x0,0x0
.long 0x0,0x0,0x0,0x0,0x0,0x0,0x0,0x0
.long 0x0,0x0,0x0,0x0,0x0,0x0,0x0,0x0
.long 0x0,0x0,0x0,0x0,0x0,0x0,0x0,0x0
.long 0x0,0x0,0x0,0x0,0x0,0x0,0x0,0x0
.long 0x0,0x0,0x0,0x0,0x0,0x0,0x0,0x0
.long 0x0,0x0,0x0,0x0,0x0,0x0,0x0,0x0
.long 0x0,0x0,0x0,0x0,0x0,0x0,0x0,0x0
.long 0x0,0x0,0x0,0x0,0x0,0x0,0x0,0x0
.long 0x0,0x0,0x0,0x0,0x0,0x0,0x0,0x0
.long 0x0,0x0,0x0,0x0,0x0,0x0,0x0,0x0
.long 0x0,0x0,0x0,0x0,0x0,0x0,0x0,0x0
.long 0x0,0x0,0x0,0x0,0x0,0x0,0x0,0x0
.long 0x0,0x0,0x0,0x0,0x0,0x0,0x0,0x0
.long 0x0,0x0,0x0,0x0,0x0,0x0,0x0,0x0
.long 0x0,0x0,0x0,0x0,0x0,0x0,0x0,0x0
.long 0x0,0x0,0x0,0x0,0x0,0x0,0x0,0x0
.long 0x0,0x0,0x0,0x0,0x0,0x0,0x0,0x0
.long 0x338b338b,0x338b338b,0x338b338b,0x0,0x3316338b,0x2f8b31c7,0x331631c7,0x0
.long 0x31c7338b,0xaf8b293d,0x31c7293d,0x0,0x2f8b338b,0xb38baf8b,0x2f8baf8b,0x0
.long 0x293d338b,0xaf8bb316,0x293db316,0x0,0xa93d338b,0x2f8bb316,0xa93db316,0x0
.long 0xaf8b338b,0x338baf8b,0xaf8baf8b,0x0,0xb1c7338b,0x2f8b293d,0xb1c7293d,0x0
.long 0xb316338b,0xaf8b31c7,0xb31631c7,0x0,0xb38b338b,0xb38b338b,0xb38b338b,0x0
.long 0xb316338b,0xaf8b31c7,0xb31631c7,0x0,0xb1c7338b,0x2f8b293d,0xb1c7293d,0x0
.long 0xaf8b338b,0x338baf8b,0xaf8baf8b,0x0,0xa93d338b,0x2f8bb316,0xa93db316,0x0
.long 0x293d338b,0xaf8bb316,0x293db316,0x0,0x2f8b338b,0xb38baf8b,0x2f8baf8b,0x0
.long 0x338b338b,0x338b338b,0x0,0x0,0xa93d293d,0xb1c7af8b,0x0,0x0
.long 0xb316b316,0x293daf8b,0x0,0x0,0x2f8baf8b,0x2f8b338b,0x0,0x0
.long 0x31c731c7,0xb316af8b,0x0,0x0,0xb1c731c7,0x3316af8b,0x0,0x0
.long 0xaf8baf8b,0xaf8b338b,0x0,0x0,0x3316b316,0xa93daf8b,0x0,0x0
.long 0x293d293d,0x31c7af8b,0x0,0x0,0xb38b338b,0xb38b338b,0x0,0x0
.long 0x293d293d,0x31c7af8b,0x0,0x0,0x3316b316,0xa93daf8b,0x0,0x0
.long 0xaf8baf8b,0xaf8b338b,0x0,0x0,0xb1c731c7,0x3316af8b,0x0,0x0
.long 0x31c731c7,0xb316af8b,0x0,0x0,0x2f8baf8b,0x2f8b338b,0x0,0x0
.long 0x338b338b,0x338b338b,0x0,0x0,0xb38bb316,0xb1c7b316,0x0,0x0
.long 0x338b31c7,0x293d31c7,0x0,0x0,0xb38baf8b,0x2f8baf8b,0x0,0x0
.long 0x338b293d,0xb316293d,0x0,0x0,0xb38b293d,0x3316293d,0x0,0x0
.long 0x338baf8b,0xaf8baf8b,0x0,0x0,0xb38b31c7,0xa93d31c7,0x0,0x0
.long 0x338bb316,0x31c7b316,0x0,0x0,0xb38b338b,0xb38b338b,0x0,0x0
.long 0x338bb316,0x31c7b316,0x0,0x0,0xb38b31c7,0xa93d31c7,0x0,0x0
.long 0x338baf8b,0xaf8baf8b,0x0,0x0,0xb38b293d,0x3316293d,0x0,0x0
.long 0x338b293d,0xb316293d,0x0,0x0,0xb38baf8b,0x2f8baf8b,0x0,0x0
.long 0x338b338b,0x338b338b,0x0,0x0,0xa93daf8b,0x2f8b293d,0x0,0x0
.long 0xb316af8b,0xaf8bb316,0x0,0x0,0x2f8b338b,0xb38baf8b,0x0,0x0
.long 0x31c7af8b,0xaf8b31c7,0x0,0x0,0xb1c7af8b,0x2f8b31c7,0x0,0x0
.long 0xaf8b338b,0x338baf8b,0x0,0x0,0x3316af8b,0x2f8bb316,0x0,0x0
.long 0x293daf8b,0xaf8b293d,0x0,0x0,0xb38b338b,0xb38b338b,0x0,0x0
.long 0x293daf8b,0xaf8b293d,0x0,0x0,0x3316af8b,0x2f8bb316,0x0,0x0
.long 0xaf8b338b,0x338baf8b,0x0,0x0,0xb1c7af8b,0x2f8b31c7,0x0,0x0
.long 0x31c7af8b,0xaf8b31c7,0x0,0x0,0x2f8b338b,0xb38baf8b,0x0,0x0
.long 0x0,0x0,0x0,0x0,0x2d290000,0x328830d9,0xad29b0d9,0x0
.long 0x30d90000,0x3288336e,0xb0d9b36e,0x0,0x32880000,0x3288,0xb288b288,0x0
.long 0x336e0000,0xb2882d29,0xb36ead29,0x0,0x336e0000,0xb288ad29,0xb36e2d29,0x0
.long 0x32880000,0xb288,0xb2883288,0x0,0x30d90000,0x3288b36e,0xb0d9336e,0x0
.long 0x2d290000,0x3288b0d9,0xad2930d9,0x0,0x0,0x0,0x0,0x0
.long 0xad290000,0xb28830d9,0x2d29b0d9,0x0,0xb0d90000,0xb288336e,0x30d9b36e,0x0
.long 0xb2880000,0x3288,0x3288b288,0x0,0xb36e0000,0x32882d29,0x336ead29,0x0
.long 0xb36e0000,0x3288ad29,0x336e2d29,0x0,0xb2880000,0xb288,0x32883288,0x0
.long 0x0,0x0,0x0,0x0,0x336e336e,0x30d93288,0x0,0x0
.long 0xad292d29,0xb36eb288,0x0,0x0,0xb288b288,0x32880000,0x0,0x0
.long 0x30d9b0d9,0xad293288,0x0,0x0,0x30d930d9,0xad29b288,0x0,0x0
.long 0xb2883288,0x32880000,0x0,0x0,0xad29ad29,0xb36e3288,0x0,0x0
.long 0x336eb36e,0x30d9b288,0x0,0x0,0x0,0x0,0x0,0x0
.long 0xb36e336e,0xb0d93288,0x0,0x0,0x2d292d29,0x336eb288,0x0,0x0
.long 0x3288b288,0xb2880000,0x0,0x0,0xb0d9b0d9,0x2d293288,0x0,0x0
.long 0xb0d930d9,0x2d29b288,0x0,0x0,0x32883288,0xb2880000,0x0,0x0
.long 0x0,0x0,0x0,0x0,0x2d29,0xb0d9ad29,0x0,0x0
.long 0xb0d9,0x336e30d9,0x0,0x0,0x3288,0xb288b288,0x0,0x0
.long 0xb36e,0x2d29336e,0x0,0x0,0x336e,0x2d29b36e,0x0,0x0
.long 0xb288,0xb2883288,0x0,0x0,0x30d9,0x336eb0d9,0x0,0x0
.long 0xad29,0xb0d92d29,0x0,0x0,0x0,0x0,0x0,0x0
.long 0x2d29,0x30d9ad29,0x0,0x0,0xb0d9,0xb36e30d9,0x0,0x0
.long 0x3288,0x3288b288,0x0,0x0,0xb36e,0xad29336e,0x0,0x0
.long 0x336e,0xad29b36e,0x0,0x0,0xb288,0x32883288,0x0,0x0
.long 0x0,0x0,0x0,0x0,0xb36eb288,0xb288b36e,0x0,0x0
.long 0x2d293288,0xb288ad29,0x0,0x0,0x32880000,0x3288,0x0,0x0
.long 0xb0d9b288,0x328830d9,0x0,0x0,0xb0d93288,0x3288b0d9,0x0,0x0
.long 0x32880000,0xb288,0x0,0x0,0x2d29b288,0xb2882d29,0x0,0x0
.long 0xb36e3288,0xb288336e,0x0,0x0,0x0,0x0,0x0,0x0
.long 0x336eb288,0x3288b36e,0x0,0x0,0xad293288,0x3288ad29,0x0,0x0
.long 0xb2880000,0x3288,0x0,0x0,0x30d9b288,0xb28830d9,0x0,0x0
.long 0x30d93288,0xb288b0d9,0x0,0x0,0xb2880000,0xb288,0x0,0x0
.long 0x80008000,0x80008000,0x80008000,0x0,0xad298000,0xb288b0d9,0x2d2930d9,0x0
.long 0xb0d98000,0xb288b36e,0x30d9336e,0x0,0xb2888000,0x8000b288,0x32883288,0x0
.long 0xb36e8000,0x3288ad29,0x336e2d29,0x0,0xb36e8000,0x32882d29,0x336ead29,0x0
.long 0xb2888000,0x80003288,0x3288b288,0x0,0xb0d98000,0xb288336e,0x30d9b36e,0x0
.long 0xad298000,0xb28830d9,0x2d29b0d9,0x0,0x80008000,0x80008000,0x80008000,0x0
.long 0x2d298000,0x3288b0d9,0xad2930d9,0x0,0x30d98000,0x3288b36e,0xb0d9336e,0x0
.long 0x32888000,0x8000b288,0xb2883288,0x0,0x336e8000,0xb288ad29,0xb36e2d29,0x0
.long 0x336e8000,0xb2882d29,0xb36ead29,0x0,0x32888000,0x80003288,0xb288b288,0x0
.long 0x80008000,0x80008000,0x0,0x0,0xb36eb36e,0xb0d9b288,0x0,0x0
.long 0x2d29ad29,0x336e3288,0x0,0x0,0x32883288,0xb2888000,0x0,0x0
.long 0xb0d930d9,0x2d29b288,0x0,0x0,0xb0d9b0d9,0x2d293288,0x0,0x0
.long 0x3288b288,0xb2888000,0x0,0x0,0x2d292d29,0x336eb288,0x0,0x0
.long 0xb36e336e,0xb0d93288,0x0,0x0,0x80008000,0x80008000,0x0,0x0
.long 0x336eb36e,0x30d9b288,0x0,0x0,0xad29ad29,0xb36e3288,0x0,0x0
.long 0xb2883288,0x32888000,0x0,0x0,0x30d930d9,0xad29b288,0x0,0x0
.long 0x30d9b0d9,0xad293288,0x0,0x0,0xb288b288,0x32888000,0x0,0x0
.long 0x80008000,0x80008000,0x0,0x0,0x8000ad29,0x30d92d29,0x0,0x0
.long 0x800030d9,0xb36eb0d9,0x0,0x0,0x8000b288,0x32883288,0x0,0x0
.long 0x8000336e,0xad29b36e,0x0,0x0,0x8000b36e,0xad29336e,0x0,0x0
.long 0x80003288,0x3288b288,0x0,0x0,0x8000b0d9,0xb36e30d9,0x0,0x0
.long 0x80002d29,0x30d9ad29,0x0,0x0,0x80008000,0x80008000,0x0,0x0
.long 0x8000ad29,0xb0d92d29,0x0,0x0,0x800030d9,0x336eb0d9,0x0,0x0
.long 0x8000b288,0xb2883288,0x0,0x0,0x8000336e,0x2d29b36e,0x0,0x0
.long 0x8000b36e,0x2d29336e,0x0,0x0,0x80003288,0xb288b288,0x0,0x0
.long 0x80008000,0x80008000,0x0,0x0,0x336e3288,0x3288336e,0x0,0x0
.long 0xad29b288,0x32882d29,0x0,0x0,0xb2888000,0x8000b288,0x0,0x0
.long 0x30d93288,0xb288b0d9,0x0,0x0,0x30d9b288,0xb28830d9,0x0,0x0
.long 0xb2888000,0x80003288,0x0,0x0,0xad293288,0x3288ad29,0x0,0x0
.long 0x336eb288,0x3288b36e,0x0,0x0,0x80008000,0x80008000,0x0,0x0
.long 0xb36e3288,0xb288336e,0x0,0x0,0x2d29b288,0xb2882d29,0x0,0x0
.long 0x32888000,0x8000b288,0x0,0x0,0xb0d93288,0x3288b0d9,0x0,0x0
.long 0xb0d9b288,0x328830d9,0x0,0x0,0x32888000,0x80003288,0x0,0x0
.long 0x31c7338b,0xaf8b293d,0x31c7293d,0x0,0x3316338b,0x2f8b31c7,0x331631c7,0x0
.long 0x30d98000,0x3288336e,0xb0d9b36e,0x0,0x2d298000,0x328830d9,0xad29b0d9,0x0
.long 0x0,0x0,0x0,0x0,0x0,0x0,0x0,0x0
.long 0x0,0x0,0x0,0x0,0x0,0x0,0x0,0x0
.long 0x0,0x0,0x0,0x0,0x0,0x0,0x0,0x0
.long 0x0,0x0,0x0,0x0,0x0,0x0,0x0,0x0
.long 0x0,0x0,0x0,0x0,0x0,0x0,0x0,0x0
.long 0x0,0x0,0x0,0x0,0x0,0x0,0x0,0x0
.long 0xb316b316,0x293daf8b,0x0,0x0,0xa93d293d,0xb1c7af8b,0x0,0x0
.long 0xad292d29,0xb36eb288,0x0,0x0,0x336e336e,0x30d93288,0x0,0x0
.long 0x0,0x0,0x0,0x0,0x0,0x0,0x0,0x0
.long 0x0,0x0,0x0,0x0,0x0,0x0,0x0,0x0
.long 0x0,0x0,0x0,0x0,0x0,0x0,0x0,0x0
.long 0x0,0x0,0x0,0x0,0x0,0x0,0x0,0x0
.long 0x0,0x0,0x0,0x0,0x0,0x0,0x0,0x0
.long 0x0,0x0,0x0,0x0,0x0,0x0,0x0,0x0
.long 0x338b31c7,0x293d31c7,0x0,0x0,0xb38bb316,0xb1c7b316,0x0,0x0
.long 0x8000b0d9,0x336e30d9,0x0,0x0,0x80002d29,0xb0d9ad29,0x0,0x0
.long 0x0,0x0,0x0,0x0,0x0,0x0,0x0,0x0
.long 0x0,0x0,0x0,0x0,0x0,0x0,0x0,0x0
.long 0x0,0x0,0x0,0x0,0x0,0x0,0x0,0x0
.long 0x0,0x0,0x0,0x0,0x0,0x0,0x0,0x0
.long 0x0,0x0,0x0,0x0,0x0,0x0,0x0,0x0
.long 0x0,0x0,0x0,0x0,0x0,0x0,0x0,0x0
.long 0xb316af8b,0xaf8bb316,0x0,0x0,0xa93daf8b,0x2f8b293d,0x0,0x0
.long 0x2d293288,0xb288ad29,0x0,0x0,0xb36eb288,0xb288b36e,0x0,0x0
.long 0x0,0x0,0x0,0x0,0x0,0x0,0x0,0x0
.long 0x0,0x0,0x0,0x0,0x0,0x0,0x0,0x0
.long 0x0,0x0,0x0,0x0,0x0,0x0,0x0,0x0
.long 0x0,0x0,0x0,0x0,0x0,0x0,0x0,0x0
.long 0x0,0x0,0x0,0x0,0x0,0x0,0x0,0x0
.long 0x0,0x0,0x0,0x0,0x0,0x0,0x0,0x0
.long 0xb0d90000,0xb288b36e,0x30d9336e,0x0,0xad290000,0xb288b0d9,0x2d2930d9,0x0
.long 0x31c7338b,0xaf8b293d,0x31c7293d,0x0,0x3316338b,0x2f8b31c7,0x331631c7,0x0
.long 0x0,0x0,0x0,0x0,0x0,0x0,0x0,0x0
.long 0x0,0x0,0x0,0x0,0x0,0x0,0x0,0x0
.long 0x0,0x0,0x0,0x0,0x0,0x0,0x0,0x0
.long 0x0,0x0,0x0,0x0,0x0,0x0,0x0,0x0
.long 0x0,0x0,0x0,0x0,0x0,0x0,0x0,0x0
.long 0x0,0x0,0x0,0x0,0x0,0x0,0x0,0x0
.long 0x2d29ad29,0x336e3288,0x0,0x0,0xb36eb36e,0xb0d9b288,0x0,0x0
.long 0xb316b316,0x293daf8b,0x0,0x0,0xa93d293d,0xb1c7af8b,0x0,0x0
.long 0x0,0x0,0x0,0x0,0x0,0x0,0x0,0x0
.long 0x0,0x0,0x0,0x0,0x0,0x0,0x0,0x0
.long 0x0,0x0,0x0,0x0,0x0,0x0,0x0,0x0
.long 0x0,0x0,0x0,0x0,0x0,0x0,0x0,0x0
.long 0x0,0x0,0x0,0x0,0x0,0x0,0x0,0x0
.long 0x0,0x0,0x0,0x0,0x0,0x0,0x0,0x0
.long 0x30d9,0xb36eb0d9,0x0,0x0,0xad29,0x30d92d29,0x0,0x0
.long 0x338b31c7,0x293d31c7,0x0,0x0,0xb38bb316,0xb1c7b316,0x0,0x0
.long 0x0,0x0,0x0,0x0,0x0,0x0,0x0,0x0
.long 0x0,0x0,0x0,0x0,0x0,0x0,0x0,0x0
.long 0x0,0x0,0x0,0x0,0x0,0x0,0x0,0x0
.long 0x0,0x0,0x0,0x0,0x0,0x0,0x0,0x0
.long 0x0,0x0,0x0,0x0,0x0,0x0,0x0,0x0
.long 0x0,0x0,0x0,0x0,0x0,0x0,0x0,0x0
.long 0xad29b288,0x32882d29,0x0,0x0,0x336e3288,0x3288336e,0x0,0x0
.long 0xb316af8b,0xaf8bb316,0x0,0x0,0xa93daf8b,0x2f8b293d,0x0,0x0
.long 0x0,0x0,0x0,0x0,0x0,0x0,0x0,0x0
.long 0x0,0x0,0x0,0x0,0x0,0x0,0x0,0x0
.long 0x0,0x0,0x0,0x0,0x0,0x0,0x0,0x0
.long 0x0,0x0,0x0,0x0,0x0,0x0,0x0,0x0
.long 0x0,0x0,0x0,0x0,0x0,0x0,0x0,0x0
.long 0x0,0x0,0x0,0x0,0x0,0x0,0x0,0x0
.long 0x0,0x0,0x34003400,0x34003400,0x2e1f0000,0x336431a8,0x33643400,0x2e1f31a8
.long 0x31a80000,0x31a83400,0x31a83400,0xb1a80000,0x33640000,0xae1f31a8,0x2e1f3400,0xb364b1a8
.long 0x34000000,0xb4000000,0x3400,0x8000b400,0x33640000,0xae1fb1a8,0xae1f3400,0x3364b1a8
.long 0x31a80000,0x31a8b400,0xb1a83400,0x31a88000,0x2e1f0000,0x3364b1a8,0xb3643400,0xae1f31a8
.long 0x0,0x0,0xb4003400,0xb4003400,0xae1f0000,0xb36431a8,0xb3643400,0xae1f31a8
.long 0xb1a80000,0xb1a83400,0xb1a83400,0x31a80000,0xb3640000,0x2e1f31a8,0xae1f3400,0x3364b1a8
.long 0xb4000000,0x34000000,0x80003400,0xb400,0xb3640000,0x2e1fb1a8,0x2e1f3400,0xb364b1a8
.long 0xb1a80000,0xb1a8b400,0x31a83400,0xb1a88000,0xae1f0000,0xb364b1a8,0x33643400,0x2e1f31a8
.long 0x0,0x0,0x34003400,0x34003400,0x33643400,0x2e1f31a8,0xae1f0000,0xb364b1a8
.long 0xb1a80000,0xb1a8b400,0xb1a8b400,0x31a88000,0xae1fb400,0x336431a8,0x33648000,0xae1f31a8
.long 0x34000000,0xb4000000,0x3400,0x8000b400,0xae1f3400,0x3364b1a8,0xb3640000,0x2e1f31a8
.long 0xb1a80000,0xb1a83400,0x31a8b400,0xb1a80000,0x3364b400,0x2e1fb1a8,0x2e1f8000,0x3364b1a8
.long 0x0,0x0,0xb4003400,0xb4003400,0xb3643400,0xae1f31a8,0x2e1f0000,0x3364b1a8
.long 0x31a80000,0x31a8b400,0x31a8b400,0xb1a88000,0x2e1fb400,0xb36431a8,0xb3648000,0x2e1f31a8
.long 0xb4000000,0x34000000,0x80003400,0xb400,0x2e1f3400,0xb364b1a8,0x33640000,0xae1f31a8
.long 0x31a80000,0x31a83400,0xb1a8b400,0x31a80000,0xb364b400,0xae1fb1a8,0xae1f8000,0xb364b1a8
.long 0x0,0x0,0x34003400,0x34003400,0xae1f0000,0xb364b1a8,0xb364b400,0xae1fb1a8
.long 0x31a80000,0x31a83400,0x31a83400,0xb1a80000,0xb3640000,0x2e1fb1a8,0xae1fb400,0x336431a8
.long 0x34000000,0xb4000000,0x3400,0x8000b400,0xb3640000,0x2e1f31a8,0x2e1fb400,0xb36431a8
.long 0x31a80000,0x31a8b400,0xb1a83400,0x31a88000,0xae1f0000,0xb36431a8,0x3364b400,0x2e1fb1a8
.long 0x0,0x0,0xb4003400,0xb4003400,0x2e1f0000,0x3364b1a8,0x3364b400,0x2e1fb1a8
.long 0xb1a80000,0xb1a83400,0xb1a83400,0x31a80000,0x33640000,0xae1fb1a8,0x2e1fb400,0xb36431a8
.long 0xb4000000,0x34000000,0x80003400,0xb400,0x33640000,0xae1f31a8,0xae1fb400,0x336431a8
.long 0xb1a80000,0xb1a8b400,0x31a83400,0xb1a88000,0x2e1f0000,0x336431a8,0xb364b400,0xae1fb1a8
.long 0x0,0x0,0x34003400,0x34003400,0xb364b400,0xae1fb1a8,0x2e1f8000,0x336431a8
.long 0xb1a80000,0xb1a8b400,0xb1a8b400,0x31a88000,0x2e1f3400,0xb364b1a8,0xb3640000,0x2e1fb1a8
.long 0x34000000,0xb4000000,0x3400,0x8000b400,0x2e1fb400,0xb36431a8,0x33648000,0xae1fb1a8
.long 0xb1a80000,0xb1a83400,0x31a8b400,0xb1a80000,0xb3643400,0xae1f31a8,0xae1f0000,0xb36431a8
.long 0x0,0x0,0xb4003400,0xb4003400,0x3364b400,0x2e1fb1a8,0xae1f8000,0xb36431a8
.long 0x31a80000,0x31a8b400,0x31a8b400,0xb1a88000,0xae1f3400,0x3364b1a8,0x33640000,0xae1fb1a8
.long 0xb4000000,0x34000000,0x80003400,0xb400,0xae1fb400,0x336431a8,0xb3648000,0x2e1fb1a8
.long 0x31a80000,0x31a83400,0xb1a8b400,0x31a80000,0x33643400,0x2e1f31a8,0x2e1f0000,0x336431a8
.long 0x80008000,0x80008000,0x34003400,0x34003400,0xae1f8000,0xb364b1a8,0x33643400,0x2e1f31a8
.long 0xb1a88000,0xb1a8b400,0x31a83400,0xb1a80000,0xb3648000,0x2e1fb1a8,0x2e1f3400,0xb364b1a8
.long 0xb4008000,0x34008000,0x3400,0x8000b400,0xb3648000,0x2e1f31a8,0xae1f3400,0x3364b1a8
.long 0xb1a88000,0xb1a83400,0xb1a83400,0x31a88000,0xae1f8000,0xb36431a8,0xb3643400,0xae1f31a8
.long 0x80008000,0x80008000,0xb4003400,0xb4003400,0x2e1f8000,0x3364b1a8,0xb3643400,0xae1f31a8
.long 0x31a88000,0x31a8b400,0xb1a83400,0x31a80000,0x33648000,0xae1fb1a8,0xae1f3400,0x3364b1a8
.long 0x34008000,0xb4008000,0x80003400,0xb400,0x33648000,0xae1f31a8,0x2e1f3400,0xb364b1a8
.long 0x31a88000,0x31a83400,0x31a83400,0xb1a88000,0x2e1f8000,0x336431a8,0x33643400,0x2e1f31a8
.long 0x80008000,0x80008000,0x34003400,0x34003400,0xb364b400,0xae1fb1a8,0xae1f0000,0xb364b1a8
.long 0x31a88000,0x31a83400,0xb1a8b400,0x31a88000,0x2e1f3400,0xb364b1a8,0x33648000,0xae1f31a8
.long 0xb4008000,0x34008000,0x3400,0x8000b400,0x2e1fb400,0xb36431a8,0xb3640000,0x2e1f31a8
.long 0x31a88000,0x31a8b400,0x31a8b400,0xb1a80000,0xb3643400,0xae1f31a8,0x2e1f8000,0x3364b1a8
.long 0x80008000,0x80008000,0xb4003400,0xb4003400,0x3364b400,0x2e1fb1a8,0x2e1f0000,0x3364b1a8
.long 0xb1a88000,0xb1a83400,0x31a8b400,0xb1a88000,0xae1f3400,0x3364b1a8,0xb3648000,0x2e1f31a8
.long 0x34008000,0xb4008000,0x80003400,0xb400,0xae1fb400,0x336431a8,0x33640000,0xae1f31a8
.long 0xb1a88000,0xb1a8b400,0xb1a8b400,0x31a80000,0x33643400,0x2e1f31a8,0xae1f8000,0xb364b1a8
.long 0x80008000,0x80008000,0x34003400,0x34003400,0x2e1f8000,0x336431a8,0xb364b400,0xae1fb1a8
.long 0xb1a88000,0xb1a8b400,0x31a83400,0xb1a80000,0x33648000,0xae1f31a8,0xae1fb400,0x336431a8
.long 0xb4008000,0x34008000,0x3400,0x8000b400,0x33648000,0xae1fb1a8,0x2e1fb400,0xb36431a8
.long 0xb1a88000,0xb1a83400,0xb1a83400,0x31a88000,0x2e1f8000,0x3364b1a8,0x3364b400,0x2e1fb1a8
.long 0x80008000,0x80008000,0xb4003400,0xb4003400,0xae1f8000,0xb36431a8,0x3364b400,0x2e1fb1a8
.long 0x31a88000,0x31a8b400,0xb1a83400,0x31a80000,0xb3648000,0x2e1f31a8,0x2e1fb400,0xb36431a8
.long 0x34008000,0xb4008000,0x80003400,0xb400,0xb3648000,0x2e1fb1a8,0xae1fb400,0x336431a8
.long 0x31a88000,0x31a83400,0x31a83400,0xb1a88000,0xae1f8000,0xb364b1a8,0xb364b400,0xae1fb1a8
.long 0x80008000,0x80008000,0x34003400,0x34003400,0x33643400,0x2e1f31a8,0x2e1f8000,0x336431a8
.long 0x31a88000,0x31a83400,0xb1a8b400,0x31a88000,0xae1fb400,0x336431a8,0xb3640000,0x2e1fb1a8
.long 0xb4008000,0x34008000,0x3400,0x8000b400,0xae1f3400,0x3364b1a8,0x33648000,0xae1fb1a8
.long 0x31a88000,0x31a8b400,0x31a8b400,0xb1a80000,0x3364b400,0x2e1fb1a8,0xae1f0000,0xb36431a8
.long 0x80008000,0x80008000,0xb4003400,0xb4003400,0xb3643400,0xae1f31a8,0xae1f8000,0xb36431a8
.long 0xb1a88000,0xb1a83400,0x31a8b400,0xb1a88000,0x2e1fb400,0xb36431a8,0x33640000,0xae1fb1a8
.long 0x34008000,0xb4008000,0x80003400,0xb400,0x2e1f3400,0xb364b1a8,0xb3648000,0x2e1fb1a8
.long 0xb1a88000,0xb1a8b400,0xb1a8b400,0x31a80000,0xb364b400,0xae1fb1a8,0x2e1f0000,0x336431a8
.long 0x0,0x0,0x0,0x0,0x2e1f0000,0x336431a8,0x0,0x0
.long 0x31a80000,0x31a83400,0x0,0x0,0x33640000,0xae1f31a8,0x0,0x0
.long 0x34000000,0xb4000000,0x0,0x0,0x33640000,0xae1fb1a8,0x0,0x0
.long 0x31a80000,0x31a8b400,0x0,0x0,0x2e1f0000,0x3364b1a8,0x0,0x0
.long 0x0,0x0,0x0,0x0,0xae1f0000,0xb36431a8,0x0,0x0
.long 0xb1a80000,0xb1a83400,0x0,0x0,0xb3640000,0x2e1f31a8,0x0,0x0
.long 0xb4000000,0x34000000,0x0,0x0,0xb3640000,0x2e1fb1a8,0x0,0x0
.long 0xb1a80000,0xb1a8b400,0x0,0x0,0xae1f0000,0xb364b1a8,0x0,0x0
.long 0x0,0x0,0x0,0x0,0x33643400,0x2e1f31a8,0x0,0x0
.long 0xb1a80000,0xb1a8b400,0x0,0x0,0xae1fb400,0x336431a8,0x0,0x0
.long 0x34000000,0xb4000000,0x0,0x0,0xae1f3400,0x3364b1a8,0x0,0x0
.long 0xb1a80000,0xb1a83400,0x0,0x0,0x3364b400,0x2e1fb1a8,0x0,0x0
.long 0x0,0x0,0x0,0x0,0xb3643400,0xae1f31a8,0x0,0x0
.long 0x31a80000,0x31a8b400,0x0,0x0,0x2e1fb400,0xb36431a8,0x0,0x0
.long 0xb4000000,0x34000000,0x0,0x0,0x2e1f3400,0xb364b1a8,0x0,0x0
.long 0x31a80000,0x31a83400,0x0,0x0,0xb364b400,0xae1fb1a8,0x0,0x0
.long 0x0,0x0,0x0,0x0,0xae1f0000,0xb364b1a8,0x0,0x0
.long 0x31a80000,0x31a83400,0x0,0x0,0xb3640000,0x2e1fb1a8,0x0,0x0
.long 0x34000000,0xb4000000,0x0,0x0,0xb3640000,0x2e1f31a8,0x0,0x0
.long 0x31a80000,0x31a8b400,0x0,0x0,0xae1f0000,0xb36431a8,0x0,0x0
.long 0x0,0x0,0x0,0x0,0x2e1f0000,0x3364b1a8,0x0,0x0
.long 0xb1a80000,0xb1a83400,0x0,0x0,0x33640000,0xae1fb1a8,0x0,0x0
.long 0xb4000000,0x34000000,0x0,0x0,0x33640000,0xae1f31a8,0x0,0x0
.long 0xb1a80000,0xb1a8b400,0x0,0x0,0x2e1f0000,0x336431a8,0x0,0x0
.long 0x0,0x0,0x0,0x0,0xb364b400,0xae1fb1a8,0x0,0x0
.long 0xb1a80000,0xb1a8b400,0x0,0x0,0x2e1f3400,0xb364b1a8,0x0,0x0
.long 0x34000000,0xb4000000,0x0,0x0,0x2e1fb400,0xb36431a8,0x0,0x0
.long 0xb1a80000,0xb1a83400,0x0,0x0,0xb3643400,0xae1f31a8,0x0,0x0
.long 0x0,0x0,0x0,0x0,0x3364b400,0x2e1fb1a8,0x0,0x0
.long 0x31a80000,0x31a8b400,0x0,0x0,0xae1f3400,0x3364b1a8,0x0,0x0
.long 0xb4000000,0x34000000,0x0,0x0,0xae1fb400,0x336431a8,0x0,0x0
.long 0x31a80000,0x31a83400,0x0,0x0,0x33643400,0x2e1f31a8,0x0,0x0
.long 0x3f800000,0x3f800000,0x3f800000,0x3f800000,0x3f800000,0x3f7ffc1a,0x3f7ff067,0x3f7fdce9
.long 0x3f800000,0x3f7ff067,0x3f7fc1a0,0x3f7f73af,0x3f800000,0x3f7fdce9,0x3f7f73af,0x3f7ec46d
.long 0x3f800000,0x3f7fc1a0,0x3f7f069e,0x3f7dcf55,0x3f800000,0x3f7f9e8c,0x3f7e7a7a,0x3f7c94a8
.long 0x3f800000,0x3f7f73af,0x3f7dcf55,0x3f7b14be,0x3f800000,0x3f7f4109,0x3f7d0543,0x3f795000
.long 0x3f800000,0x3f7f069e,0x3f7c1c5c,0x3f7746ea,0x3f800000,0x3f7ec46d,0x3f7b14be,0x3f74fa0b
.long 0x3f800000,0x3f7e7a7a,0x3f79ee89,0x3f726a03,0x3f800000,0x3f7e28c6,0x3f78a9e0,0x3f6f9788
.long 0x3f800000,0x3f7dcf55,0x3f7746ea,0x3f6c835e,0x3f800000,0x3f7d6e28,0x3f75c5d4,0x3f692e5f
.long 0x3f800000,0x3f7d0543,0x3f7426cb,0x3f659974,0x3f800000,0x3f7c94a8,0x3f726a03,0x3f61c598
.long 0x3f800000,0x3f800000,0x3f800000,0x3f800000,0x3f7fc1a0,0x3f7f9e8c,0x3f7f73af,0x3f7f4109
.long 0x3f7f069e,0x3f7e7a7a,0x3f7dcf55,0x3f7d0543,0x3f7dcf55,0x3f7c94a8,0x3f7b14be,0x3f795000
.long 0x3f7c1c5c,0x3f79ee89,0x3f7746ea,0x3f7426cb,0x3f79ee89,0x3f768a20,0x3f726a03,0x3f6d9156
.long 0x3f7746ea,0x3f726a03,0x3f6c835e,0x3f659974,0x3f7426cb,0x3f6d9156,0x3f659974,0x3f5c4b07
.long 0x3f708fb2,0x3f6803ca,0x3f5db3d7,0x3f51b3f3,0x3f6c835e,0x3f61c598,0x3f54db31,0x3f45e403
.long 0x3f6803ca,0x3f5adb81,0x3f4b1934,0x3f38ecd8,0x3f631324,0x3f534aca,0x3f407893,0x3f2ae1c9
.long 0x3f5db3d7,0x3f4b1934,0x3f3504f3,0x3f1bd7ca,0x3f57e880,0x3f424cfe,0x3f28cae3,0x3f0be54a
.long 0x3f51b3f3,0x3f38ecd8,0x3f1bd7ca,0x3ef64429,0x3f4b1934,0x3f2effe8,0x3f0e39da,0x3ed34e56
.long 0x3f800000,0x3f800000,0x3f800000,0x3f800000,0x3f7f069e,0x3f7ec46d,0x3f7e7a7a,0x3f7e28c6
.long 0x3f7c1c5c,0x3f7b14be,0x3f79ee89,0x3f78a9e0,0x3f7746ea,0x3f74fa0b,0x3f726a03,0x3f6f9788
.long 0x3f708fb2,0x3f6c835e,0x3f6803ca,0x3f631324,0x3f6803ca,0x3f61c598,0x3f5adb81,0x3f534aca
.long 0x3f5db3d7,0x3f54db31,0x3f4b1934,0x3f407893,0x3f51b3f3,0x3f45e403,0x3f38ecd8,0x3f2ae1c9
.long 0x3f441b7d,0x3f3504f3,0x3f248dbb,0x3f12d5e8,0x3f3504f3,0x3f226799,0x3f0e39da,0x3ef15aea
.long 0x3f248dbb,0x3f0e39da,0x3eec6a50,0x3eb9917b,0x3f12d5e8,0x3ef15aea,0x3eb9917b,0x3e7e39c4
.long 0x3f000000,0x3ec3ef15,0x3e8483ee,0x3e05a8a8,0x3ed8616c,0x3e94a031,0x3e1bc63c,0x3c32b7da
.long 0x3eaf1d44,0x3e47c5c2,0x3d32aa3e,0xbddef599,0x3e8483ee,0x3dc8bd36,0xbd85f213,0xbe6886ae
.long 0x3f800000,0x3f800000,0x3f800000,0x3f800000,0x3f7dcf55,0x3f7d6e28,0x3f7d0543,0x3f7c94a8
.long 0x3f7746ea,0x3f75c5d4,0x3f7426cb,0x3f726a03,0x3f6c835e,0x3f692e5f,0x3f659974,0x3f61c598
.long 0x3f5db3d7,0x3f57e880,0x3f51b3f3,0x3f4b1934,0x3f4b1934,0x3f424cfe,0x3f38ecd8,0x3f2effe8
.long 0x3f3504f3,0x3f28cae3,0x3f1bd7ca,0x3f0e39da,0x3f1bd7ca,0x3f0be54a,0x3ef64429,0x3ed34e56
.long 0x3f000000,0x3ed8616c,0x3eaf1d44,0x3e8483ee,0x3ec3ef15,0x3e94a031,0x3e47c5c2,0x3dc8bd36
.long 0x3e8483ee,0x3e1bc63c,0x3d32aa3e,0xbd85f213,0x3e05a8a8,0x3c32b7da,0xbddef599,0xbe6886ae
.long 0x248d3132,0xbe05a8a8,0xbe8483ee,0xbec3ef15,0xbe05a8a8,0xbe89e6f1,0xbece34d0,0xbf072f74
.long 0xbe8483ee,0xbece34d0,0xbf098c78,0xbf28cae3,0xbec3ef15,0xbf072f74,0xbf28cae3,0xbf45e403
.long 0x0,0x0,0x0,0x0,0x0,0x3c32b7da,0x3cb2b521,0x3d060472
.long 0x0,0x3cb2b521,0x3d32aa3e,0x3d85f213,0x0,0x3d060472,0x3d85f213,0x3dc8bd36
.long 0x0,0x3d32aa3e,0x3db27eb6,0x3e05a8a8,0x0,0x3d5f4a99,0x3ddef599,0x3e26ce12
.long 0x0,0x3d85f213,0x3e05a8a8,0x3e47c5c2,0x0,0x3d9c3ac6,0x3e1bc63c,0x3e6886ae
.long 0x0,0x3db27eb6,0x3e31d0d4,0x3e8483ee,0x0,0x3dc8bd36,0x3e47c5c2,0x3e94a031
.long 0x0,0x3ddef599,0x3e5da259,0x3ea493b7,0x0,0x3df52731,0x3e7363ee,0x3eb45a1e
.long 0x0,0x3e05a8a8,0x3e8483ee,0x3ec3ef15,0x0,0x3e10b9a6,0x3e8f45c0,0x3ed34e56
.long 0x0,0x3e1bc63c,0x3e99f61c,0x3ee273aa,0x0,0x3e26ce12,0x3ea493b7,0x3ef15aea
.long 0x0,0x0,0x0,0x0,0x3d32aa3e,0x3d5f4a99,0x3d85f213,0x3d9c3ac6
.long 0x3db27eb6,0x3ddef599,0x3e05a8a8,0x3e1bc63c,0x3e05a8a8,0x3e26ce12,0x3e47c5c2,0x3e6886ae
.long 0x3e31d0d4,0x3e5da259,0x3e8483ee,0x3e99f61c,0x3e5da259,0x3e89e6f1,0x3ea493b7,0x3ebec330
.long 0x3e8483ee,0x3ea493b7,0x3ec3ef15,0x3ee273aa,0x3e99f61c,0x3ebec330,0x3ee273aa,0x3f026926
.long 0x3eaf1d44,0x3ed8616c,0x3f000000,0x3f12d5e8,0x3ec3ef15,0x3ef15aea,0x3f0e39da,0x3f226799
.long 0x3ed8616c,0x3f04ce53,0x3f1bd7ca,0x3f310700,0x3eec6a50,0x3f108a14,0x3f28cae3,0x3f3e9e4b
.long 0x3f000000,0x3f1bd7ca,0x3f3504f3,0x3f4b1934,0x3f098c78,0x3f26aed9,0x3f407893,0x3f56651d
.long 0x3f12d5e8,0x3f310700,0x3f4b1934,0x3f60712a,0x3f1bd7ca,0x3f3ad85f,0x3f54db31,0x3f692e5f
.long 0x0,0x0,0x0,0x0,0x3db27eb6,0x3dc8bd36,0x3ddef599,0x3df52731
.long 0x3e31d0d4,0x3e47c5c2,0x3e5da259,0x3e7363ee,0x3e8483ee,0x3e94a031,0x3ea493b7,0x3eb45a1e
.long 0x3eaf1d44,0x3ec3ef15,0x3ed8616c,0x3eec6a50,0x3ed8616c,0x3ef15aea,0x3f04ce53,0x3f108a14
.long 0x3f000000,0x3f0e39da,0x3f1bd7ca,0x3f28cae3,0x3f12d5e8,0x3f226799,0x3f310700,0x3f3e9e4b
.long 0x3f248dbb,0x3f3504f3,0x3f441b7d,0x3f51b3f3,0x3f3504f3,0x3f45e403,0x3f54db31,0x3f61c598
.long 0x3f441b7d,0x3f54db31,0x3f631324,0x3f6e9811,0x3f51b3f3,0x3f61c598,0x3f6e9811,0x3f77fc2c
.long 0x3f5db3d7,0x3f6c835e,0x3f7746ea,0x3f7dcf55,0x3f6803ca,0x3f74fa0b,0x3f7d0543,0x3f7ffc1a
.long 0x3f708fb2,0x3f7b14be,0x3f7fc1a0,0x3f7e7a7a,0x3f7746ea,0x3f7ec46d,0x3f7f73af,0x3f795000
.long 0x0,0x0,0x0,0x0,0x3e05a8a8,0x3e10b9a6,0x3e1bc63c,0x3e26ce12
.long 0x3e8483ee,0x3e8f45c0,0x3e99f61c,0x3ea493b7,0x3ec3ef15,0x3ed34e56,0x3ee273aa,0x3ef15aea
.long 0x3f000000,0x3f098c78,0x3f12d5e8,0x3f1bd7ca,0x3f1bd7ca,0x3f26aed9,0x3f310700,0x3f3ad85f
.long 0x3f3504f3,0x3f407893,0x3f4b1934,0x3f54db31,0x3f4b1934,0x3f56651d,0x3f60712a,0x3f692e5f
.long 0x3f5db3d7,0x3f6803ca,0x3f708fb2,0x3f7746ea,0x3f6c835e,0x3f74fa0b,0x3f7b14be,0x3f7ec46d
.long 0x3f7746ea,0x3f7d0543,0x3f7fc1a0,0x3f7f73af,0x3f7dcf55,0x3f7ffc1a,0x3f7e7a7a,0x3f795000
.long 0x3f800000,0x3f7dcf55,0x3f7746ea,0x3f6c835e,0x3f7dcf55,0x3f768a20,0x3f6a51da,0x3f596550
.long 0x3f7746ea,0x3f6a51da,0x3f57e880,0x3f407893,0x3f6c835e,0x3f596550,0x3f407893,0x3f226799
.long 0x3f800000,0x3f800000,0x0,0x0,0x3f7c1c5c,0x3f7b9c62,0x3e31d0d4,0x3e3cce2b
.long 0x3f708fb2,0x3f6e9811,0x3eaf1d44,0x3eb9917b,0x3f5db3d7,0x3f596550,0x3f000000,0x3f072f74
.long 0x3f441b7d,0x3f3cbe35,0x3f248dbb,0x3f2cf37b,0x3f248dbb,0x3f199e45,0x3f441b7d,0x3f4cc94c
.long 0x3f000000,0x3ee273aa,0x3f5db3d7,0x3f659974,0x3eaf1d44,0x3e89e6f1,0x3f708fb2,0x3f768a20
.long 0x3e31d0d4,0x3db27eb6,0x3f7c1c5c,0x3f7f069e,0x248d3132,0xbdc8bd36,0x3f800000,0x3f7ec46d
.long 0xbe31d0d4,0xbe8f45c0,0x3f7c1c5c,0x3f75c5d4,0xbeaf1d44,0xbee77284,0x3f708fb2,0x3f6459c6
.long 0xbf000000,0xbf1bd7ca,0x3f5db3d7,0x3f4b1934,0xbf248dbb,0xbf3e9e4b,0x3f441b7d,0x3f2ae1c9
.long 0xbf441b7d,0xbf5adb81,0x3f248dbb,0x3f04ce53,0xbf5db3d7,0xbf6f9788,0x3f000000,0x3eb45a1e
.long 0x0,0x0,0x0,0x0,0x0,0x0,0x0,0x0
.long 0x0,0x0,0x0,0x0,0x0,0x0,0x0,0x0
.long 0x0,0x0,0x0,0x0,0x0,0x0,0x0,0x0
.long 0x0,0x0,0x0,0x0,0x0,0x0,0x0,0x0
.long 0x0,0x0,0x0,0x0,0x0,0x0,0x0,0x0
.long 0x0,0x0,0x0,0x0,0x0,0x0,0x0,0x0
.long 0x0,0x0,0x0,0x0,0x0,0x0,0x0,0x0
.long 0x0,0x0,0x0,0x0,0x0,0x0,0x0,0x0
.long 0x0,0x0,0x0,0x0,0x0,0x0,0x0,0x0
.long 0x0,0x0,0x0,0x0,0x0,0x0,0x0,0x0
.long 0x0,0x0,0x0,0x0,0x0,0x0,0x0,0x0
.long 0x0,0x0,0x0,0x0,0x0,0x0,0x0,0x0
.long 0x0,0x0,0x0,0x0,0x0,0x0,0x0,0x0
.long 0x0,0x0,0x0,0x0,0x0,0x0,0x0,0x0
.long 0x0,0x0,0x0,0x0,0x0,0x0,0x0,0x0
.long 0x0,0x0,0x0,0x0,0x0,0x0,0x0,0x0
.long 0x0,0x0,0x0,0x0,0x0,0x0,0x0,0x0
.long 0x0,0x0,0x0,0x0,0x0,0x0,0x0,0x0
.long 0x0,0x0,0x0,0x0,0x0,0x0,0x0,0x0
.long 0x0,0x0,0x0,0x0,0x0,0x0,0x0,0x0
.long 0x0,0x0,0x0,0x0,0x0,0x0,0x0,0x0
.long 0x0,0x0,0x0,0x0,0x0,0x0,0x0,0x0
.long 0x0,0x0,0x0,0x0,0x0,0x0,0x0,0x0
.long 0x0,0x0,0x0,0x0,0x0,0x0,0x0,0x0
.long 0x3f800000,0x3f7c1c5c,0x3f708fb2,0x3f5db3d7,0x3f800000,0x3f7b9c62,0x3f6e9811,0x3f596550
.long 0x3f800000,0x3f7b14be,0x3f6c835e,0x3f54db31,0x3f800000,0x3f7a8575,0x3f6a51da,0x3f5016b8
.long 0x3f800000,0x3f79ee89,0x3f6803ca,0x3f4b1934,0x3f800000,0x3f795000,0x3f659974,0x3f45e403
.long 0x3f800000,0x3f78a9e0,0x3f631324,0x3f407893,0x3f800000,0x3f77fc2c,0x3f60712a,0x3f3ad85f
.long 0x3f800000,0x3f7746ea,0x3f5db3d7,0x3f3504f3,0x3f800000,0x3f768a20,0x3f5adb81,0x3f2effe8
.long 0x3f800000,0x3f75c5d4,0x3f57e880,0x3f28cae3,0x3f800000,0x3f74fa0b,0x3f54db31,0x3f226799
.long 0x3f800000,0x3f7426cb,0x3f51b3f3,0x3f1bd7ca,0x3f800000,0x3f734c1c,0x3f4e7327,0x3f151d42
.long 0x3f800000,0x3f726a03,0x3f4b1934,0x3f0e39da,0x3f800000,0x3f718088,0x3f47a682,0x3f072f74
.long 0x3f441b7d,0x3f248dbb,0x3f000000,0x3eaf1d44,0x3f3cbe35,0x3f199e45,0x3ee273aa,0x3e89e6f1
.long 0x3f3504f3,0x3f0e39da,0x3ec3ef15,0x3e47c5c2,0x3f2cf37b,0x3f026926,0x3ea493b7,0x3df52731
.long 0x3f248dbb,0x3eec6a50,0x3e8483ee,0x3d32aa3e,0x3f1bd7ca,0x3ed34e56,0x3e47c5c2,0xbd060472
.long 0x3f12d5e8,0x3eb9917b,0x3e05a8a8,0xbddef599,0x3f098c78,0x3e9f4757,0x3d85f213,0xbe3cce2b
.long 0x3f000000,0x3e8483ee,0x248d3132,0xbe8483ee,0x3eec6a50,0x3e52b743,0xbd85f213,0xbea9db13
.long 0x3ed8616c,0x3e1bc63c,0xbe05a8a8,0xbece34d0,0x3ec3ef15,0x3dc8bd36,0xbe47c5c2,0xbef15aea
.long 0x3eaf1d44,0x3d32aa3e,0xbe8483ee,0xbf098c78,0x3e99f61c,0xbc32b7da,0xbea493b7,0xbf199e45
.long 0x3e8483ee,0xbd85f213,0xbec3ef15,0xbf28cae3,0x3e5da259,0xbdf52731,0xbee273aa,0xbf36fbaf
.long 0x3e31d0d4,0x248d3132,0xbe31d0d4,0xbeaf1d44,0x3db27eb6,0xbdc8bd36,0xbe8f45c0,0xbee77284
.long 0x248d3132,0xbe47c5c2,0xbec3ef15,0xbf0e39da,0xbdb27eb6,0xbe94a031,0xbef64429,0xbf26aed9
.long 0xbe31d0d4,0xbec3ef15,0xbf12d5e8,0xbf3cbe35,0xbe8483ee,0xbef15aea,0xbf28cae3,0xbf5016b8
.long 0xbeaf1d44,0xbf0e39da,0xbf3cbe35,0xbf60712a,0xbed8616c,0xbf226799,0xbf4e7327,0xbf6d9156
.long 0xbf000000,0xbf3504f3,0xbf5db3d7,0xbf7746ea,0xbf12d5e8,0xbf45e403,0xbf6a51da,0xbf7d6e28
.long 0xbf248dbb,0xbf54db31,0xbf7426cb,0xbf7ff067,0xbf3504f3,0xbf61c598,0xbf7b14be,0xbf7ec46d
.long 0xbf441b7d,0xbf6c835e,0xbf7f069e,0xbf79ee89,0xbf51b3f3,0xbf74fa0b,0xbf7ff067,0xbf718088
.long 0xbf5db3d7,0xbf7b14be,0xbf7dcf55,0xbf659974,0xbf6803ca,0xbf7ec46d,0xbf78a9e0,0xbf56651d
.long 0xbf000000,0xbf248dbb,0xbf441b7d,0xbf5db3d7,0xbf1bd7ca,0xbf3e9e4b,0xbf5adb81,0xbf6f9788
.long 0xbf3504f3,0xbf54db31,0xbf6c835e,0xbf7b14be,0xbf4b1934,0xbf66d223,0xbf78a9e0,0xbf7fdce9
.long 0xbf5db3d7,0xbf7426cb,0xbf7f069e,0xbf7dcf55,0xbf6c835e,0xbf7c94a8,0xbf7f73af,0xbf74fa0b
.long 0xbf7746ea,0xbf7ff067,0xbf79ee89,0xbf659974,0xbf7dcf55,0xbf7e28c6,0xbf6e9811,0xbf5016b8
.long 0xbf800000,0xbf7746ea,0xbf5db3d7,0xbf3504f3,0xbf7dcf55,0xbf6b6e32,0xbf47a682,0xbf151d42
.long 0xbf7746ea,0xbf5adb81,0xbf2cf37b,0xbee273aa,0xbf6c835e,0xbf45e403,0xbf0e39da,0xbe94a031
.long 0xbf5db3d7,0xbf2cf37b,0xbed8616c,0xbe05a8a8,0xbf4b1934,0xbf108a14,0xbe8f45c0,0x3d060472
.long 0xbf3504f3,0xbee273aa,0xbe05a8a8,0x3e47c5c2,0xbf1bd7ca,0xbe9f4757,0x3cb2b521,0x3eb45a1e
.long 0x0,0x3e31d0d4,0x3eaf1d44,0x3f000000,0x0,0x3e3cce2b,0x3eb9917b,0x3f072f74
.long 0x0,0x3e47c5c2,0x3ec3ef15,0x3f0e39da,0x0,0x3e52b743,0x3ece34d0,0x3f151d42
.long 0x0,0x3e5da259,0x3ed8616c,0x3f1bd7ca,0x0,0x3e6886ae,0x3ee273aa,0x3f226799
.long 0x0,0x3e7363ee,0x3eec6a50,0x3f28cae3,0x0,0x3e7e39c4,0x3ef64429,0x3f2effe8
.long 0x0,0x3e8483ee,0x3f000000,0x3f3504f3,0x0,0x3e89e6f1,0x3f04ce53,0x3f3ad85f
.long 0x0,0x3e8f45c0,0x3f098c78,0x3f407893,0x0,0x3e94a031,0x3f0e39da,0x3f45e403
.long 0x0,0x3e99f61c,0x3f12d5e8,0x3f4b1934,0x0,0x3e9f4757,0x3f176012,0x3f5016b8
.long 0x0,0x3ea493b7,0x3f1bd7ca,0x3f54db31,0x0,0x3ea9db13,0x3f203c85,0x3f596550
.long 0x3f248dbb,0x3f441b7d,0x3f5db3d7,0x3f708fb2,0x3f2cf37b,0x3f4cc94c,0x3f659974,0x3f768a20
.long 0x3f3504f3,0x3f54db31,0x3f6c835e,0x3f7b14be,0x3f3cbe35,0x3f5c4b07,0x3f726a03,0x3f7e28c6
.long 0x3f441b7d,0x3f631324,0x3f7746ea,0x3f7fc1a0,0x3f4b1934,0x3f692e5f,0x3f7b14be,0x3f7fdce9
.long 0x3f51b3f3,0x3f6e9811,0x3f7dcf55,0x3f7e7a7a,0x3f57e880,0x3f734c1c,0x3f7f73af,0x3f7b9c62
.long 0x3f5db3d7,0x3f7746ea,0x3f800000,0x3f7746ea,0x3f631324,0x3f7a8575,0x3f7f73af,0x3f718088
.long 0x3f6803ca,0x3f7d0543,0x3f7dcf55,0x3f6a51da,0x3f6c835e,0x3f7ec46d,0x3f7b14be,0x3f61c598
.long 0x3f708fb2,0x3f7fc1a0,0x3f7746ea,0x3f57e880,0x3f7426cb,0x3f7ffc1a,0x3f726a03,0x3f4cc94c
.long 0x3f7746ea,0x3f7f73af,0x3f6c835e,0x3f407893,0x3f79ee89,0x3f7e28c6,0x3f659974,0x3f3308b4
.long 0x3f7c1c5c,0x3f800000,0x3f7c1c5c,0x3f708fb2,0x3f7f069e,0x3f7ec46d,0x3f75c5d4,0x3f6459c6
.long 0x3f800000,0x3f7b14be,0x3f6c835e,0x3f54db31,0x3f7f069e,0x3f74fa0b,0x3f60712a,0x3f424cfe
.long 0x3f7c1c5c,0x3f6c835e,0x3f51b3f3,0x3f2cf37b,0x3f7746ea,0x3f61c598,0x3f407893,0x3f151d42
.long 0x3f708fb2,0x3f54db31,0x3f2cf37b,0x3ef64429,0x3f6803ca,0x3f45e403,0x3f176012,0x3ebec330
.long 0x3f5db3d7,0x3f3504f3,0x3f000000,0x3e8483ee,0x3f51b3f3,0x3f226799,0x3ece34d0,0x3e10b9a6
.long 0x3f441b7d,0x3f0e39da,0x3e99f61c,0x3cb2b521,0x3f3504f3,0x3ef15aea,0x3e47c5c2,0xbdc8bd36
.long 0x3f248dbb,0x3ec3ef15,0x3db27eb6,0xbe5da259,0x3f12d5e8,0x3e94a031,0xbcb2b521,0xbea9db13
.long 0x3f000000,0x3e47c5c2,0xbe05a8a8,0xbee273aa,0x3ed8616c,0x3dc8bd36,0xbe7363ee,0xbf0be54a
.long 0x3f5db3d7,0x3f441b7d,0x3f248dbb,0x3f000000,0x3f4b1934,0x3f2ae1c9,0x3f04ce53,0x3eb45a1e
.long 0x3f3504f3,0x3f0e39da,0x3ec3ef15,0x3e47c5c2,0x3f1bd7ca,0x3edd6dea,0x3e7363ee,0x3d060472
.long 0x3f000000,0x3e99f61c,0x3db27eb6,0xbe05a8a8,0x3ec3ef15,0x3e26ce12,0xbd85f213,0xbe94a031
.long 0x3e8483ee,0x3cb2b521,0xbe5da259,0xbee273aa,0x3e05a8a8,0xbdf52731,0xbeb9917b,0xbf151d42
.long 0x250d3132,0xbe8483ee,0xbf000000,0xbf3504f3,0xbe05a8a8,0xbec91503,0xbf203c85,0xbf5016b8
.long 0xbe8483ee,0xbf04ce53,0xbf3cbe35,0xbf659974,0xbec3ef15,0xbf226799,0xbf54db31,0xbf74fa0b
.long 0xbf000000,0xbf3cbe35,0xbf6803ca,0xbf7dcf55,0xbf1bd7ca,0xbf534aca,0xbf75c5d4,0xbf7fdce9
.long 0xbf3504f3,0xbf659974,0xbf7dcf55,0xbf7b14be,0xbf4b1934,0xbf734c1c,0xbf7ff067,0xbf6f9788
.long 0xbf708fb2,0xbf7c1c5c,0x3eaf1d44,0x3e31d0d4,0xbf7c1c5c,0xbf7ffc1a,0x3e31d0d4,0xbc32b7da
.long 0xbf800000,0xbf7b14be,0x250d3132,0xbe47c5c2,0xbf7c1c5c,0xbf6d9156,0xbe31d0d4,0xbebec330
.long 0xbf708fb2,0xbf57e880,0xbeaf1d44,0xbf098c78,0xbf5db3d7,0xbf3ad85f,0xbf000000,0xbf2effe8
.long 0xbf441b7d,0xbf176012,0xbf248dbb,0xbf4e7327,0xbf248dbb,0xbedd6dea,0xbf441b7d,0xbf66d223
.long 0xbf000000,0xbe8483ee,0xbf5db3d7,0xbf7746ea,0xbeaf1d44,0xbd9c3ac6,0xbf708fb2,0xbf7f4109
.long 0xbe31d0d4,0x3ddef599,0xbf7c1c5c,0xbf7e7a7a,0xa553c9ca,0x3e94a031,0xbf800000,0xbf74fa0b
.long 0x3e31d0d4,0x3eec6a50,0xbf7c1c5c,0xbf631324,0x3eaf1d44,0x3f1e0c90,0xbf708fb2,0xbf4962ed
.long 0x3f000000,0x3f407893,0xbf5db3d7,0xbf28cae3,0x3f248dbb,0x3f5c4b07,0xbf441b7d,0xbf026926
.long 0x0,0x0,0x0,0x0,0x0,0x0,0x0,0x0
.long 0x0,0x0,0x0,0x0,0x0,0x0,0x0,0x0
.long 0x0,0x0,0x0,0x0,0x0,0x0,0x0,0x0
.long 0x0,0x0,0x0,0x0,0x0,0x0,0x0,0x0
.long 0x0,0x0,0x0,0x0,0x0,0x0,0x0,0x0
.long 0x0,0x0,0x0,0x0,0x0,0x0,0x0,0x0
.long 0x0,0x0,0x0,0x0,0x0,0x0,0x0,0x0
.long 0x0,0x0,0x0,0x0,0x0,0x0,0x0,0x0
.long 0x0,0x0,0x0,0x0,0x0,0x0,0x0,0x0
.long 0x0,0x0,0x0,0x0,0x0,0x0,0x0,0x0
.long 0x0,0x0,0x0,0x0,0x0,0x0,0x0,0x0
.long 0x0,0x0,0x0,0x0,0x0,0x0,0x0,0x0
.long 0x0,0x0,0x0,0x0,0x0,0x0,0x0,0x0
.long 0x0,0x0,0x0,0x0,0x0,0x0,0x0,0x0
.long 0x0,0x0,0x0,0x0,0x0,0x0,0x0,0x0
.long 0x0,0x0,0x0,0x0,0x0,0x0,0x0,0x0
.long 0x0,0x0,0x0,0x0,0x0,0x0,0x0,0x0
.long 0x0,0x0,0x0,0x0,0x0,0x0,0x0,0x0
.long 0x0,0x0,0x0,0x0,0x0,0x0,0x0,0x0
.long 0x0,0x0,0x0,0x0,0x0,0x0,0x0,0x0
.long 0x0,0x0,0x0,0x0,0x0,0x0,0x0,0x0
.long 0x0,0x0,0x0,0x0,0x0,0x0,0x0,0x0
.long 0x0,0x0,0x0,0x0,0x0,0x0,0x0,0x0
.long 0x0,0x0,0x0,0x0,0x0,0x0,0x0,0x0
.long 0x3f800000,0x3f800000,0x3f800000,0x3f800000,0x3f800000,0x3f7fec43,0x3f7fb10f,0x3f7f4e6d
.long 0x3f800000,0x3f7fb10f,0x3f7ec46d,0x3f7d3aac,0x3f800000,0x3f7f4e6d,0x3f7d3aac,0x3f79c79d
.long 0x3f800000,0x3f7ec46d,0x3f7b14be,0x3f74fa0b,0x3f800000,0x3f7e1324,0x3f7853f8,0x3f6ed89e
.long 0x3f800000,0x3f7d3aac,0x3f74fa0b,0x3f676bd8,0x3f800000,0x3f7c3b28,0x3f710908,0x3f5ebe05
.long 0x3f800000,0x3f7b14be,0x3f6c835e,0x3f54db31,0x3f800000,0x3f79c79d,0x3f676bd8,0x3f49d112
.long 0x3f800000,0x3f7853f8,0x3f61c598,0x3f3daef9,0x3f800000,0x3f76ba07,0x3f5b941a,0x3f3085bb
.long 0x3f800000,0x3f74fa0b,0x3f54db31,0x3f226799,0x3f800000,0x3f731447,0x3f4d9f02,0x3f13682a
.long 0x3f800000,0x3f710908,0x3f45e403,0x3f039c3d,0x3f800000,0x3f6ed89e,0x3f3daef9,0x3ee63375
.long 0x3f800000,0x3f800000,0x3f800000,0x3f800000,0x3f7ec46d,0x3f7e1324,0x3f7d3aac,0x3f7c3b28
.long 0x3f7b14be,0x3f7853f8,0x3f74fa0b,0x3f710908,0x3f74fa0b,0x3f6ed89e,0x3f676bd8,0x3f5ebe05
.long 0x3f6c835e,0x3f61c598,0x3f54db31,0x3f45e403,0x3f61c598,0x3f514d3d,0x3f3daef9,0x3f273656
.long 0x3f54db31,0x3f3daef9,0x3f226799,0x3f039c3d,0x3f45e403,0x3f273656,0x3f039c3d,0x3eb8442a
.long 0x3f3504f3,0x3f0e39da,0x3ec3ef15,0x3e47c5c2,0x3f226799,0x3ee63375,0x3e78cfcc,0x3cc90ab0
.long 0x3f0e39da,0x3eac7cd4,0x3dc8bd36,0xbe164083,0x3ef15aea,0x3e605c13,0xbd48fb30,0xbea09ae5
.long 0x3ec3ef15,0x3dc8bd36,0xbe47c5c2,0xbef15aea,0x3e94a031,0xbcc90ab0,0xbeac7cd4,0xbf1d7fd1
.long 0x3e47c5c2,0xbe164083,0xbef15aea,0xbf3daef9,0x3dc8bd36,0xbe888e93,0xbf187fc0,0xbf584853
.long 0x3f800000,0x3f800000,0x3f800000,0x3f800000,0x3f7b14be,0x3f79c79d,0x3f7853f8,0x3f76ba07
.long 0x3f6c835e,0x3f676bd8,0x3f61c598,0x3f5b941a,0x3f54db31,0x3f49d112,0x3f3daef9,0x3f3085bb
.long 0x3f3504f3,0x3f226799,0x3f0e39da,0x3ef15aea,0x3f0e39da,0x3ee63375,0x3eac7cd4,0x3e605c13
.long 0x3ec3ef15,0x3e78cfcc,0x3dc8bd36,0xbd48fb30,0x3e47c5c2,0x3cc90ab0,0xbe164083,0xbea09ae5
.long 0x248d3132,0xbe47c5c2,0xbec3ef15,0xbf0e39da,0xbe47c5c2,0xbecf7bca,0xbf187fc0,0xbf41d870
.long 0xbec3ef15,0xbf187fc0,0xbf45e403,0xbf676bd8,0xbf0e39da,0xbf41d870,0xbf676bd8,0xbf7c3b28
.long 0xbf3504f3,0xbf61c598,0xbf7b14be,0xbf7ec46d,0xbf54db31,0xbf76ba07,0xbf7fb10f,0xbf6ed89e
.long 0xbf6c835e,0xbf7fb10f,0xbf74fa0b,0xbf4d9f02,0xbf7b14be,0xbf7c3b28,0xbf5b941a,0xbf1d7fd1
.long 0x3f800000,0x3f800000,0x3f800000,0x3f800000,0x3f74fa0b,0x3f731447,0x3f710908,0x3f6ed89e
.long 0x3f54db31,0x3f4d9f02,0x3f45e403,0x3f3daef9,0x3f226799,0x3f13682a,0x3f039c3d,0x3ee63375
.long 0x3ec3ef15,0x3e94a031,0x3e47c5c2,0x3dc8bd36,0x3dc8bd36,0xbcc90ab0,0xbe164083,0xbe888e93
.long 0xbe47c5c2,0xbeac7cd4,0xbef15aea,0xbf187fc0,0xbef15aea,0xbf1d7fd1,0xbf3daef9,0xbf584853
.long 0xbf3504f3,0xbf54db31,0xbf6c835e,0xbf7b14be,0xbf61c598,0xbf76ba07,0xbf7fb10f,0xbf7c3b28
.long 0xbf7b14be,0xbf7fb10f,0xbf74fa0b,0xbf5b941a,0xbf7ec46d,0xbf6ed89e,0xbf4d9f02,0xbf1d7fd1
.long 0xbf6c835e,0xbf45e403,0xbf0e39da,0xbe94a031,0xbf45e403,0xbf08f59b,0xbe78cfcc,0x3d96a905
.long 0xbf0e39da,0xbe78cfcc,0x3dc8bd36,0x3edae880,0xbe94a031,0x3d96a905,0x3edae880,0x3f396842
.long 0x0,0x0,0x0,0x0,0x0,0x3cc90ab0,0x3d48fb30,0x3d96a905
.long 0x0,0x3d48fb30,0x3dc8bd36,0x3e164083,0x0,0x3d96a905,0x3e164083,0x3e605c13
.long 0x0,0x3dc8bd36,0x3e47c5c2,0x3e94a031,0x0,0x3dfab273,0x3e78cfcc,0x3eb8442a
.long 0x0,0x3e164083,0x3e94a031,0x3edae880,0x0,0x3e2f10a2,0x3eac7cd4,0x3efc5d27
.long 0x0,0x3e47c5c2,0x3ec3ef15,0x3f0e39da,0x0,0x3e605c13,0x3edae880,0x3f1d7fd1
.long 0x0,0x3e78cfcc,0x3ef15aea,0x3f2beb4a,0x0,0x3e888e93,0x3f039c3d,0x3f396842
.long 0x0,0x3e94a031,0x3f0e39da,0x3f45e403,0x0,0x3ea09ae5,0x3f187fc0,0x3f514d3d
.long 0x0,0x3eac7cd4,0x3f226799,0x3f5b941a,0x0,0x3eb8442a,0x3f2beb4a,0x3f64aa59
.long 0x0,0x0,0x0,0x0,0x3dc8bd36,0x3dfab273,0x3e164083,0x3e2f10a2
.long 0x3e47c5c2,0x3e78cfcc,0x3e94a031,0x3eac7cd4,0x3e94a031,0x3eb8442a,0x3edae880,0x3efc5d27
.long 0x3ec3ef15,0x3ef15aea,0x3f0e39da,0x3f226799,0x3ef15aea,0x3f13682a,0x3f2beb4a,0x3f41d870
.long 0x3f0e39da,0x3f2beb4a,0x3f45e403,0x3f5b941a,0x3f226799,0x3f41d870,0x3f5b941a,0x3f6ed89e
.long 0x3f3504f3,0x3f54db31,0x3f6c835e,0x3f7b14be,0x3f45e403,0x3f64aa59,0x3f7853f8,0x3f7fec43
.long 0x3f54db31,0x3f710908,0x3f7ec46d,0x3f7d3aac,0x3f61c598,0x3f79c79d,0x3f7fb10f,0x3f731447
.long 0x3f6c835e,0x3f7ec46d,0x3f7b14be,0x3f61c598,0x3f74fa0b,0x3f7fec43,0x3f710908,0x3f49d112
.long 0x3f7b14be,0x3f7d3aac,0x3f61c598,0x3f2beb4a,0x3f7ec46d,0x3f76ba07,0x3f4d9f02,0x3f08f59b
.long 0x0,0x0,0x0,0x0,0x3e47c5c2,0x3e605c13,0x3e78cfcc,0x3e888e93
.long 0x3ec3ef15,0x3edae880,0x3ef15aea,0x3f039c3d,0x3f0e39da,0x3f1d7fd1,0x3f2beb4a,0x3f396842
.long 0x3f3504f3,0x3f45e403,0x3f54db31,0x3f61c598,0x3f54db31,0x3f64aa59,0x3f710908,0x3f79c79d
.long 0x3f6c835e,0x3f7853f8,0x3f7ec46d,0x3f7fb10f,0x3f7b14be,0x3f7fec43,0x3f7d3aac,0x3f731447
.long 0x3f800000,0x3f7b14be,0x3f6c835e,0x3f54db31,0x3f7b14be,0x3f6a09a7,0x3f4d9f02,0x3f273656
.long 0x3f6c835e,0x3f4d9f02,0x3f226799,0x3edae880,0x3f54db31,0x3f273656,0x3edae880,0x3e2f10a2
.long 0x3f3504f3,0x3ef15aea,0x3e47c5c2,0xbdc8bd36,0x3f0e39da,0x3e888e93,0xbd48fb30,0xbeb8442a
.long 0x3ec3ef15,0x3d48fb30,0xbe94a031,0xbf187fc0,0x3e47c5c2,0xbe2f10a2,0xbf039c3d,0xbf49d112
.long 0x0,0x0,0x0,0x0,0x3e94a031,0x3ea09ae5,0x3eac7cd4,0x3eb8442a
.long 0x3f0e39da,0x3f187fc0,0x3f226799,0x3f2beb4a,0x3f45e403,0x3f514d3d,0x3f5b941a,0x3f64aa59
.long 0x3f6c835e,0x3f74fa0b,0x3f7b14be,0x3f7ec46d,0x3f7ec46d,0x3f7fec43,0x3f7d3aac,0x3f76ba07
.long 0x3f7b14be,0x3f710908,0x3f61c598,0x3f4d9f02,0x3f61c598,0x3f49d112,0x3f2beb4a,0x3f08f59b
.long 0x3f3504f3,0x3f0e39da,0x3ec3ef15,0x3e47c5c2,0x3ef15aea,0x3e888e93,0x3d48fb30,0xbe2f10a2
.long 0x3e47c5c2,0xbd48fb30,0xbe94a031,0xbf039c3d,0xbdc8bd36,0xbeb8442a,0xbf187fc0,0xbf49d112
.long 0xbec3ef15,0xbf226799,0xbf54db31,0xbf74fa0b,0xbf226799,0xbf584853,0xbf7853f8,0xbf7f4e6d
.long 0xbf54db31,0xbf7853f8,0xbf7ec46d,0xbf676bd8,0xbf74fa0b,0xbf7f4e6d,0xbf676bd8,0xbf3085bb
.long 0x29182600,0x2f482c30,0x38902600,0x2003680,0x29202608,0x2f502c38,0x39982708,0x2023788
.long 0x29282610,0x2f582c40,0x3aa02810,0x2044910,0x29282610,0x2f582c40,0x3ba82918,0x2064a18
.long 0x29302618,0x2f602c48,0x3cb02a20,0x2084b20,0x29382620,0x2f682c50,0x3db82b28,0x20a4b20
.long 0x29402628,0x2f702c58,0x3ec02c30,0x20c4b20,0x29402628,0x2f702c58,0x3fc82d38,0x20e4b20
.long 0x29482630,0x2f782c60,0x40d02e40,0x2104b20,0x29502638,0x2f802c68,0x41d82f48,0x2124b20
.long 0x29582640,0x2f882c70,0x42e03050,0x2144b20,0x29582640,0x2f882c70,0x43e83158,0x2164b20
.long 0x29602648,0x2f902c78,0x44f03260,0x2184b20,0x29682650,0x2f982c80,0x45f83368,0x21a4b20
.long 0x29702658,0x2fa02c88,0x47003470,0x21c4b20,0x29702658,0x2fa02c88,0x48083578,0x21e4b20
.long 0x3ba83890,0x41d83ec0,0x38b02620,0x22036a0,0x3bb03898,0x41e03ec8,0x39b82728,0x22237a8
.long 0x3bb838a0,0x41e83ed0,0x3ac02830,0x2244930,0x3bb838a0,0x41e83ed0,0x3bc82938,0x2264a38
.long 0x3bc038a8,0x41f03ed8,0x3cd02a40,0x2284b20,0x3bc838b0,0x41f83ee0,0x3dd82b48,0x22a4b20
.long 0x3bd038b8,0x42003ee8,0x3ee02c50,0x22c4b20,0x3bd038b8,0x42003ee8,0x3fe82d58,0x22e4b20
.long 0x3bd838c0,0x42083ef0,0x40f02e60,0x2304b20,0x3be038c8,0x42103ef8,0x41f82f68,0x2324b20
.long 0x3be838d0,0x42183f00,0x43003070,0x2344b20,0x3be838d0,0x42183f00,0x44083178,0x2364b20
.long 0x3bf038d8,0x42203f08,0x45103280,0x2384b20,0x3bf838e0,0x42283f10,0x46183388,0x23a4b20
.long 0x3c0038e8,0x42303f18,0x47203490,0x23c4b20,0x3c0038e8,0x42303f18,0x48283598,0x23e4b20
.long 0x35782600,0x2f483260,0x38d02640,0x48036c0,0x35683880,0x2f383250,0x39d82748,0x48237c8
.long 0x35603878,0x2f303248,0x3ae02850,0x4844950,0x35603878,0x2f303248,0x3be82958,0x4864a58
.long 0x35583870,0x2f283240,0x3cf02a60,0x4884b20,0x35503868,0x2f203238,0x3df82b68,0x48a4b20
.long 0x35483860,0x2f183230,0x3f002c70,0x48c4b20,0x35483860,0x2f183230,0x40082d78,0x48e4b20
.long 0x35403858,0x2f103228,0x41102e80,0x4904b20,0x35383850,0x2f083220,0x42182f88,0x4924b20
.long 0x35303848,0x2f003218,0x43203090,0x4944b20,0x35303848,0x2f003218,0x44283198,0x4964b20
.long 0x35283840,0x2ef83210,0x453032a0,0x4984b20,0x35203838,0x2ef03208,0x463833a8,0x49a4b20
.long 0x35183830,0x2ee83200,0x474034b0,0x49c4b20,0x35183830,0x2ee83200,0x484835b8,0x49e4b20
.long 0x48083890,0x41d844f0,0x38f02660,0x4a036e0,0x47f84b10,0x41c844e0,0x39f82768,0x4a237e8
.long 0x47f04b08,0x41c044d8,0x3b002870,0x4a44970,0x47f04b08,0x41c044d8,0x3c082978,0x4a64a78
.long 0x47e84b00,0x41b844d0,0x3d102a80,0x4a84b20,0x47e04af8,0x41b044c8,0x3e182b88,0x4aa4b20
.long 0x47d84af0,0x41a844c0,0x3f202c90,0x4ac4b20,0x47d84af0,0x41a844c0,0x40282d98,0x4ae4b20
.long 0x47d04ae8,0x41a044b8,0x41302ea0,0x4b04b20,0x47c84ae0,0x419844b0,0x42382fa8,0x4b24b20
.long 0x47c04ad8,0x419044a8,0x434030b0,0x4b44b20,0x47c04ad8,0x419044a8,0x444831b8,0x4b64b20
.long 0x47b84ad0,0x418844a0,0x455032c0,0x4b84b20,0x47b04ac8,0x41804498,0x465833c8,0x4ba4b20
.long 0x47a84ac0,0x41784490,0x476034d0,0x4bc4b20,0x47a84ac0,0x41784490,0x486835d8,0x4be4b20
.long 0x29782660,0x2f482c90,0x38922602,0xb003682,0x29802668,0x2f502c98,0x399a270a,0xb02378a
.long 0x29882670,0x2f582ca0,0x3aa22812,0xb044912,0x29882670,0x2f582ca0,0x3baa291a,0xb064a1a
.long 0x29902678,0x2f602ca8,0x3cb22a22,0xb084b20,0x29982680,0x2f682cb0,0x3dba2b2a,0xb0a4b20
.long 0x29a02688,0x2f702cb8,0x3ec22c32,0xb0c4b20,0x29a02688,0x2f702cb8,0x3fca2d3a,0xb0e4b20
.long 0x29a82690,0x2f782cc0,0x40d22e42,0xb104b20,0x29b02698,0x2f802cc8,0x41da2f4a,0xb124b20
.long 0x29b826a0,0x2f882cd0,0x42e23052,0xb144b20,0x29b826a0,0x2f882cd0,0x43ea315a,0xb164b20
.long 0x29c026a8,0x2f902cd8,0x44f23262,0xb184b20,0x29c826b0,0x2f982ce0,0x45fa336a,0xb1a4b20
.long 0x29d026b8,0x2fa02ce8,0x47023472,0xb1c4b20,0x29d026b8,0x2fa02ce8,0x480a357a,0xb1e4b20
.long 0x3c0838f0,0x41d83f20,0x38b22622,0xb2036a2,0x3c1038f8,0x41e03f28,0x39ba272a,0xb2237aa
.long 0x3c183900,0x41e83f30,0x3ac22832,0xb244932,0x3c183900,0x41e83f30,0x3bca293a,0xb264a3a
.long 0x3c203908,0x41f03f38,0x3cd22a42,0xb284b20,0x3c283910,0x41f83f40,0x3dda2b4a,0xb2a4b20
.long 0x3c303918,0x42003f48,0x3ee22c52,0xb2c4b20,0x3c303918,0x42003f48,0x3fea2d5a,0xb2e4b20
.long 0x3c383920,0x42083f50,0x40f22e62,0xb304b20,0x3c403928,0x42103f58,0x41fa2f6a,0xb324b20
.long 0x3c483930,0x42183f60,0x43023072,0xb344b20,0x3c483930,0x42183f60,0x440a317a,0xb364b20
.long 0x3c503938,0x42203f68,0x45123282,0xb384b20,0x3c583940,0x42283f70,0x461a338a,0xb3a4b20
.long 0x3c603948,0x42303f78,0x47223492,0xb3c4b20,0x3c603948,0x42303f78,0x482a359a,0xb3e4b20
.long 0x35103828,0x2f4831f8,0x38d22642,0xd8036c2,0x35083820,0x2f3831f0,0x39da274a,0xd8237ca
.long 0x35003818,0x2f3031e8,0x3ae22852,0xd844952,0x35003818,0x2f3031e8,0x3bea295a,0xd864a5a
.long 0x34f83810,0x2f2831e0,0x3cf22a62,0xd884b20,0x34f03808,0x2f2031d8,0x3dfa2b6a,0xd8a4b20
.long 0x34e83800,0x2f1831d0,0x3f022c72,0xd8c4b20,0x34e83800,0x2f1831d0,0x400a2d7a,0xd8e4b20
.long 0x34e037f8,0x2f1031c8,0x41122e82,0xd904b20,0x34d837f0,0x2f0831c0,0x421a2f8a,0xd924b20
.long 0x34d037e8,0x2f0031b8,0x43223092,0xd944b20,0x34d037e8,0x2f0031b8,0x442a319a,0xd964b20
.long 0x34c837e0,0x2ef831b0,0x453232a2,0xd984b20,0x34c037d8,0x2ef031a8,0x463a33aa,0xd9a4b20
.long 0x34b837d0,0x2ee831a0,0x474234b2,0xd9c4b20,0x34b837d0,0x2ee831a0,0x484a35ba,0xd9e4b20
.long 0x47a04ab8,0x41d84488,0x38f22662,0xda036e2,0x47984ab0,0x41c84480,0x39fa276a,0xda237ea
.long 0x47904aa8,0x41c04478,0x3b022872,0xda44972,0x47904aa8,0x41c04478,0x3c0a297a,0xda64a7a
.long 0x47884aa0,0x41b84470,0x3d122a82,0xda84b20,0x47804a98,0x41b04468,0x3e1a2b8a,0xdaa4b20
.long 0x47784a90,0x41a84460,0x3f222c92,0xdac4b20,0x47784a90,0x41a84460,0x402a2d9a,0xdae4b20
.long 0x47704a88,0x41a04458,0x41322ea2,0xdb04b20,0x47684a80,0x41984450,0x423a2faa,0xdb24b20
.long 0x47604a78,0x41904448,0x434230b2,0xdb44b20,0x47604a78,0x41904448,0x444a31ba,0xdb64b20
.long 0x47584a70,0x41884440,0x455232c2,0xdb84b20,0x47504a68,0x41804438,0x465a33ca,0xdba4b20
.long 0x47484a60,0x41784430,0x476234d2,0xdbc4b20,0x47484a60,0x41784430,0x486a35da,0xdbe4b20
.long 0x29d826c0,0x2f482cf0,0x38942604,0x14003684,0x29e026c8,0x2f502cf8,0x399c270c,0x1402378c
.long 0x29e826d0,0x2f582d00,0x3aa42814,0x14044914,0x29e826d0,0x2f582d00,0x3bac291c,0x14064a1c
.long 0x29f026d8,0x2f602d08,0x3cb42a24,0x14084b20,0x29f826e0,0x2f682d10,0x3dbc2b2c,0x140a4b20
.long 0x2a0026e8,0x2f702d18,0x3ec42c34,0x140c4b20,0x2a0026e8,0x2f702d18,0x3fcc2d3c,0x140e4b20
.long 0x2a0826f0,0x2f782d20,0x40d42e44,0x14104b20,0x2a1026f8,0x2f802d28,0x41dc2f4c,0x14124b20
.long 0x2a202708,0x2f882d38,0x42e43054,0x14144b20,0x2a202708,0x2f882d38,0x43ec315c,0x14164b20
.long 0x2a282710,0x2f902d40,0x44f43264,0x14184b20,0x2a302718,0x2f982d48,0x45fc336c,0x141a4b20
.long 0x2a382720,0x2fa02d50,0x47043474,0x141c4b20,0x2a382720,0x2fa02d50,0x480c357c,0x141e4b20
.long 0x3c683950,0x41d83f80,0x38b42624,0x142036a4,0x3c703958,0x41e03f88,0x39bc272c,0x142237ac
.long 0x3c783960,0x41e83f90,0x3ac42834,0x14244934,0x3c783960,0x41e83f90,0x3bcc293c,0x14264a3c
.long 0x3c803968,0x41f03f98,0x3cd42a44,0x14284b20,0x3c883970,0x41f83fa0,0x3ddc2b4c,0x142a4b20
.long 0x3c903978,0x42003fa8,0x3ee42c54,0x142c4b20,0x3c903978,0x42003fa8,0x3fec2d5c,0x142e4b20
.long 0x3c983980,0x42083fb0,0x40f42e64,0x14304b20,0x3ca03988,0x42103fb8,0x41fc2f6c,0x14324b20
.long 0x3cb03998,0x42183fc8,0x43043074,0x14344b20,0x3cb03998,0x42183fc8,0x440c317c,0x14364b20
.long 0x3cb839a0,0x42203fd0,0x45143284,0x14384b20,0x3cc039a8,0x42283fd8,0x461c338c,0x143a4b20
.long 0x3cc839b0,0x42303fe0,0x47243494,0x143c4b20,0x3cc839b0,0x42303fe0,0x482c359c,0x143e4b20
.long 0x34b037c8,0x2f483198,0x38d42644,0x168036c4,0x34a837c0,0x2f383190,0x39dc274c,0x168237cc
.long 0x34a037b8,0x2f303188,0x3ae42854,0x16844954,0x34a037b8,0x2f303188,0x3bec295c,0x16864a5c
.long 0x349837b0,0x2f283180,0x3cf42a64,0x16884b20,0x349037a8,0x2f203178,0x3dfc2b6c,0x168a4b20
.long 0x348837a0,0x2f183170,0x3f042c74,0x168c4b20,0x348837a0,0x2f183170,0x400c2d7c,0x168e4b20
.long 0x34803798,0x2f103168,0x41142e84,0x16904b20,0x34783790,0x2f083160,0x421c2f8c,0x16924b20
.long 0x34703788,0x2f003158,0x43243094,0x16944b20,0x34703788,0x2f003158,0x442c319c,0x16964b20
.long 0x34603778,0x2ef83148,0x453432a4,0x16984b20,0x34583770,0x2ef03140,0x463c33ac,0x169a4b20
.long 0x34503768,0x2ee83138,0x474434b4,0x169c4b20,0x34503768,0x2ee83138,0x484c35bc,0x169e4b20
.long 0x47404a58,0x41d84428,0x38f42664,0x16a036e4,0x47384a50,0x41c84420,0x39fc276c,0x16a237ec
.long 0x47304a48,0x41c04418,0x3b042874,0x16a44974,0x47304a48,0x41c04418,0x3c0c297c,0x16a64a7c
.long 0x47284a40,0x41b84410,0x3d142a84,0x16a84b20,0x47204a38,0x41b04408,0x3e1c2b8c,0x16aa4b20
.long 0x47184a30,0x41a84400,0x3f242c94,0x16ac4b20,0x47184a30,0x41a84400,0x402c2d9c,0x16ae4b20
.long 0x47104a28,0x41a043f8,0x41342ea4,0x16b04b20,0x47084a20,0x419843f0,0x423c2fac,0x16b24b20
.long 0x47004a18,0x419043e8,0x434430b4,0x16b44b20,0x47004a18,0x419043e8,0x444c31bc,0x16b64b20
.long 0x46f04a08,0x418843d8,0x455432c4,0x16b84b20,0x46e84a00,0x418043d0,0x465c33cc,0x16ba4b20
.long 0x46e049f8,0x417843c8,0x476434d4,0x16bc4b20,0x46e049f8,0x417843c8,0x486c35dc,0x16be4b20
.long 0x2a402728,0x2f482d58,0x38962606,0x1d003686,0x2a482730,0x2f502d60,0x399e270e,0x1d02378e
.long 0x2a502738,0x2f582d68,0x3aa62816,0x1d044916,0x2a502738,0x2f582d68,0x3bae291e,0x1d064a1e
.long 0x2a582740,0x2f602d70,0x3cb62a26,0x1d084b20,0x2a602748,0x2f682d78,0x3dbe2b2e,0x1d0a4b20
.long 0x2a682750,0x2f702d80,0x3ec62c36,0x1d0c4b20,0x2a682750,0x2f702d80,0x3fce2d3e,0x1d0e4b20
.long 0x2a702758,0x2f782d88,0x40d62e46,0x1d104b20,0x2a782760,0x2f802d90,0x41de2f4e,0x1d124b20
.long 0x2a802768,0x2f882d98,0x42e63056,0x1d144b20,0x2a802768,0x2f882d98,0x43ee315e,0x1d164b20
.long 0x2a882770,0x2f902da0,0x44f63266,0x1d184b20,0x2a902778,0x2f982da8,0x45fe336e,0x1d1a4b20
.long 0x2a982780,0x2fa02db0,0x47063476,0x1d1c4b20,0x2a982780,0x2fa02db0,0x480e357e,0x1d1e4b20
.long 0x3cd039b8,0x41d83fe8,0x38b62626,0x1d2036a6,0x3cd839c0,0x41e03ff0,0x39be272e,0x1d2237ae
.long 0x3ce039c8,0x41e83ff8,0x3ac62836,0x1d244936,0x3ce039c8,0x41e83ff8,0x3bce293e,0x1d264a3e
.long 0x3ce839d0,0x41f04000,0x3cd62a46,0x1d284b20,0x3cf039d8,0x41f84008,0x3dde2b4e,0x1d2a4b20
.long 0x3cf839e0,0x42004010,0x3ee62c56,0x1d2c4b20,0x3cf839e0,0x42004010,0x3fee2d5e,0x1d2e4b20
.long 0x3d0039e8,0x42084018,0x40f62e66,0x1d304b20,0x3d0839f0,0x42104020,0x41fe2f6e,0x1d324b20
.long 0x3d1039f8,0x42184028,0x43063076,0x1d344b20,0x3d1039f8,0x42184028,0x440e317e,0x1d364b20
.long 0x3d183a00,0x42204030,0x45163286,0x1d384b20,0x3d203a08,0x42284038,0x461e338e,0x1d3a4b20
.long 0x3d283a10,0x42304040,0x47263496,0x1d3c4b20,0x3d283a10,0x42304040,0x482e359e,0x1d3e4b20
.long 0x34483760,0x2f483130,0x38d62646,0x1f8036c6,0x34403758,0x2f383128,0x39de274e,0x1f8237ce
.long 0x34383750,0x2f303120,0x3ae62856,0x1f844956,0x34383750,0x2f303120,0x3bee295e,0x1f864a5e
.long 0x34303748,0x2f283118,0x3cf62a66,0x1f884b20,0x34283740,0x2f203110,0x3dfe2b6e,0x1f8a4b20
.long 0x34203738,0x2f183108,0x3f062c76,0x1f8c4b20,0x34203738,0x2f183108,0x400e2d7e,0x1f8e4b20
.long 0x34183730,0x2f103100,0x41162e86,0x1f904b20,0x34103728,0x2f0830f8,0x421e2f8e,0x1f924b20
.long 0x34083720,0x2f0030f0,0x43263096,0x1f944b20,0x34083720,0x2f0030f0,0x442e319e,0x1f964b20
.long 0x34003718,0x2ef830e8,0x453632a6,0x1f984b20,0x33f83710,0x2ef030e0,0x463e33ae,0x1f9a4b20
.long 0x33f03708,0x2ee830d8,0x474634b6,0x1f9c4b20,0x33f03708,0x2ee830d8,0x484e35be,0x1f9e4b20
.long 0x46d849f0,0x41d843c0,0x38f62666,0x1fa036e6,0x46d049e8,0x41c843b8,0x39fe276e,0x1fa237ee
.long 0x46c849e0,0x41c043b0,0x3b062876,0x1fa44976,0x46c849e0,0x41c043b0,0x3c0e297e,0x1fa64a7e
.long 0x46c049d8,0x41b843a8,0x3d162a86,0x1fa84b20,0x46b849d0,0x41b043a0,0x3e1e2b8e,0x1faa4b20
.long 0x46b049c8,0x41a84398,0x3f262c96,0x1fac4b20,0x46b049c8,0x41a84398,0x402e2d9e,0x1fae4b20
.long 0x46a849c0,0x41a04390,0x41362ea6,0x1fb04b20,0x46a049b8,0x41984388,0x423e2fae,0x1fb24b20
.long 0x469849b0,0x41904380,0x434630b6,0x1fb44b20,0x469849b0,0x41904380,0x444e31be,0x1fb64b20
.long 0x469049a8,0x41884378,0x455632c6,0x1fb84b20,0x468849a0,0x41804370,0x465e33ce,0x1fba4b20
.long 0x46804998,0x41784368,0x476634d6,0x1fbc4b20,0x46804998,0x41784368,0x486e35de,0x1fbe4b20
.long 0x2aa02788,0x2f482db8,0x39102680,0x6803700,0x2aa82790,0x2f502dc0,0x3a182788,0x6823808
.long 0x2ab02798,0x2f582dc8,0x3b202890,0x6844990,0x2ab02798,0x2f582dc8,0x3c282998,0x6864a98
.long 0x2ab827a0,0x2f602dd0,0x3d302aa0,0x6884b20,0x2ac027a8,0x2f682dd8,0x3e382ba8,0x68a4b20
.long 0x2ac827b0,0x2f702de0,0x3f402cb0,0x68c4b20,0x2ac827b0,0x2f702de0,0x40482db8,0x68e4b20
.long 0x2ad027b8,0x2f782de8,0x41502ec0,0x6904b20,0x2ad827c0,0x2f802df0,0x42582fc8,0x6924b20
.long 0x2ae027c8,0x2f882df8,0x436030d0,0x6944b20,0x2ae027c8,0x2f882df8,0x446831d8,0x6964b20
.long 0x2ae827d0,0x2f902e00,0x457032e0,0x6984b20,0x2af027d8,0x2f982e08,0x467833e8,0x69a4b20
.long 0x2af827e0,0x2fa02e10,0x478034f0,0x69c4b20,0x2af827e0,0x2fa02e10,0x488835f8,0x69e4b20
.long 0x3d303a18,0x41d84048,0x393026a0,0x6a03720,0x3d383a20,0x41e04050,0x3a3827a8,0x6a23828
.long 0x3d403a28,0x41e84058,0x3b4028b0,0x6a449b0,0x3d403a28,0x41e84058,0x3c4829b8,0x6a64ab8
.long 0x3d483a30,0x41f04060,0x3d502ac0,0x6a84b20,0x3d503a38,0x41f84068,0x3e582bc8,0x6aa4b20
.long 0x3d583a40,0x42004070,0x3f602cd0,0x6ac4b20,0x3d583a40,0x42004070,0x40682dd8,0x6ae4b20
.long 0x3d603a48,0x42084078,0x41702ee0,0x6b04b20,0x3d683a50,0x42104080,0x42782fe8,0x6b24b20
.long 0x3d703a58,0x42184088,0x438030f0,0x6b44b20,0x3d703a58,0x42184088,0x448831f8,0x6b64b20
.long 0x3d783a60,0x42204090,0x45903300,0x6b84b20,0x3d803a68,0x42284098,0x46983408,0x6ba4b20
.long 0x3d883a70,0x423040a0,0x47a03510,0x6bc4b20,0x3d883a70,0x423040a0,0x48a83618,0x6be4b20
.long 0x33e83700,0x2f4830d0,0x395026c0,0x9003740,0x33e036f8,0x2f3830c8,0x3a5827c8,0x9023848
.long 0x33d836f0,0x2f3030c0,0x3b6028d0,0x90449d0,0x33d836f0,0x2f3030c0,0x3c6829d8,0x9064ad8
.long 0x33d036e8,0x2f2830b8,0x3d702ae0,0x9084b20,0x33c836e0,0x2f2030b0,0x3e782be8,0x90a4b20
.long 0x33c036d8,0x2f1830a8,0x3f802cf0,0x90c4b20,0x33c036d8,0x2f1830a8,0x40882df8,0x90e4b20
.long 0x33b836d0,0x2f1030a0,0x41902f00,0x9104b20,0x33b036c8,0x2f083098,0x42983008,0x9124b20
.long 0x33a836c0,0x2f003090,0x43a03110,0x9144b20,0x33a836c0,0x2f003090,0x44a83218,0x9164b20
.long 0x33a036b8,0x2ef83088,0x45b03320,0x9184b20,0x339836b0,0x2ef03080,0x46b83428,0x91a4b20
.long 0x339036a8,0x2ee83078,0x47c03530,0x91c4b20,0x339036a8,0x2ee83078,0x48c83638,0x91e4b20
.long 0x46784990,0x41d84360,0x397026e0,0x9203760,0x46704988,0x41c84358,0x3a7827e8,0x9223868
.long 0x46684980,0x41c04350,0x3b8028f0,0x92449f0,0x46684980,0x41c04350,0x3c8829f8,0x9264af8
.long 0x46604978,0x41b84348,0x3d902b00,0x9284b20,0x46584970,0x41b04340,0x3e982c08,0x92a4b20
.long 0x46504968,0x41a84338,0x3fa02d10,0x92c4b20,0x46504968,0x41a84338,0x40a82e18,0x92e4b20
.long 0x46484960,0x41a04330,0x41b02f20,0x9304b20,0x46404958,0x41984328,0x42b83028,0x9324b20
.long 0x46384950,0x41904320,0x43c03130,0x9344b20,0x46384950,0x41904320,0x44c83238,0x9364b20
.long 0x46304948,0x41884318,0x45d03340,0x9384b20,0x46284940,0x41804310,0x46d83448,0x93a4b20
.long 0x46204938,0x41784308,0x47e03550,0x93c4b20,0x46204938,0x41784308,0x48e83658,0x93e4b20
.long 0x2b0027e8,0x2f482e18,0x39122682,0xf803702,0x2b0827f0,0x2f502e20,0x3a1a278a,0xf82380a
.long 0x2b1027f8,0x2f582e28,0x3b222892,0xf844992,0x2b1027f8,0x2f582e28,0x3c2a299a,0xf864a9a
.long 0x2b182800,0x2f602e30,0x3d322aa2,0xf884b20,0x2b282810,0x2f682e40,0x3e3a2baa,0xf8a4b20
.long 0x2b302818,0x2f702e48,0x3f422cb2,0xf8c4b20,0x2b302818,0x2f702e48,0x404a2dba,0xf8e4b20
.long 0x2b382820,0x2f782e50,0x41522ec2,0xf904b20,0x2b402828,0x2f802e58,0x425a2fca,0xf924b20
.long 0x2b482830,0x2f882e60,0x436230d2,0xf944b20,0x2b482830,0x2f882e60,0x446a31da,0xf964b20
.long 0x2b502838,0x2f902e68,0x457232e2,0xf984b20,0x2b582840,0x2f982e70,0x467a33ea,0xf9a4b20
.long 0x2b602848,0x2fa02e78,0x478234f2,0xf9c4b20,0x2b602848,0x2fa02e78,0x488a35fa,0xf9e4b20
.long 0x3d903a78,0x41d840a8,0x393226a2,0xfa03722,0x3d983a80,0x41e040b0,0x3a3a27aa,0xfa2382a
.long 0x3da03a88,0x41e840b8,0x3b4228b2,0xfa449b2,0x3da03a88,0x41e840b8,0x3c4a29ba,0xfa64aba
.long 0x3da83a90,0x41f040c0,0x3d522ac2,0xfa84b20,0x3db83aa0,0x41f840d0,0x3e5a2bca,0xfaa4b20
.long 0x3dc03aa8,0x420040d8,0x3f622cd2,0xfac4b20,0x3dc03aa8,0x420040d8,0x406a2dda,0xfae4b20
.long 0x3dc83ab0,0x420840e0,0x41722ee2,0xfb04b20,0x3dd03ab8,0x421040e8,0x427a2fea,0xfb24b20
.long 0x3dd83ac0,0x421840f0,0x438230f2,0xfb44b20,0x3dd83ac0,0x421840f0,0x448a31fa,0xfb64b20
.long 0x3de03ac8,0x422040f8,0x45923302,0xfb84b20,0x3de83ad0,0x42284100,0x469a340a,0xfba4b20
.long 0x3df03ad8,0x42304108,0x47a23512,0xfbc4b20,0x3df03ad8,0x42304108,0x48aa361a,0xfbe4b20
.long 0x338836a0,0x2f483070,0x395226c2,0x12003742,0x33803698,0x2f383068,0x3a5a27ca,0x1202384a
.long 0x33783690,0x2f303060,0x3b6228d2,0x120449d2,0x33783690,0x2f303060,0x3c6a29da,0x12064ada
.long 0x33703688,0x2f283058,0x3d722ae2,0x12084b20,0x33683680,0x2f203050,0x3e7a2bea,0x120a4b20
.long 0x33583670,0x2f183040,0x3f822cf2,0x120c4b20,0x33583670,0x2f183040,0x408a2dfa,0x120e4b20
.long 0x33503668,0x2f103038,0x41922f02,0x12104b20,0x33483660,0x2f083030,0x429a300a,0x12124b20
.long 0x33403658,0x2f003028,0x43a23112,0x12144b20,0x33403658,0x2f003028,0x44aa321a,0x12164b20
.long 0x33383650,0x2ef83020,0x45b23322,0x12184b20,0x33303648,0x2ef03018,0x46ba342a,0x121a4b20
.long 0x33283640,0x2ee83010,0x47c23532,0x121c4b20,0x33283640,0x2ee83010,0x48ca363a,0x121e4b20
.long 0x46184930,0x41d84300,0x397226e2,0x12203762,0x46104928,0x41c842f8,0x3a7a27ea,0x1222386a
.long 0x46084920,0x41c042f0,0x3b8228f2,0x122449f2,0x46084920,0x41c042f0,0x3c8a29fa,0x12264afa
.long 0x46004918,0x41b842e8,0x3d922b02,0x12284b20,0x45f84910,0x41b042e0,0x3e9a2c0a,0x122a4b20
.long 0x45e84900,0x41a842d0,0x3fa22d12,0x122c4b20,0x45e84900,0x41a842d0,0x40aa2e1a,0x122e4b20
.long 0x45e048f8,0x41a042c8,0x41b22f22,0x12304b20,0x45d848f0,0x419842c0,0x42ba302a,0x12324b20
.long 0x45d048e8,0x419042b8,0x43c23132,0x12344b20,0x45d048e8,0x419042b8,0x44ca323a,0x12364b20
.long 0x45c848e0,0x418842b0,0x45d23342,0x12384b20,0x45c048d8,0x418042a8,0x46da344a,0x123a4b20
.long 0x45b848d0,0x417842a0,0x47e23552,0x123c4b20,0x45b848d0,0x417842a0,0x48ea365a,0x123e4b20
.long 0x2b682850,0x2f482e80,0x39142684,0x18803704,0x2b702858,0x2f502e88,0x3a1c278c,0x1882380c
.long 0x2b782860,0x2f582e90,0x3b242894,0x18844994,0x2b782860,0x2f582e90,0x3c2c299c,0x18864a9c
.long 0x2b802868,0x2f602e98,0x3d342aa4,0x18884b20,0x2b882870,0x2f682ea0,0x3e3c2bac,0x188a4b20
.long 0x2b902878,0x2f702ea8,0x3f442cb4,0x188c4b20,0x2b902878,0x2f702ea8,0x404c2dbc,0x188e4b20
.long 0x2b982880,0x2f782eb0,0x41542ec4,0x18904b20,0x2ba02888,0x2f802eb8,0x425c2fcc,0x18924b20
.long 0x2ba82890,0x2f882ec0,0x436430d4,0x18944b20,0x2ba82890,0x2f882ec0,0x446c31dc,0x18964b20
.long 0x2bb02898,0x2f902ec8,0x457432e4,0x18984b20,0x2bb828a0,0x2f982ed0,0x467c33ec,0x189a4b20
.long 0x2bc028a8,0x2fa02ed8,0x478434f4,0x189c4b20,0x2bc028a8,0x2fa02ed8,0x488c35fc,0x189e4b20
.long 0x3df83ae0,0x41d84110,0x393426a4,0x18a03724,0x3e003ae8,0x41e04118,0x3a3c27ac,0x18a2382c
.long 0x3e083af0,0x41e84120,0x3b4428b4,0x18a449b4,0x3e083af0,0x41e84120,0x3c4c29bc,0x18a64abc
.long 0x3e103af8,0x41f04128,0x3d542ac4,0x18a84b20,0x3e183b00,0x41f84130,0x3e5c2bcc,0x18aa4b20
.long 0x3e203b08,0x42004138,0x3f642cd4,0x18ac4b20,0x3e203b08,0x42004138,0x406c2ddc,0x18ae4b20
.long 0x3e283b10,0x42084140,0x41742ee4,0x18b04b20,0x3e303b18,0x42104148,0x427c2fec,0x18b24b20
.long 0x3e383b20,0x42184150,0x438430f4,0x18b44b20,0x3e383b20,0x42184150,0x448c31fc,0x18b64b20
.long 0x3e403b28,0x42204158,0x45943304,0x18b84b20,0x3e483b30,0x42284160,0x469c340c,0x18ba4b20
.long 0x3e503b38,0x42304168,0x47a43514,0x18bc4b20,0x3e503b38,0x42304168,0x48ac361c,0x18be4b20
.long 0x33203638,0x2f483008,0x395426c4,0x1b003744,0x33183630,0x2f383000,0x3a5c27cc,0x1b02384c
.long 0x33103628,0x2f302ff8,0x3b6428d4,0x1b0449d4,0x33103628,0x2f302ff8,0x3c6c29dc,0x1b064adc
.long 0x33083620,0x2f282ff0,0x3d742ae4,0x1b084b20,0x33003618,0x2f202fe8,0x3e7c2bec,0x1b0a4b20
.long 0x32f83610,0x2f182fe0,0x3f842cf4,0x1b0c4b20,0x32f83610,0x2f182fe0,0x408c2dfc,0x1b0e4b20
.long 0x32f03608,0x2f102fd8,0x41942f04,0x1b104b20,0x32e83600,0x2f082fd0,0x429c300c,0x1b124b20
.long 0x32e035f8,0x2f002fc8,0x43a43114,0x1b144b20,0x32e035f8,0x2f002fc8,0x44ac321c,0x1b164b20
.long 0x32d835f0,0x2ef82fc0,0x45b43324,0x1b184b20,0x32d035e8,0x2ef02fb8,0x46bc342c,0x1b1a4b20
.long 0x32c835e0,0x2ee82fb0,0x47c43534,0x1b1c4b20,0x32c835e0,0x2ee82fb0,0x48cc363c,0x1b1e4b20
.long 0x45b048c8,0x41d84298,0x397426e4,0x1b203764,0x45a848c0,0x41c84290,0x3a7c27ec,0x1b22386c
.long 0x45a048b8,0x41c04288,0x3b8428f4,0x1b2449f4,0x45a048b8,0x41c04288,0x3c8c29fc,0x1b264afc
.long 0x459848b0,0x41b84280,0x3d942b04,0x1b284b20,0x459048a8,0x41b04278,0x3e9c2c0c,0x1b2a4b20
.long 0x458848a0,0x41a84270,0x3fa42d14,0x1b2c4b20,0x458848a0,0x41a84270,0x40ac2e1c,0x1b2e4b20
.long 0x45804898,0x41a04268,0x41b42f24,0x1b304b20,0x45784890,0x41984260,0x42bc302c,0x1b324b20
.long 0x45704888,0x41904258,0x43c43134,0x1b344b20,0x45704888,0x41904258,0x44cc323c,0x1b364b20
.long 0x45684880,0x41884250,0x45d43344,0x1b384b20,0x45604878,0x41804248,0x46dc344c,0x1b3a4b20
.long 0x45584870,0x41784240,0x47e43554,0x1b3c4b20,0x45584870,0x41784240,0x48ec365c,0x1b3e4b20
.long 0x2bc828b0,0x2f482ee0,0x39162686,0x21803706,0x2bd028b8,0x2f502ee8,0x3a1e278e,0x2182380e
.long 0x2bd828c0,0x2f582ef0,0x3b262896,0x21844996,0x2bd828c0,0x2f582ef0,0x3c2e299e,0x21864a9e
.long 0x2be028c8,0x2f602ef8,0x3d362aa6,0x21884b20,0x2be828d0,0x2f682f00,0x3e3e2bae,0x218a4b20
.long 0x2bf028d8,0x2f702f08,0x3f462cb6,0x218c4b20,0x2bf028d8,0x2f702f08,0x404e2dbe,0x218e4b20
.long 0x2bf828e0,0x2f782f10,0x41562ec6,0x21904b20,0x2c0028e8,0x2f802f18,0x425e2fce,0x21924b20
.long 0x2c0828f0,0x2f882f20,0x436630d6,0x21944b20,0x2c0828f0,0x2f882f20,0x446e31de,0x21964b20
.long 0x2c1028f8,0x2f902f28,0x457632e6,0x21984b20,0x2c182900,0x2f982f30,0x467e33ee,0x219a4b20
.long 0x2c202908,0x2fa02f38,0x478634f6,0x219c4b20,0x2c202908,0x2fa02f38,0x488e35fe,0x219e4b20
.long 0x3e583b40,0x41d84170,0x393626a6,0x21a03726,0x3e603b48,0x41e04178,0x3a3e27ae,0x21a2382e
.long 0x3e683b50,0x41e84180,0x3b4628b6,0x21a449b6,0x3e683b50,0x41e84180,0x3c4e29be,0x21a64abe
.long 0x3e703b58,0x41f04188,0x3d562ac6,0x21a84b20,0x3e783b60,0x41f84190,0x3e5e2bce,0x21aa4b20
.long 0x3e803b68,0x42004198,0x3f662cd6,0x21ac4b20,0x3e803b68,0x42004198,0x406e2dde,0x21ae4b20
.long 0x3e883b70,0x420841a0,0x41762ee6,0x21b04b20,0x3e903b78,0x421041a8,0x427e2fee,0x21b24b20
.long 0x3e983b80,0x421841b0,0x438630f6,0x21b44b20,0x3e983b80,0x421841b0,0x448e31fe,0x21b64b20
.long 0x3ea03b88,0x422041b8,0x45963306,0x21b84b20,0x3ea83b90,0x422841c0,0x469e340e,0x21ba4b20
.long 0x3eb03b98,0x423041c8,0x47a63516,0x21bc4b20,0x3eb03b98,0x423041c8,0x48ae361e,0x21be4b20
.long 0x32c035d8,0x2f482fa8,0x395626c6,0x24003746,0x32b835d0,0x2f382fa0,0x3a5e27ce,0x2402384e
.long 0x32b035c8,0x2f302f98,0x3b6628d6,0x240449d6,0x32b035c8,0x2f302f98,0x3c6e29de,0x24064ade
.long 0x32a835c0,0x2f282f90,0x3d762ae6,0x24084b20,0x32a035b8,0x2f202f88,0x3e7e2bee,0x240a4b20
.long 0x329835b0,0x2f182f80,0x3f862cf6,0x240c4b20,0x329835b0,0x2f182f80,0x408e2dfe,0x240e4b20
.long 0x329035a8,0x2f102f78,0x41962f06,0x24104b20,0x328835a0,0x2f082f70,0x429e300e,0x24124b20
.long 0x32803598,0x2f002f68,0x43a63116,0x24144b20,0x32803598,0x2f002f68,0x44ae321e,0x24164b20
.long 0x32783590,0x2ef82f60,0x45b63326,0x24184b20,0x32703588,0x2ef02f58,0x46be342e,0x241a4b20
.long 0x32683580,0x2ee82f50,0x47c63536,0x241c4b20,0x32683580,0x2ee82f50,0x48ce363e,0x241e4b20
.long 0x45504868,0x41d84238,0x397626e6,0x24203766,0x45484860,0x41c84230,0x3a7e27ee,0x2422386e
.long 0x45404858,0x41c04228,0x3b8628f6,0x242449f6,0x45404858,0x41c04228,0x3c8e29fe,0x24264afe
.long 0x45384850,0x41b84220,0x3d962b06,0x24284b20,0x45304848,0x41b04218,0x3e9e2c0e,0x242a4b20
.long 0x45284840,0x41a84210,0x3fa62d16,0x242c4b20,0x45284840,0x41a84210,0x40ae2e1e,0x242e4b20
.long 0x45204838,0x41a04208,0x41b62f26,0x24304b20,0x45184830,0x41984200,0x42be302e,0x24324b20
.long 0x45104828,0x419041f8,0x43c63136,0x24344b20,0x45104828,0x419041f8,0x44ce323e,0x24364b20
.long 0x45084820,0x418841f0,0x45d63346,0x24384b20,0x45004818,0x418041e8,0x46de344e,0x243a4b20
.long 0x44f84810,0x417841e0,0x47e63556,0x243c4b20,0x44f84810,0x417841e0,0x48ee365e,0x243e4b20
.long 0x2480200,0xbf40250,0xba402a0,0x2400200,0xb5402f0,0xb040700,0x6f40750,0x2900250
.long 0x6a407a0,0x65407f0,0x6040340,0x2e002a0,0xab40390,0xa6403e0,0xa140430,0x33002f0
.long 0x9c40840,0x5b40890,0x56408e0,0x3800340,0x5140930,0x4c40480,0x97404d0,0x3d00390
.long 0x9240520,0x8d40570,0x8840980,0x42003e0,0x47409d0,0x4240a20,0x3d40a70,0x4700430
.long 0x38405c0,0x8340610,0x7e40660,0x4c00480,0x79406b0,0x7440ac0,0x3340b10,0x51004d0
.long 0x2e40b60,0x2940bb0,0x2440204,0x5600520,0xbf00254,0xba002a4,0xb5002f4,0x5b00570
.long 0xb000704,0x6f00754,0x6a007a4,0x60005c0,0x65007f4,0x6000344,0xab00394,0x6500610
.long 0xa6003e4,0xa100434,0x9c00844,0x6a00660,0x5b00894,0x56008e4,0x5100934,0x6f006b0
.long 0xc500c08,0x15fc0c58,0x15ac0ca8,0x2480208,0x155c0cf8,0x150c1108,0x10fc1158,0x2980258
.long 0x10ac11a8,0x105c11f8,0x100c0d48,0x2e802a8,0x14bc0d98,0x146c0de8,0x141c0e38,0x33802f8
.long 0x13cc1248,0xfbc1298,0xf6c12e8,0x3880348,0xf1c1338,0xecc0e88,0x137c0ed8,0x3d80398
.long 0x132c0f28,0x12dc0f78,0x128c1388,0x42803e8,0xe7c13d8,0xe2c1428,0xddc1478,0x4780438
.long 0xd8c0fc8,0x123c1018,0x11ec1068,0x4c80488,0x119c10b8,0x114c14c8,0xd3c1518,0x51804d8
.long 0xcec1568,0xc9c15b8,0xc4c0c0c,0x5680528,0x15f80c5c,0x15a80cac,0x15580cfc,0x5b80578
.long 0x1508110c,0x10f8115c,0x10a811ac,0x60805c8,0x105811fc,0x10080d4c,0x14b80d9c,0x6580618
.long 0x14680dec,0x14180e3c,0x13c8124c,0x6a80668,0xfb8129c,0xf6812ec,0xf18133c,0x6f806b8
.long 0x16581610,0x20041660,0x1fb416b0,0x2400210,0x1f641700,0x1f141b10,0x1b041b60,0x2900260
.long 0x1ab41bb0,0x1a641c00,0x1a141750,0x2e002b0,0x1ec417a0,0x1e7417f0,0x1e241840,0x3300300
.long 0x1dd41c50,0x19c41ca0,0x19741cf0,0x3800350,0x19241d40,0x18d41890,0x1d8418e0,0x3d003a0
.long 0x1d341930,0x1ce41980,0x1c941d90,0x42003f0,0x18841de0,0x18341e30,0x17e41e80,0x4700440
.long 0x179419d0,0x1c441a20,0x1bf41a70,0x4c00490,0x1ba41ac0,0x1b541ed0,0x17441f20,0x51004e0
.long 0x16f41f70,0x16a41fc0,0x16541614,0x5600530,0x20001664,0x1fb016b4,0x1f601704,0x5b00580
.long 0x1f101b14,0x1b001b64,0x1ab01bb4,0x60005d0,0x1a601c04,0x1a101754,0x1ec017a4,0x6500620
.long 0x1e7017f4,0x1e201844,0x1dd01c54,0x6a00670,0x19c01ca4,0x19701cf4,0x19201d44,0x6f006c0
.long 0x20602018,0x2a0c2068,0x29bc20b8,0x2480218,0x296c2108,0x291c2518,0x250c2568,0x2980268
.long 0x24bc25b8,0x246c2608,0x241c2158,0x2e802b8,0x28cc21a8,0x287c21f8,0x282c2248,0x3380308
.long 0x27dc2658,0x23cc26a8,0x237c26f8,0x3880358,0x232c2748,0x22dc2298,0x278c22e8,0x3d803a8
.long 0x273c2338,0x26ec2388,0x269c2798,0x42803f8,0x228c27e8,0x223c2838,0x21ec2888,0x4780448
.long 0x219c23d8,0x264c2428,0x25fc2478,0x4c80498,0x25ac24c8,0x255c28d8,0x214c2928,0x51804e8
.long 0x20fc2978,0x20ac29c8,0x205c201c,0x5680538,0x2a08206c,0x29b820bc,0x2968210c,0x5b80588
.long 0x2918251c,0x2508256c,0x24b825bc,0x60805d8,0x2468260c,0x2418215c,0x28c821ac,0x6580628
.long 0x287821fc,0x2828224c,0x27d8265c,0x6a80678,0x23c826ac,0x237826fc,0x2328274c,0x6f806c8
.long 0x4c00484,0x97004d4,0x9200524,0xc480c08,0x8d00574,0x8800984,0x47009d4,0xc980c58
.long 0x4200a24,0x3d00a74,0x38005c4,0xce80ca8,0x8300614,0x7e00664,0x79006b4,0xd380cf8
.long 0x7400ac4,0x3300b14,0x2e00b64,0xd880d48,0x2900bb4,0x2400208,0xbec0258,0xdd80d98
.long 0xb9c02a8,0xb4c02f8,0xafc0708,0xe280de8,0x6ec0758,0x69c07a8,0x64c07f8,0xe780e38
.long 0x5fc0348,0xaac0398,0xa5c03e8,0xec80e88,0xa0c0438,0x9bc0848,0x5ac0898,0xf180ed8
.long 0x55c08e8,0x50c0938,0x4bc0488,0xf680f28,0x96c04d8,0x91c0528,0x8cc0578,0xfb80f78
.long 0x87c0988,0x46c09d8,0x41c0a28,0x10080fc8,0x3cc0a78,0x37c05c8,0x82c0618,0x10581018
.long 0x7dc0668,0x78c06b8,0x73c0ac8,0x10a81068,0x32c0b18,0x2dc0b68,0x28c0bb8,0x10f810b8
.long 0xec80e8c,0x13780edc,0x13280f2c,0xc500c10,0x12d80f7c,0x1288138c,0xe7813dc,0xca00c60
.long 0xe28142c,0xdd8147c,0xd880fcc,0xcf00cb0,0x1238101c,0x11e8106c,0x119810bc,0xd400d00
.long 0x114814cc,0xd38151c,0xce8156c,0xd900d50,0xc9815bc,0xc480c10,0x15f40c60,0xde00da0
.long 0x15a40cb0,0x15540d00,0x15041110,0xe300df0,0x10f41160,0x10a411b0,0x10541200,0xe800e40
.long 0x10040d50,0x14b40da0,0x14640df0,0xed00e90,0x14140e40,0x13c41250,0xfb412a0,0xf200ee0
.long 0xf6412f0,0xf141340,0xec40e90,0xf700f30,0x13740ee0,0x13240f30,0x12d40f80,0xfc00f80
.long 0x12841390,0xe7413e0,0xe241430,0x10100fd0,0xdd41480,0xd840fd0,0x12341020,0x10601020
.long 0x11e41070,0x119410c0,0x114414d0,0x10b01070,0xd341520,0xce41570,0xc9415c0,0x110010c0
.long 0x18d01894,0x1d8018e4,0x1d301934,0xc480c18,0x1ce01984,0x1c901d94,0x18801de4,0xc980c68
.long 0x18301e34,0x17e01e84,0x179019d4,0xce80cb8,0x1c401a24,0x1bf01a74,0x1ba01ac4,0xd380d08
.long 0x1b501ed4,0x17401f24,0x16f01f74,0xd880d58,0x16a01fc4,0x16501618,0x1ffc1668,0xdd80da8
.long 0x1fac16b8,0x1f5c1708,0x1f0c1b18,0xe280df8,0x1afc1b68,0x1aac1bb8,0x1a5c1c08,0xe780e48
.long 0x1a0c1758,0x1ebc17a8,0x1e6c17f8,0xec80e98,0x1e1c1848,0x1dcc1c58,0x19bc1ca8,0xf180ee8
.long 0x196c1cf8,0x191c1d48,0x18cc1898,0xf680f38,0x1d7c18e8,0x1d2c1938,0x1cdc1988,0xfb80f88
.long 0x1c8c1d98,0x187c1de8,0x182c1e38,0x10080fd8,0x17dc1e88,0x178c19d8,0x1c3c1a28,0x10581028
.long 0x1bec1a78,0x1b9c1ac8,0x1b4c1ed8,0x10a81078,0x173c1f28,0x16ec1f78,0x169c1fc8,0x10f810c8
.long 0x22d8229c,0x278822ec,0x2738233c,0xc500c20,0x26e8238c,0x2698279c,0x228827ec,0xca00c70
.long 0x2238283c,0x21e8288c,0x219823dc,0xcf00cc0,0x2648242c,0x25f8247c,0x25a824cc,0xd400d10
.long 0x255828dc,0x2148292c,0x20f8297c,0xd900d60,0x20a829cc,0x20582020,0x2a042070,0xde00db0
.long 0x29b420c0,0x29642110,0x29142520,0xe300e00,0x25042570,0x24b425c0,0x24642610,0xe800e50
.long 0x24142160,0x28c421b0,0x28742200,0xed00ea0,0x28242250,0x27d42660,0x23c426b0,0xf200ef0
.long 0x23742700,0x23242750,0x22d422a0,0xf700f40,0x278422f0,0x27342340,0x26e42390,0xfc00f90
.long 0x269427a0,0x228427f0,0x22342840,0x10100fe0,0x21e42890,0x219423e0,0x26442430,0x10601030
.long 0x25f42480,0x25a424d0,0x255428e0,0x10b01080,0x21442930,0x20f42980,0x20a429d0,0x110010d0
.long 0x23c020c,0xbe8025c,0xb9802ac,0x16501610,0xb4802fc,0xaf8070c,0x6e8075c,0x16a01660
.long 0x69807ac,0x64807fc,0x5f8034c,0x16f016b0,0xaa8039c,0xa5803ec,0xa08043c,0x17401700
.long 0x9b8084c,0x5a8089c,0x55808ec,0x17901750,0x508093c,0x4b8048c,0x96804dc,0x17e017a0
.long 0x918052c,0x8c8057c,0x878098c,0x183017f0,0x46809dc,0x4180a2c,0x3c80a7c,0x18801840
.long 0x37805cc,0x828061c,0x7d8066c,0x18d01890,0x78806bc,0x7380acc,0x3280b1c,0x192018e0
.long 0x2d80b6c,0x2880bbc,0x2380210,0x19701930,0xbe40260,0xb9402b0,0xb440300,0x19c01980
.long 0xaf40710,0x6e40760,0x69407b0,0x1a1019d0,0x6440800,0x5f40350,0xaa403a0,0x1a601a20
.long 0xa5403f0,0xa040440,0x9b40850,0x1ab01a70,0x5a408a0,0x55408f0,0x5040940,0x1b001ac0
.long 0xc440c14,0x15f00c64,0x15a00cb4,0x16581618,0x15500d04,0x15001114,0x10f01164,0x16a81668
.long 0x10a011b4,0x10501204,0x10000d54,0x16f816b8,0x14b00da4,0x14600df4,0x14100e44,0x17481708
.long 0x13c01254,0xfb012a4,0xf6012f4,0x17981758,0xf101344,0xec00e94,0x13700ee4,0x17e817a8
.long 0x13200f34,0x12d00f84,0x12801394,0x183817f8,0xe7013e4,0xe201434,0xdd01484,0x18881848
.long 0xd800fd4,0x12301024,0x11e01074,0x18d81898,0x119010c4,0x114014d4,0xd301524,0x192818e8
.long 0xce01574,0xc9015c4,0xc400c18,0x19781938,0x15ec0c68,0x159c0cb8,0x154c0d08,0x19c81988
.long 0x14fc1118,0x10ec1168,0x109c11b8,0x1a1819d8,0x104c1208,0xffc0d58,0x14ac0da8,0x1a681a28
.long 0x145c0df8,0x140c0e48,0x13bc1258,0x1ab81a78,0xfac12a8,0xf5c12f8,0xf0c1348,0x1b081ac8
.long 0x164c161c,0x1ff8166c,0x1fa816bc,0x16501620,0x1f58170c,0x1f081b1c,0x1af81b6c,0x16a01670
.long 0x1aa81bbc,0x1a581c0c,0x1a08175c,0x16f016c0,0x1eb817ac,0x1e6817fc,0x1e18184c,0x17401710
.long 0x1dc81c5c,0x19b81cac,0x19681cfc,0x17901760,0x19181d4c,0x18c8189c,0x1d7818ec,0x17e017b0
.long 0x1d28193c,0x1cd8198c,0x1c881d9c,0x18301800,0x18781dec,0x18281e3c,0x17d81e8c,0x18801850
.long 0x178819dc,0x1c381a2c,0x1be81a7c,0x18d018a0,0x1b981acc,0x1b481edc,0x17381f2c,0x192018f0
.long 0x16e81f7c,0x16981fcc,0x16481620,0x19701940,0x1ff41670,0x1fa416c0,0x1f541710,0x19c01990
.long 0x1f041b20,0x1af41b70,0x1aa41bc0,0x1a1019e0,0x1a541c10,0x1a041760,0x1eb417b0,0x1a601a30
.long 0x1e641800,0x1e141850,0x1dc41c60,0x1ab01a80,0x19b41cb0,0x19641d00,0x19141d50,0x1b001ad0
.long 0x20542024,0x2a002074,0x29b020c4,0x16581628,0x29602114,0x29102524,0x25002574,0x16a81678
.long 0x24b025c4,0x24602614,0x24102164,0x16f816c8,0x28c021b4,0x28702204,0x28202254,0x17481718
.long 0x27d02664,0x23c026b4,0x23702704,0x17981768,0x23202754,0x22d022a4,0x278022f4,0x17e817b8
.long 0x27302344,0x26e02394,0x269027a4,0x18381808,0x228027f4,0x22302844,0x21e02894,0x18881858
.long 0x219023e4,0x26402434,0x25f02484,0x18d818a8,0x25a024d4,0x255028e4,0x21402934,0x192818f8
.long 0x20f02984,0x20a029d4,0x20502028,0x19781948,0x29fc2078,0x29ac20c8,0x295c2118,0x19c81998
.long 0x290c2528,0x24fc2578,0x24ac25c8,0x1a1819e8,0x245c2618,0x240c2168,0x28bc21b8,0x1a681a38
.long 0x286c2208,0x281c2258,0x27cc2668,0x1ab81a88,0x23bc26b8,0x236c2708,0x231c2758,0x1b081ad8
.long 0x4b40490,0x96404e0,0x9140530,0x20582018,0x8c40580,0x8740990,0x46409e0,0x20a82068
.long 0x4140a30,0x3c40a80,0x37405d0,0x20f820b8,0x8240620,0x7d40670,0x78406c0,0x21482108
.long 0x7340ad0,0x3240b20,0x2d40b70,0x21982158,0x2840bc0,0x2340214,0xbe00264,0x21e821a8
.long 0xb9002b4,0xb400304,0xaf00714,0x223821f8,0x6e00764,0x69007b4,0x6400804,0x22882248
.long 0x5f00354,0xaa003a4,0xa5003f4,0x22d82298,0xa000444,0x9b00854,0x5a008a4,0x232822e8
.long 0x55008f4,0x5000944,0x4b00494,0x23782338,0x96004e4,0x9100534,0x8c00584,0x23c82388
.long 0x8700994,0x46009e4,0x4100a34,0x241823d8,0x3c00a84,0x37005d4,0x8200624,0x24682428
.long 0x7d00674,0x78006c4,0x7300ad4,0x24b82478,0x3200b24,0x2d00b74,0x2800bc4,0x250824c8
.long 0xebc0e98,0x136c0ee8,0x131c0f38,0x20602020,0x12cc0f88,0x127c1398,0xe6c13e8,0x20b02070
.long 0xe1c1438,0xdcc1488,0xd7c0fd8,0x210020c0,0x122c1028,0x11dc1078,0x118c10c8,0x21502110
.long 0x113c14d8,0xd2c1528,0xcdc1578,0x21a02160,0xc8c15c8,0xc3c0c1c,0x15e80c6c,0x21f021b0
.long 0x15980cbc,0x15480d0c,0x14f8111c,0x22402200,0x10e8116c,0x109811bc,0x1048120c,0x22902250
.long 0xff80d5c,0x14a80dac,0x14580dfc,0x22e022a0,0x14080e4c,0x13b8125c,0xfa812ac,0x233022f0
.long 0xf5812fc,0xf08134c,0xeb80e9c,0x23802340,0x13680eec,0x13180f3c,0x12c80f8c,0x23d02390
.long 0x1278139c,0xe6813ec,0xe18143c,0x242023e0,0xdc8148c,0xd780fdc,0x1228102c,0x24702430
.long 0x11d8107c,0x118810cc,0x113814dc,0x24c02480,0xd28152c,0xcd8157c,0xc8815cc,0x251024d0
.long 0x18c418a0,0x1d7418f0,0x1d241940,0x20582028,0x1cd41990,0x1c841da0,0x18741df0,0x20a82078
.long 0x18241e40,0x17d41e90,0x178419e0,0x20f820c8,0x1c341a30,0x1be41a80,0x1b941ad0,0x21482118
.long 0x1b441ee0,0x17341f30,0x16e41f80,0x21982168,0x16941fd0,0x16441624,0x1ff01674,0x21e821b8
.long 0x1fa016c4,0x1f501714,0x1f001b24,0x22382208,0x1af01b74,0x1aa01bc4,0x1a501c14,0x22882258
.long 0x1a001764,0x1eb017b4,0x1e601804,0x22d822a8,0x1e101854,0x1dc01c64,0x19b01cb4,0x232822f8
.long 0x19601d04,0x19101d54,0x18c018a4,0x23782348,0x1d7018f4,0x1d201944,0x1cd01994,0x23c82398
.long 0x1c801da4,0x18701df4,0x18201e44,0x241823e8,0x17d01e94,0x178019e4,0x1c301a34,0x24682438
.long 0x1be01a84,0x1b901ad4,0x1b401ee4,0x24b82488,0x17301f34,0x16e01f84,0x16901fd4,0x250824d8
.long 0x22cc22a8,0x277c22f8,0x272c2348,0x20602030,0x26dc2398,0x268c27a8,0x227c27f8,0x20b02080
.long 0x222c2848,0x21dc2898,0x218c23e8,0x210020d0,0x263c2438,0x25ec2488,0x259c24d8,0x21502120
.long 0x254c28e8,0x213c2938,0x20ec2988,0x21a02170,0x209c29d8,0x204c202c,0x29f8207c,0x21f021c0
.long 0x29a820cc,0x2958211c,0x2908252c,0x22402210,0x24f8257c,0x24a825cc,0x2458261c,0x22902260
.long 0x2408216c,0x28b821bc,0x2868220c,0x22e022b0,0x2818225c,0x27c8266c,0x23b826bc,0x23302300
.long 0x2368270c,0x2318275c,0x22c822ac,0x23802350,0x277822fc,0x2728234c,0x26d8239c,0x23d023a0
.long 0x268827ac,0x227827fc,0x2228284c,0x242023f0,0x21d8289c,0x218823ec,0x2638243c,0x24702440
.long 0x25e8248c,0x259824dc,0x254828ec,0x24c02490,0x2138293c,0x20e8298c,0x209829dc,0x251024e0
.long 0x2300218,0xbdc0268,0xb8c02b8,0x2400200,0xb3c0308,0xaec0718,0x6dc0768,0x2900250
.long 0x68c07b8,0x63c0808,0x5ec0358,0x2e002a0,0xa9c03a8,0xa4c03f8,0x9fc0448,0x33002f0
.long 0x9ac0858,0x59c08a8,0x54c08f8,0x3800340,0x4fc0948,0x4ac0498,0x95c04e8,0x3d00390
.long 0x90c0538,0x8bc0588,0x86c0998,0x42003e0,0x45c09e8,0x40c0a38,0x3bc0a88,0x4700430
.long 0x36c05d8,0x81c0628,0x7cc0678,0x4c00480,0x77c06c8,0x72c0ad8,0x31c0b28,0x51004d0
.long 0x2cc0b78,0x27c0bc8,0x22c021c,0x5600520,0xbd8026c,0xb8802bc,0xb38030c,0x5b00570
.long 0xae8071c,0x6d8076c,0x68807bc,0x60005c0,0x638080c,0x5e8035c,0xa9803ac,0x6500610
.long 0xa4803fc,0x9f8044c,0x9a8085c,0x6a00660,0x59808ac,0x54808fc,0x4f8094c,0x6f006b0
.long 0xc380c20,0x15e40c70,0x15940cc0,0x2480208,0x15440d10,0x14f41120,0x10e41170,0x2980258
.long 0x109411c0,0x10441210,0xff40d60,0x2e802a8,0x14a40db0,0x14540e00,0x14040e50,0x33802f8
.long 0x13b41260,0xfa412b0,0xf541300,0x3880348,0xf041350,0xeb40ea0,0x13640ef0,0x3d80398
.long 0x13140f40,0x12c40f90,0x127413a0,0x42803e8,0xe6413f0,0xe141440,0xdc41490,0x4780438
.long 0xd740fe0,0x12241030,0x11d41080,0x4c80488,0x118410d0,0x113414e0,0xd241530,0x51804d8
.long 0xcd41580,0xc8415d0,0xc340c24,0x5680528,0x15e00c74,0x15900cc4,0x15400d14,0x5b80578
.long 0x14f01124,0x10e01174,0x109011c4,0x60805c8,0x10401214,0xff00d64,0x14a00db4,0x6580618
.long 0x14500e04,0x14000e54,0x13b01264,0x6a80668,0xfa012b4,0xf501304,0xf001354,0x6f806b8
.long 0x16401628,0x1fec1678,0x1f9c16c8,0x2400210,0x1f4c1718,0x1efc1b28,0x1aec1b78,0x2900260
.long 0x1a9c1bc8,0x1a4c1c18,0x19fc1768,0x2e002b0,0x1eac17b8,0x1e5c1808,0x1e0c1858,0x3300300
.long 0x1dbc1c68,0x19ac1cb8,0x195c1d08,0x3800350,0x190c1d58,0x18bc18a8,0x1d6c18f8,0x3d003a0
.long 0x1d1c1948,0x1ccc1998,0x1c7c1da8,0x42003f0,0x186c1df8,0x181c1e48,0x17cc1e98,0x4700440
.long 0x177c19e8,0x1c2c1a38,0x1bdc1a88,0x4c00490,0x1b8c1ad8,0x1b3c1ee8,0x172c1f38,0x51004e0
.long 0x16dc1f88,0x168c1fd8,0x163c162c,0x5600530,0x1fe8167c,0x1f9816cc,0x1f48171c,0x5b00580
.long 0x1ef81b2c,0x1ae81b7c,0x1a981bcc,0x60005d0,0x1a481c1c,0x19f8176c,0x1ea817bc,0x6500620
.long 0x1e58180c,0x1e08185c,0x1db81c6c,0x6a00670,0x19a81cbc,0x19581d0c,0x19081d5c,0x6f006c0
.long 0x20482030,0x29f42080,0x29a420d0,0x2480218,0x29542120,0x29042530,0x24f42580,0x2980268
.long 0x24a425d0,0x24542620,0x24042170,0x2e802b8,0x28b421c0,0x28642210,0x28142260,0x3380308
.long 0x27c42670,0x23b426c0,0x23642710,0x3880358,0x23142760,0x22c422b0,0x27742300,0x3d803a8
.long 0x27242350,0x26d423a0,0x268427b0,0x42803f8,0x22742800,0x22242850,0x21d428a0,0x4780448
.long 0x218423f0,0x26342440,0x25e42490,0x4c80498,0x259424e0,0x254428f0,0x21342940,0x51804e8
.long 0x20e42990,0x209429e0,0x20442034,0x5680538,0x29f02084,0x29a020d4,0x29502124,0x5b80588
.long 0x29002534,0x24f02584,0x24a025d4,0x60805d8,0x24502624,0x24002174,0x28b021c4,0x6580628
.long 0x28602214,0x28102264,0x27c02674,0x6a80678,0x23b026c4,0x23602714,0x23102764,0x6f806c8
.long 0x4a8049c,0x95804ec,0x908053c,0xc480c08,0x8b8058c,0x868099c,0x45809ec,0xc980c58
.long 0x4080a3c,0x3b80a8c,0x36805dc,0xce80ca8,0x818062c,0x7c8067c,0x77806cc,0xd380cf8
.long 0x7280adc,0x3180b2c,0x2c80b7c,0xd880d48,0x2780bcc,0x2280220,0xbd40270,0xdd80d98
.long 0xb8402c0,0xb340310,0xae40720,0xe280de8,0x6d40770,0x68407c0,0x6340810,0xe780e38
.long 0x5e40360,0xa9403b0,0xa440400,0xec80e88,0x9f40450,0x9a40860,0x59408b0,0xf180ed8
.long 0x5440900,0x4f40950,0x4a404a0,0xf680f28,0x95404f0,0x9040540,0x8b40590,0xfb80f78
.long 0x86409a0,0x45409f0,0x4040a40,0x10080fc8,0x3b40a90,0x36405e0,0x8140630,0x10581018
.long 0x7c40680,0x77406d0,0x7240ae0,0x10a81068,0x3140b30,0x2c40b80,0x2740bd0,0x10f810b8
.long 0xeb00ea4,0x13600ef4,0x13100f44,0xc500c10,0x12c00f94,0x127013a4,0xe6013f4,0xca00c60
.long 0xe101444,0xdc01494,0xd700fe4,0xcf00cb0,0x12201034,0x11d01084,0x118010d4,0xd400d00
.long 0x113014e4,0xd201534,0xcd01584,0xd900d50,0xc8015d4,0xc300c28,0x15dc0c78,0xde00da0
.long 0x158c0cc8,0x153c0d18,0x14ec1128,0xe300df0,0x10dc1178,0x108c11c8,0x103c1218,0xe800e40
.long 0xfec0d68,0x149c0db8,0x144c0e08,0xed00e90,0x13fc0e58,0x13ac1268,0xf9c12b8,0xf200ee0
.long 0xf4c1308,0xefc1358,0xeac0ea8,0xf700f30,0x135c0ef8,0x130c0f48,0x12bc0f98,0xfc00f80
.long 0x126c13a8,0xe5c13f8,0xe0c1448,0x10100fd0,0xdbc1498,0xd6c0fe8,0x121c1038,0x10601020
.long 0x11cc1088,0x117c10d8,0x112c14e8,0x10b01070,0xd1c1538,0xccc1588,0xc7c15d8,0x110010c0
.long 0x18b818ac,0x1d6818fc,0x1d18194c,0xc480c18,0x1cc8199c,0x1c781dac,0x18681dfc,0xc980c68
.long 0x18181e4c,0x17c81e9c,0x177819ec,0xce80cb8,0x1c281a3c,0x1bd81a8c,0x1b881adc,0xd380d08
.long 0x1b381eec,0x17281f3c,0x16d81f8c,0xd880d58,0x16881fdc,0x16381630,0x1fe41680,0xdd80da8
.long 0x1f9416d0,0x1f441720,0x1ef41b30,0xe280df8,0x1ae41b80,0x1a941bd0,0x1a441c20,0xe780e48
.long 0x19f41770,0x1ea417c0,0x1e541810,0xec80e98,0x1e041860,0x1db41c70,0x19a41cc0,0xf180ee8
.long 0x19541d10,0x19041d60,0x18b418b0,0xf680f38,0x1d641900,0x1d141950,0x1cc419a0,0xfb80f88
.long 0x1c741db0,0x18641e00,0x18141e50,0x10080fd8,0x17c41ea0,0x177419f0,0x1c241a40,0x10581028
.long 0x1bd41a90,0x1b841ae0,0x1b341ef0,0x10a81078,0x17241f40,0x16d41f90,0x16841fe0,0x10f810c8
.long 0x22c022b4,0x27702304,0x27202354,0xc500c20,0x26d023a4,0x268027b4,0x22702804,0xca00c70
.long 0x22202854,0x21d028a4,0x218023f4,0xcf00cc0,0x26302444,0x25e02494,0x259024e4,0xd400d10
.long 0x254028f4,0x21302944,0x20e02994,0xd900d60,0x209029e4,0x20402038,0x29ec2088,0xde00db0
.long 0x299c20d8,0x294c2128,0x28fc2538,0xe300e00,0x24ec2588,0x249c25d8,0x244c2628,0xe800e50
.long 0x23fc2178,0x28ac21c8,0x285c2218,0xed00ea0,0x280c2268,0x27bc2678,0x23ac26c8,0xf200ef0
.long 0x235c2718,0x230c2768,0x22bc22b8,0xf700f40,0x276c2308,0x271c2358,0x26cc23a8,0xfc00f90
.long 0x267c27b8,0x226c2808,0x221c2858,0x10100fe0,0x21cc28a8,0x217c23f8,0x262c2448,0x10601030
.long 0x25dc2498,0x258c24e8,0x253c28f8,0x10b01080,0x212c2948,0x20dc2998,0x208c29e8,0x110010d0
.long 0x24c0224,0x2a202a20,0x2a202a20,0x16501610,0x2a202a20,0x2a202a20,0x2a202a20,0x16a01660
.long 0x2a202a20,0x2a202a20,0x2a202a20,0x16f016b0,0x2a202a20,0x2a202a20,0x2a202a20,0x17401700
.long 0x2a202a20,0x2a202a20,0x2a202a20,0x17901750,0x2a202a20,0x2a202a20,0x2a202a20,0x17e017a0
.long 0x2a202a20,0x2a202a20,0x2a202a20,0x183017f0,0x2a202a20,0x2a202a20,0x2a202a20,0x18801840
.long 0x2a202a20,0x2a202a20,0x2a202a20,0x18d01890,0x2a202a20,0x2a202a20,0x2a202a20,0x192018e0
.long 0x2a202a20,0x2a202a20,0x2a202a20,0x19701930,0x2a202a20,0x2a202a20,0x2a202a20,0x19c01980
.long 0x2a202a20,0x2a202a20,0x2a202a20,0x1a1019d0,0x2a202a20,0x2a202a20,0x2a202a20,0x1a601a20
.long 0x2a202a20,0x2a202a20,0x2a202a20,0x1ab01a70,0x2a202a20,0x2a202a20,0x2a202a20,0x1b001ac0
.long 0xc540c2c,0x2a202a20,0x2a202a20,0x16581618,0x2a202a20,0x2a202a20,0x2a202a20,0x16a81668
.long 0x2a202a20,0x2a202a20,0x2a202a20,0x16f816b8,0x2a202a20,0x2a202a20,0x2a202a20,0x17481708
.long 0x2a202a20,0x2a202a20,0x2a202a20,0x17981758,0x2a202a20,0x2a202a20,0x2a202a20,0x17e817a8
.long 0x2a202a20,0x2a202a20,0x2a202a20,0x183817f8,0x2a202a20,0x2a202a20,0x2a202a20,0x18881848
.long 0x2a202a20,0x2a202a20,0x2a202a20,0x18d81898,0x2a202a20,0x2a202a20,0x2a202a20,0x192818e8
.long 0x2a202a20,0x2a202a20,0x2a202a20,0x19781938,0x2a202a20,0x2a202a20,0x2a202a20,0x19c81988
.long 0x2a202a20,0x2a202a20,0x2a202a20,0x1a1819d8,0x2a202a20,0x2a202a20,0x2a202a20,0x1a681a28
.long 0x2a202a20,0x2a202a20,0x2a202a20,0x1ab81a78,0x2a202a20,0x2a202a20,0x2a202a20,0x1b081ac8
.long 0x165c1634,0x2a202a20,0x2a202a20,0x16501620,0x2a202a20,0x2a202a20,0x2a202a20,0x16a01670
.long 0x2a202a20,0x2a202a20,0x2a202a20,0x16f016c0,0x2a202a20,0x2a202a20,0x2a202a20,0x17401710
.long 0x2a202a20,0x2a202a20,0x2a202a20,0x17901760,0x2a202a20,0x2a202a20,0x2a202a20,0x17e017b0
.long 0x2a202a20,0x2a202a20,0x2a202a20,0x18301800,0x2a202a20,0x2a202a20,0x2a202a20,0x18801850
.long 0x2a202a20,0x2a202a20,0x2a202a20,0x18d018a0,0x2a202a20,0x2a202a20,0x2a202a20,0x192018f0
.long 0x2a202a20,0x2a202a20,0x2a202a20,0x19701940,0x2a202a20,0x2a202a20,0x2a202a20,0x19c01990
.long 0x2a202a20,0x2a202a20,0x2a202a20,0x1a1019e0,0x2a202a20,0x2a202a20,0x2a202a20,0x1a601a30
.long 0x2a202a20,0x2a202a20,0x2a202a20,0x1ab01a80,0x2a202a20,0x2a202a20,0x2a202a20,0x1b001ad0
.long 0x2064203c,0x2a202a20,0x2a202a20,0x16581628,0x2a202a20,0x2a202a20,0x2a202a20,0x16a81678
.long 0x2a202a20,0x2a202a20,0x2a202a20,0x16f816c8,0x2a202a20,0x2a202a20,0x2a202a20,0x17481718
.long 0x2a202a20,0x2a202a20,0x2a202a20,0x17981768,0x2a202a20,0x2a202a20,0x2a202a20,0x17e817b8
.long 0x2a202a20,0x2a202a20,0x2a202a20,0x18381808,0x2a202a20,0x2a202a20,0x2a202a20,0x18881858
.long 0x2a202a20,0x2a202a20,0x2a202a20,0x18d818a8,0x2a202a20,0x2a202a20,0x2a202a20,0x192818f8
.long 0x2a202a20,0x2a202a20,0x2a202a20,0x19781948,0x2a202a20,0x2a202a20,0x2a202a20,0x19c81998
.long 0x2a202a20,0x2a202a20,0x2a202a20,0x1a1819e8,0x2a202a20,0x2a202a20,0x2a202a20,0x1a681a38
.long 0x2a202a20,0x2a202a20,0x2a202a20,0x1ab81a88,0x2a202a20,0x2a202a20,0x2a202a20,0x1b081ad8
.long 0x2a202a20,0x2a202a20,0x2a202a20,0x20582018,0x2a202a20,0x2a202a20,0x2a202a20,0x20a82068
.long 0x2a202a20,0x2a202a20,0x2a202a20,0x20f820b8,0x2a202a20,0x2a202a20,0x2a202a20,0x21482108
.long 0x2a202a20,0x2a202a20,0x2a202a20,0x21982158,0x2a202a20,0x2a202a20,0x2a202a20,0x21e821a8
.long 0x2a202a20,0x2a202a20,0x2a202a20,0x223821f8,0x2a202a20,0x2a202a20,0x2a202a20,0x22882248
.long 0x2a202a20,0x2a202a20,0x2a202a20,0x22d82298,0x2a202a20,0x2a202a20,0x2a202a20,0x232822e8
.long 0x2a202a20,0x2a202a20,0x2a202a20,0x23782338,0x2a202a20,0x2a202a20,0x2a202a20,0x23c82388
.long 0x2a202a20,0x2a202a20,0x2a202a20,0x241823d8,0x2a202a20,0x2a202a20,0x2a202a20,0x24682428
.long 0x2a202a20,0x2a202a20,0x2a202a20,0x24b82478,0x2a202a20,0x2a202a20,0x2a202a20,0x250824c8
.long 0x2a202a20,0x2a202a20,0x2a202a20,0x20602020,0x2a202a20,0x2a202a20,0x2a202a20,0x20b02070
.long 0x2a202a20,0x2a202a20,0x2a202a20,0x210020c0,0x2a202a20,0x2a202a20,0x2a202a20,0x21502110
.long 0x2a202a20,0x2a202a20,0x2a202a20,0x21a02160,0x2a202a20,0x2a202a20,0x2a202a20,0x21f021b0
.long 0x2a202a20,0x2a202a20,0x2a202a20,0x22402200,0x2a202a20,0x2a202a20,0x2a202a20,0x22902250
.long 0x2a202a20,0x2a202a20,0x2a202a20,0x22e022a0,0x2a202a20,0x2a202a20,0x2a202a20,0x233022f0
.long 0x2a202a20,0x2a202a20,0x2a202a20,0x23802340,0x2a202a20,0x2a202a20,0x2a202a20,0x23d02390
.long 0x2a202a20,0x2a202a20,0x2a202a20,0x242023e0,0x2a202a20,0x2a202a20,0x2a202a20,0x24702430
.long 0x2a202a20,0x2a202a20,0x2a202a20,0x24c02480,0x2a202a20,0x2a202a20,0x2a202a20,0x251024d0
.long 0x2a202a20,0x2a202a20,0x2a202a20,0x20582028,0x2a202a20,0x2a202a20,0x2a202a20,0x20a82078
.long 0x2a202a20,0x2a202a20,0x2a202a20,0x20f820c8,0x2a202a20,0x2a202a20,0x2a202a20,0x21482118
.long 0x2a202a20,0x2a202a20,0x2a202a20,0x21982168,0x2a202a20,0x2a202a20,0x2a202a20,0x21e821b8
.long 0x2a202a20,0x2a202a20,0x2a202a20,0x22382208,0x2a202a20,0x2a202a20,0x2a202a20,0x22882258
.long 0x2a202a20,0x2a202a20,0x2a202a20,0x22d822a8,0x2a202a20,0x2a202a20,0x2a202a20,0x232822f8
.long 0x2a202a20,0x2a202a20,0x2a202a20,0x23782348,0x2a202a20,0x2a202a20,0x2a202a20,0x23c82398
.long 0x2a202a20,0x2a202a20,0x2a202a20,0x241823e8,0x2a202a20,0x2a202a20,0x2a202a20,0x24682438
.long 0x2a202a20,0x2a202a20,0x2a202a20,0x24b82488,0x2a202a20,0x2a202a20,0x2a202a20,0x250824d8
.long 0x2a202a20,0x2a202a20,0x2a202a20,0x20602030,0x2a202a20,0x2a202a20,0x2a202a20,0x20b02080
.long 0x2a202a20,0x2a202a20,0x2a202a20,0x210020d0,0x2a202a20,0x2a202a20,0x2a202a20,0x21502120
.long 0x2a202a20,0x2a202a20,0x2a202a20,0x21a02170,0x2a202a20,0x2a202a20,0x2a202a20,0x21f021c0
.long 0x2a202a20,0x2a202a20,0x2a202a20,0x22402210,0x2a202a20,0x2a202a20,0x2a202a20,0x22902260
.long 0x2a202a20,0x2a202a20,0x2a202a20,0x22e022b0,0x2a202a20,0x2a202a20,0x2a202a20,0x23302300
.long 0x2a202a20,0x2a202a20,0x2a202a20,0x23802350,0x2a202a20,0x2a202a20,0x2a202a20,0x23d023a0
.long 0x2a202a20,0x2a202a20,0x2a202a20,0x242023f0,0x2a202a20,0x2a202a20,0x2a202a20,0x24702440
.long 0x2a202a20,0x2a202a20,0x2a202a20,0x24c02490,0x2a202a20,0x2a202a20,0x2a202a20,0x251024e0
.long 0x2a802a80,0x3280,0x3f002a20,0x0,0x2aa02ac8,0x103288,0x3f800298,0x0
.long 0x2ac02b10,0x203290,0x3f8002e8,0x0,0x2ae02b58,0x303298,0x3f800338,0x0
.long 0x2b002ba0,0x4032a0,0x3f800388,0x0,0x2b202be8,0x5032a8,0x3f8003d8,0x0
.long 0x2b402c30,0x6032b0,0x3f800428,0x0,0x2b602c78,0x7032b8,0x3f800478,0x0
.long 0x2b802cc0,0x8032c0,0x3f8004c8,0x0,0x2ba02d08,0x9032c8,0x3f800518,0x0
.long 0x2bc02d50,0xa032d0,0x3f800568,0x0,0x2be02d98,0xb032d8,0x3f8005b8,0x0
.long 0x2c002de0,0xc032e0,0x3f800608,0x0,0x2c202e28,0xd032e8,0x3f800658,0x0
.long 0x2c402e70,0xe032f0,0x3f8006a8,0x0,0x2c602eb8,0xf032f8,0x3f8006f8,0x0
.long 0x2c802a90,0xd003300,0x3f000748,0x0,0x2ca02ad8,0xd103308,0x3f800798,0x0
.long 0x2cc02b20,0xd203310,0x3f8007e8,0x0,0x2ce02b68,0xd303318,0x3f800838,0x0
.long 0x2d002bb0,0xd403320,0x3f800888,0x0,0x2d202bf8,0xd503328,0x3f8008d8,0x0
.long 0x2d402c40,0xd603330,0x3f800928,0x0,0x2d602c88,0xd703338,0x3f800978,0x0
.long 0x2d802cd0,0xd803340,0x3f8009c8,0x0,0x2da02d18,0xd903348,0x3f800a18,0x0
.long 0x2dc02d60,0xda03350,0x3f800a68,0x0,0x2de02da8,0xdb03358,0x3f800ab8,0x0
.long 0x2e002df0,0xdc03360,0x3f800b08,0x0,0x2e202e38,0xdd03368,0x3f800b58,0x0
.long 0x2e402e80,0xde03370,0x3f800ba8,0x0,0x2e602ec8,0xdf03378,0x3f800bf8,0x0
.long 0x2e802aa0,0x1a003280,0x3f002a20,0x0,0x2ea02ae8,0x1a103288,0x3f800ca0,0x0
.long 0x2ec02b30,0x1a203290,0x3f800cf0,0x0,0x2ee02b78,0x1a303298,0x3f800d40,0x0
.long 0x2f002bc0,0x1a4032a0,0x3f800d90,0x0,0x2f202c08,0x1a5032a8,0x3f800de0,0x0
.long 0x2f402c50,0x1a6032b0,0x3f800e30,0x0,0x2f602c98,0x1a7032b8,0x3f800e80,0x0
.long 0x2f802ce0,0x1a8032c0,0x3f800ed0,0x0,0x2fa02d28,0x1a9032c8,0x3f800f20,0x0
.long 0x2fc02d70,0x1aa032d0,0x3f800f70,0x0,0x2fe02db8,0x1ab032d8,0x3f800fc0,0x0
.long 0x30002e00,0x1ac032e0,0x3f801010,0x0,0x30202e48,0x1ad032e8,0x3f801060,0x0
.long 0x30402e90,0x1ae032f0,0x3f8010b0,0x0,0x30602ed8,0x1af032f8,0x3f801100,0x0
.long 0x30802ab0,0x27003300,0x3f001150,0x0,0x30a02af8,0x27103308,0x3f8011a0,0x0
.long 0x30c02b40,0x27203310,0x3f8011f0,0x0,0x30e02b88,0x27303318,0x3f801240,0x0
.long 0x31002bd0,0x27403320,0x3f801290,0x0,0x31202c18,0x27503328,0x3f8012e0,0x0
.long 0x31402c60,0x27603330,0x3f801330,0x0,0x31602ca8,0x27703338,0x3f801380,0x0
.long 0x31802cf0,0x27803340,0x3f8013d0,0x0,0x31a02d38,0x27903348,0x3f801420,0x0
.long 0x31c02d80,0x27a03350,0x3f801470,0x0,0x31e02dc8,0x27b03358,0x3f8014c0,0x0
.long 0x32002e10,0x27c03360,0x3f801510,0x0,0x32202e58,0x27d03368,0x3f801560,0x0
.long 0x32402ea0,0x27e03370,0x3f8015b0,0x0,0x32602ee8,0x27f03378,0x3f801600,0x0
.long 0x3c803c80,0x1004480,0x3f802a20,0x0,0x3ca03cc8,0x1104488,0x3f8016a8,0x0
.long 0x3cc03d10,0x1204490,0x3f8016f8,0x0,0x3ce03d58,0x1304498,0x3f801748,0x0
.long 0x3d003da0,0x14044a0,0x3f801798,0x0,0x3d203de8,0x15044a8,0x3f8017e8,0x0
.long 0x3d403e30,0x16044b0,0x3f801838,0x0,0x3d603e78,0x17044b8,0x3f801888,0x0
.long 0x3d803ec0,0x18044c0,0x3f8018d8,0x0,0x3da03f08,0x19044c8,0x3f801928,0x0
.long 0x3dc03f50,0x1a044d0,0x3f801978,0x0,0x3de03f98,0x1b044d8,0x3f8019c8,0x0
.long 0x3e003fe0,0x1c044e0,0x3f801a18,0x0,0x3e204028,0x1d044e8,0x3f801a68,0x0
.long 0x3e404070,0x1e044f0,0x3f801ab8,0x0,0x3e6040b8,0x1f044f8,0x3f801b08,0x0
.long 0x3e803c90,0xe004500,0x3f801b58,0x0,0x3ea03cd8,0xe104508,0x3f801ba8,0x0
.long 0x3ec03d20,0xe204510,0x3f801bf8,0x0,0x3ee03d68,0xe304518,0x3f801c48,0x0
.long 0x3f003db0,0xe404520,0x3f801c98,0x0,0x3f203df8,0xe504528,0x3f801ce8,0x0
.long 0x3f403e40,0xe604530,0x3f801d38,0x0,0x3f603e88,0xe704538,0x3f801d88,0x0
.long 0x3f803ed0,0xe804540,0x3f801dd8,0x0,0x3fa03f18,0xe904548,0x3f801e28,0x0
.long 0x3fc03f60,0xea04550,0x3f801e78,0x0,0x3fe03fa8,0xeb04558,0x3f801ec8,0x0
.long 0x40003ff0,0xec04560,0x3f801f18,0x0,0x40204038,0xed04568,0x3f801f68,0x0
.long 0x40404080,0xee04570,0x3f801fb8,0x0,0x406040c8,0xef04578,0x3f802008,0x0
.long 0x40803ca0,0x1b004480,0x3f802a20,0x0,0x40a03ce8,0x1b104488,0x3f8020b0,0x0
.long 0x40c03d30,0x1b204490,0x3f802100,0x0,0x40e03d78,0x1b304498,0x3f802150,0x0
.long 0x41003dc0,0x1b4044a0,0x3f8021a0,0x0,0x41203e08,0x1b5044a8,0x3f8021f0,0x0
.long 0x41403e50,0x1b6044b0,0x3f802240,0x0,0x41603e98,0x1b7044b8,0x3f802290,0x0
.long 0x41803ee0,0x1b8044c0,0x3f8022e0,0x0,0x41a03f28,0x1b9044c8,0x3f802330,0x0
.long 0x41c03f70,0x1ba044d0,0x3f802380,0x0,0x41e03fb8,0x1bb044d8,0x3f8023d0,0x0
.long 0x42004000,0x1bc044e0,0x3f802420,0x0,0x42204048,0x1bd044e8,0x3f802470,0x0
.long 0x42404090,0x1be044f0,0x3f8024c0,0x0,0x426040d8,0x1bf044f8,0x3f802510,0x0
.long 0x42803cb0,0x28004500,0x3f802560,0x0,0x42a03cf8,0x28104508,0x3f8025b0,0x0
.long 0x42c03d40,0x28204510,0x3f802600,0x0,0x42e03d88,0x28304518,0x3f802650,0x0
.long 0x43003dd0,0x28404520,0x3f8026a0,0x0,0x43203e18,0x28504528,0x3f8026f0,0x0
.long 0x43403e60,0x28604530,0x3f802740,0x0,0x43603ea8,0x28704538,0x3f802790,0x0
.long 0x43803ef0,0x28804540,0x3f8027e0,0x0,0x43a03f38,0x28904548,0x3f802830,0x0
.long 0x43c03f80,0x28a04550,0x3f802880,0x0,0x43e03fc8,0x28b04558,0x3f8028d0,0x0
.long 0x44004010,0x28c04560,0x3f802920,0x0,0x44204058,0x28d04568,0x3f802970,0x0
.long 0x444040a0,0x28e04570,0x3f8029c0,0x0,0x446040e8,0x28f04578,0x3f802a10,0x0
.long 0x4e804e80,0x2005680,0x3f802a20,0x0,0x4ea04ec8,0x2105688,0x3f800298,0x0
.long 0x4ec04f10,0x2205690,0x3f8002e8,0x0,0x4ee04f58,0x2305698,0x3f800338,0x0
.long 0x4f004fa0,0x24056a0,0x3f800388,0x0,0x4f204fe8,0x25056a8,0x3f8003d8,0x0
.long 0x4f405030,0x26056b0,0x3f800428,0x0,0x4f605078,0x27056b8,0x3f800478,0x0
.long 0x4f8050c0,0x28056c0,0x3f8004c8,0x0,0x4fa05108,0x29056c8,0x3f800518,0x0
.long 0x4fc05150,0x2a056d0,0x3f800568,0x0,0x4fe05198,0x2b056d8,0x3f8005b8,0x0
.long 0x500051e0,0x2c056e0,0x3f800608,0x0,0x50205228,0x2d056e8,0x3f800658,0x0
.long 0x50405270,0x2e056f0,0x3f8006a8,0x0,0x506052b8,0x2f056f8,0x3f8006f8,0x0
.long 0x50804e90,0xf005700,0x3f800748,0x0,0x50a04ed8,0xf105708,0x3f800798,0x0
.long 0x50c04f20,0xf205710,0x3f8007e8,0x0,0x50e04f68,0xf305718,0x3f800838,0x0
.long 0x51004fb0,0xf405720,0x3f800888,0x0,0x51204ff8,0xf505728,0x3f8008d8,0x0
.long 0x51405040,0xf605730,0x3f800928,0x0,0x51605088,0xf705738,0x3f800978,0x0
.long 0x518050d0,0xf805740,0x3f8009c8,0x0,0x51a05118,0xf905748,0x3f800a18,0x0
.long 0x51c05160,0xfa05750,0x3f800a68,0x0,0x51e051a8,0xfb05758,0x3f800ab8,0x0
.long 0x520051f0,0xfc05760,0x3f800b08,0x0,0x52205238,0xfd05768,0x3f800b58,0x0
.long 0x52405280,0xfe05770,0x3f800ba8,0x0,0x526052c8,0xff05778,0x3f800bf8,0x0
.long 0x52804ea0,0x1c005680,0x3f802a20,0x0,0x52a04ee8,0x1c105688,0x3f800ca0,0x0
.long 0x52c04f30,0x1c205690,0x3f800cf0,0x0,0x52e04f78,0x1c305698,0x3f800d40,0x0
.long 0x53004fc0,0x1c4056a0,0x3f800d90,0x0,0x53205008,0x1c5056a8,0x3f800de0,0x0
.long 0x53405050,0x1c6056b0,0x3f800e30,0x0,0x53605098,0x1c7056b8,0x3f800e80,0x0
.long 0x538050e0,0x1c8056c0,0x3f800ed0,0x0,0x53a05128,0x1c9056c8,0x3f800f20,0x0
.long 0x53c05170,0x1ca056d0,0x3f800f70,0x0,0x53e051b8,0x1cb056d8,0x3f800fc0,0x0
.long 0x54005200,0x1cc056e0,0x3f801010,0x0,0x54205248,0x1cd056e8,0x3f801060,0x0
.long 0x54405290,0x1ce056f0,0x3f8010b0,0x0,0x546052d8,0x1cf056f8,0x3f801100,0x0
.long 0x54804eb0,0x29005700,0x3f801150,0x0,0x54a04ef8,0x29105708,0x3f8011a0,0x0
.long 0x54c04f40,0x29205710,0x3f8011f0,0x0,0x54e04f88,0x29305718,0x3f801240,0x0
.long 0x55004fd0,0x29405720,0x3f801290,0x0,0x55205018,0x29505728,0x3f8012e0,0x0
.long 0x55405060,0x29605730,0x3f801330,0x0,0x556050a8,0x29705738,0x3f801380,0x0
.long 0x558050f0,0x29805740,0x3f8013d0,0x0,0x55a05138,0x29905748,0x3f801420,0x0
.long 0x55c05180,0x29a05750,0x3f801470,0x0,0x55e051c8,0x29b05758,0x3f8014c0,0x0
.long 0x56005210,0x29c05760,0x3f801510,0x0,0x56205258,0x29d05768,0x3f801560,0x0
.long 0x564052a0,0x29e05770,0x3f8015b0,0x0,0x566052e8,0x29f05778,0x3f801600,0x0
.long 0x60806080,0x3006880,0x3f802a20,0x0,0x60a060c8,0x3106888,0x3f8016a8,0x0
.long 0x60c06110,0x3206890,0x3f8016f8,0x0,0x60e06158,0x3306898,0x3f801748,0x0
.long 0x610061a0,0x34068a0,0x3f801798,0x0,0x612061e8,0x35068a8,0x3f8017e8,0x0
.long 0x61406230,0x36068b0,0x3f801838,0x0,0x61606278,0x37068b8,0x3f801888,0x0
.long 0x618062c0,0x38068c0,0x3f8018d8,0x0,0x61a06308,0x39068c8,0x3f801928,0x0
.long 0x61c06350,0x3a068d0,0x3f801978,0x0,0x61e06398,0x3b068d8,0x3f8019c8,0x0
.long 0x620063e0,0x3c068e0,0x3f801a18,0x0,0x62206428,0x3d068e8,0x3f801a68,0x0
.long 0x62406470,0x3e068f0,0x3f801ab8,0x0,0x626064b8,0x3f068f8,0x3f801b08,0x0
.long 0x62806090,0x10006900,0x3f801b58,0x0,0x62a060d8,0x10106908,0x3f801ba8,0x0
.long 0x62c06120,0x10206910,0x3f801bf8,0x0,0x62e06168,0x10306918,0x3f801c48,0x0
.long 0x630061b0,0x10406920,0x3f801c98,0x0,0x632061f8,0x10506928,0x3f801ce8,0x0
.long 0x63406240,0x10606930,0x3f801d38,0x0,0x63606288,0x10706938,0x3f801d88,0x0
.long 0x638062d0,0x10806940,0x3f801dd8,0x0,0x63a06318,0x10906948,0x3f801e28,0x0
.long 0x63c06360,0x10a06950,0x3f801e78,0x0,0x63e063a8,0x10b06958,0x3f801ec8,0x0
.long 0x640063f0,0x10c06960,0x3f801f18,0x0,0x64206438,0x10d06968,0x3f801f68,0x0
.long 0x64406480,0x10e06970,0x3f801fb8,0x0,0x646064c8,0x10f06978,0x3f802008,0x0
.long 0x648060a0,0x1d006880,0x3f802a20,0x0,0x64a060e8,0x1d106888,0x3f8020b0,0x0
.long 0x64c06130,0x1d206890,0x3f802100,0x0,0x64e06178,0x1d306898,0x3f802150,0x0
.long 0x650061c0,0x1d4068a0,0x3f8021a0,0x0,0x65206208,0x1d5068a8,0x3f8021f0,0x0
.long 0x65406250,0x1d6068b0,0x3f802240,0x0,0x65606298,0x1d7068b8,0x3f802290,0x0
.long 0x658062e0,0x1d8068c0,0x3f8022e0,0x0,0x65a06328,0x1d9068c8,0x3f802330,0x0
.long 0x65c06370,0x1da068d0,0x3f802380,0x0,0x65e063b8,0x1db068d8,0x3f8023d0,0x0
.long 0x66006400,0x1dc068e0,0x3f802420,0x0,0x66206448,0x1dd068e8,0x3f802470,0x0
.long 0x66406490,0x1de068f0,0x3f8024c0,0x0,0x666064d8,0x1df068f8,0x3f802510,0x0
.long 0x668060b0,0x2a006900,0x3f802560,0x0,0x66a060f8,0x2a106908,0x3f8025b0,0x0
.long 0x66c06140,0x2a206910,0x3f802600,0x0,0x66e06188,0x2a306918,0x3f802650,0x0
.long 0x670061d0,0x2a406920,0x3f8026a0,0x0,0x67206218,0x2a506928,0x3f8026f0,0x0
.long 0x67406260,0x2a606930,0x3f802740,0x0,0x676062a8,0x2a706938,0x3f802790,0x0
.long 0x678062f0,0x2a806940,0x3f8027e0,0x0,0x67a06338,0x2a906948,0x3f802830,0x0
.long 0x67c06380,0x2aa06950,0x3f802880,0x0,0x67e063c8,0x2ab06958,0x3f8028d0,0x0
.long 0x68006410,0x2ac06960,0x3f802920,0x0,0x68206458,0x2ad06968,0x3f802970,0x0
.long 0x684064a0,0x2ae06970,0x3f8029c0,0x0,0x686064e8,0x2af06978,0x3f802a10,0x0
.long 0x33802ac0,0x4003b80,0x3f802a20,0x0,0x33a02b08,0x4103b88,0x3f800298,0x0
.long 0x33c02b50,0x4203b90,0x3f8002e8,0x0,0x33e02b98,0x4303b98,0x3f800338,0x0
.long 0x34002be0,0x4403ba0,0x3f800388,0x0,0x34202c28,0x4503ba8,0x3f8003d8,0x0
.long 0x34402c70,0x4603bb0,0x3f800428,0x0,0x34602cb8,0x4703bb8,0x3f800478,0x0
.long 0x34802d00,0x4803bc0,0x3f8004c8,0x0,0x34a02d48,0x4903bc8,0x3f800518,0x0
.long 0x34c02d90,0x4a03bd0,0x3f800568,0x0,0x34e02dd8,0x4b03bd8,0x3f8005b8,0x0
.long 0x35002e20,0x4c03be0,0x3f800608,0x0,0x35202e68,0x4d03be8,0x3f800658,0x0
.long 0x35402eb0,0x4e03bf0,0x3f8006a8,0x0,0x35602ef8,0x4f03bf8,0x3f8006f8,0x0
.long 0x35802ac0,0x11003c00,0x3f800748,0x0,0x35a02b08,0x11103c08,0x3f800798,0x0
.long 0x35c02b50,0x11203c10,0x3f8007e8,0x0,0x35e02b98,0x11303c18,0x3f800838,0x0
.long 0x36002be0,0x11403c20,0x3f800888,0x0,0x36202c28,0x11503c28,0x3f8008d8,0x0
.long 0x36402c70,0x11603c30,0x3f800928,0x0,0x36602cb8,0x11703c38,0x3f800978,0x0
.long 0x36802d00,0x11803c40,0x3f8009c8,0x0,0x36a02d48,0x11903c48,0x3f800a18,0x0
.long 0x36c02d90,0x11a03c50,0x3f800a68,0x0,0x36e02dd8,0x11b03c58,0x3f800ab8,0x0
.long 0x37002e20,0x11c03c60,0x3f800b08,0x0,0x37202e68,0x11d03c68,0x3f800b58,0x0
.long 0x37402eb0,0x11e03c70,0x3f800ba8,0x0,0x37602ef8,0x11f03c78,0x3f800bf8,0x0
.long 0x37802ac0,0x1e003b80,0x3f802a20,0x0,0x37a02b08,0x1e103b88,0x3f800ca0,0x0
.long 0x37c02b50,0x1e203b90,0x3f800cf0,0x0,0x37e02b98,0x1e303b98,0x3f800d40,0x0
.long 0x38002be0,0x1e403ba0,0x3f800d90,0x0,0x38202c28,0x1e503ba8,0x3f800de0,0x0
.long 0x38402c70,0x1e603bb0,0x3f800e30,0x0,0x38602cb8,0x1e703bb8,0x3f800e80,0x0
.long 0x38802d00,0x1e803bc0,0x3f800ed0,0x0,0x38a02d48,0x1e903bc8,0x3f800f20,0x0
.long 0x38c02d90,0x1ea03bd0,0x3f800f70,0x0,0x38e02dd8,0x1eb03bd8,0x3f800fc0,0x0
.long 0x39002e20,0x1ec03be0,0x3f801010,0x0,0x39202e68,0x1ed03be8,0x3f801060,0x0
.long 0x39402eb0,0x1ee03bf0,0x3f8010b0,0x0,0x39602ef8,0x1ef03bf8,0x3f801100,0x0
.long 0x39802ac0,0x2b003c00,0x3f801150,0x0,0x39a02b08,0x2b103c08,0x3f8011a0,0x0
.long 0x39c02b50,0x2b203c10,0x3f8011f0,0x0,0x39e02b98,0x2b303c18,0x3f801240,0x0
.long 0x3a002be0,0x2b403c20,0x3f801290,0x0,0x3a202c28,0x2b503c28,0x3f8012e0,0x0
.long 0x3a402c70,0x2b603c30,0x3f801330,0x0,0x3a602cb8,0x2b703c38,0x3f801380,0x0
.long 0x3a802d00,0x2b803c40,0x3f8013d0,0x0,0x3aa02d48,0x2b903c48,0x3f801420,0x0
.long 0x3ac02d90,0x2ba03c50,0x3f801470,0x0,0x3ae02dd8,0x2bb03c58,0x3f8014c0,0x0
.long 0x3b002e20,0x2bc03c60,0x3f801510,0x0,0x3b202e68,0x2bd03c68,0x3f801560,0x0
.long 0x3b402eb0,0x2be03c70,0x3f8015b0,0x0,0x3b602ef8,0x2bf03c78,0x3f801600,0x0
.long 0x45803cc0,0x5004d80,0x3f802a20,0x0,0x45a03d08,0x5104d88,0x3f8016a8,0x0
.long 0x45c03d50,0x5204d90,0x3f8016f8,0x0,0x45e03d98,0x5304d98,0x3f801748,0x0
.long 0x46003de0,0x5404da0,0x3f801798,0x0,0x46203e28,0x5504da8,0x3f8017e8,0x0
.long 0x46403e70,0x5604db0,0x3f801838,0x0,0x46603eb8,0x5704db8,0x3f801888,0x0
.long 0x46803f00,0x5804dc0,0x3f8018d8,0x0,0x46a03f48,0x5904dc8,0x3f801928,0x0
.long 0x46c03f90,0x5a04dd0,0x3f801978,0x0,0x46e03fd8,0x5b04dd8,0x3f8019c8,0x0
.long 0x47004020,0x5c04de0,0x3f801a18,0x0,0x47204068,0x5d04de8,0x3f801a68,0x0
.long 0x474040b0,0x5e04df0,0x3f801ab8,0x0,0x476040f8,0x5f04df8,0x3f801b08,0x0
.long 0x47803cc0,0x12004e00,0x3f801b58,0x0,0x47a03d08,0x12104e08,0x3f801ba8,0x0
.long 0x47c03d50,0x12204e10,0x3f801bf8,0x0,0x47e03d98,0x12304e18,0x3f801c48,0x0
.long 0x48003de0,0x12404e20,0x3f801c98,0x0,0x48203e28,0x12504e28,0x3f801ce8,0x0
.long 0x48403e70,0x12604e30,0x3f801d38,0x0,0x48603eb8,0x12704e38,0x3f801d88,0x0
.long 0x48803f00,0x12804e40,0x3f801dd8,0x0,0x48a03f48,0x12904e48,0x3f801e28,0x0
.long 0x48c03f90,0x12a04e50,0x3f801e78,0x0,0x48e03fd8,0x12b04e58,0x3f801ec8,0x0
.long 0x49004020,0x12c04e60,0x3f801f18,0x0,0x49204068,0x12d04e68,0x3f801f68,0x0
.long 0x494040b0,0x12e04e70,0x3f801fb8,0x0,0x496040f8,0x12f04e78,0x3f802008,0x0
.long 0x49803cc0,0x1f004d80,0x3f802a20,0x0,0x49a03d08,0x1f104d88,0x3f8020b0,0x0
.long 0x49c03d50,0x1f204d90,0x3f802100,0x0,0x49e03d98,0x1f304d98,0x3f802150,0x0
.long 0x4a003de0,0x1f404da0,0x3f8021a0,0x0,0x4a203e28,0x1f504da8,0x3f8021f0,0x0
.long 0x4a403e70,0x1f604db0,0x3f802240,0x0,0x4a603eb8,0x1f704db8,0x3f802290,0x0
.long 0x4a803f00,0x1f804dc0,0x3f8022e0,0x0,0x4aa03f48,0x1f904dc8,0x3f802330,0x0
.long 0x4ac03f90,0x1fa04dd0,0x3f802380,0x0,0x4ae03fd8,0x1fb04dd8,0x3f8023d0,0x0
.long 0x4b004020,0x1fc04de0,0x3f802420,0x0,0x4b204068,0x1fd04de8,0x3f802470,0x0
.long 0x4b4040b0,0x1fe04df0,0x3f8024c0,0x0,0x4b6040f8,0x1ff04df8,0x3f802510,0x0
.long 0x4b803cc0,0x2c004e00,0x3f802560,0x0,0x4ba03d08,0x2c104e08,0x3f8025b0,0x0
.long 0x4bc03d50,0x2c204e10,0x3f802600,0x0,0x4be03d98,0x2c304e18,0x3f802650,0x0
.long 0x4c003de0,0x2c404e20,0x3f8026a0,0x0,0x4c203e28,0x2c504e28,0x3f8026f0,0x0
.long 0x4c403e70,0x2c604e30,0x3f802740,0x0,0x4c603eb8,0x2c704e38,0x3f802790,0x0
.long 0x4c803f00,0x2c804e40,0x3f8027e0,0x0,0x4ca03f48,0x2c904e48,0x3f802830,0x0
.long 0x4cc03f90,0x2ca04e50,0x3f802880,0x0,0x4ce03fd8,0x2cb04e58,0x3f8028d0,0x0
.long 0x4d004020,0x2cc04e60,0x3f802920,0x0,0x4d204068,0x2cd04e68,0x3f802970,0x0
.long 0x4d4040b0,0x2ce04e70,0x3f8029c0,0x0,0x4d6040f8,0x2cf04e78,0x3f802a10,0x0
.long 0x57804ec0,0x6005f80,0x3f002a20,0x0,0x57a04f08,0x6005f88,0x3f800298,0x0
.long 0x57c04f50,0x6005f90,0x3f8002e8,0x0,0x57e04f98,0x6005f98,0x3f800338,0x0
.long 0x58004fe0,0x6005fa0,0x3f800388,0x0,0x58205028,0x6005fa8,0x3f8003d8,0x0
.long 0x58405070,0x6005fb0,0x3f800428,0x0,0x586050b8,0x6005fb8,0x3f800478,0x0
.long 0x58805100,0x6005fc0,0x3f8004c8,0x0,0x58a05148,0x6005fc8,0x3f800518,0x0
.long 0x58c05190,0x6005fd0,0x3f800568,0x0,0x58e051d8,0x6005fd8,0x3f8005b8,0x0
.long 0x59005220,0x6005fe0,0x3f800608,0x0,0x59205268,0x6005fe8,0x3f800658,0x0
.long 0x594052b0,0x6005ff0,0x3f8006a8,0x0,0x596052f8,0x6005ff8,0x3f8006f8,0x0
.long 0x59804ec0,0x13006000,0x3f000748,0x0,0x59a04f08,0x13006008,0x3f800798,0x0
.long 0x59c04f50,0x13006010,0x3f8007e8,0x0,0x59e04f98,0x13006018,0x3f800838,0x0
.long 0x5a004fe0,0x13006020,0x3f800888,0x0,0x5a205028,0x13006028,0x3f8008d8,0x0
.long 0x5a405070,0x13006030,0x3f800928,0x0,0x5a6050b8,0x13006038,0x3f800978,0x0
.long 0x5a805100,0x13006040,0x3f8009c8,0x0,0x5aa05148,0x13006048,0x3f800a18,0x0
.long 0x5ac05190,0x13006050,0x3f800a68,0x0,0x5ae051d8,0x13006058,0x3f800ab8,0x0
.long 0x5b005220,0x13006060,0x3f800b08,0x0,0x5b205268,0x13006068,0x3f800b58,0x0
.long 0x5b4052b0,0x13006070,0x3f800ba8,0x0,0x5b6052f8,0x13006078,0x3f800bf8,0x0
.long 0x5b804ec0,0x20005f80,0x3f002a20,0x0,0x5ba04f08,0x20005f88,0x3f800ca0,0x0
.long 0x5bc04f50,0x20005f90,0x3f800cf0,0x0,0x5be04f98,0x20005f98,0x3f800d40,0x0
.long 0x5c004fe0,0x20005fa0,0x3f800d90,0x0,0x5c205028,0x20005fa8,0x3f800de0,0x0
.long 0x5c405070,0x20005fb0,0x3f800e30,0x0,0x5c6050b8,0x20005fb8,0x3f800e80,0x0
.long 0x5c805100,0x20005fc0,0x3f800ed0,0x0,0x5ca05148,0x20005fc8,0x3f800f20,0x0
.long 0x5cc05190,0x20005fd0,0x3f800f70,0x0,0x5ce051d8,0x20005fd8,0x3f800fc0,0x0
.long 0x5d005220,0x20005fe0,0x3f801010,0x0,0x5d205268,0x20005fe8,0x3f801060,0x0
.long 0x5d4052b0,0x20005ff0,0x3f8010b0,0x0,0x5d6052f8,0x20005ff8,0x3f801100,0x0
.long 0x5d804ec0,0x2d006000,0x3f001150,0x0,0x5da04f08,0x2d006008,0x3f8011a0,0x0
.long 0x5dc04f50,0x2d006010,0x3f8011f0,0x0,0x5de04f98,0x2d006018,0x3f801240,0x0
.long 0x5e004fe0,0x2d006020,0x3f801290,0x0,0x5e205028,0x2d006028,0x3f8012e0,0x0
.long 0x5e405070,0x2d006030,0x3f801330,0x0,0x5e6050b8,0x2d006038,0x3f801380,0x0
.long 0x5e805100,0x2d006040,0x3f8013d0,0x0,0x5ea05148,0x2d006048,0x3f801420,0x0
.long 0x5ec05190,0x2d006050,0x3f801470,0x0,0x5ee051d8,0x2d006058,0x3f8014c0,0x0
.long 0x5f005220,0x2d006060,0x3f801510,0x0,0x5f205268,0x2d006068,0x3f801560,0x0
.long 0x5f4052b0,0x2d006070,0x3f8015b0,0x0,0x5f6052f8,0x2d006078,0x3f801600,0x0
.long 0x698060c0,0x6007180,0x3f802a20,0x0,0x69a06108,0x6007188,0x3f8016a8,0x0
.long 0x69c06150,0x6007190,0x3f8016f8,0x0,0x69e06198,0x6007198,0x3f801748,0x0
.long 0x6a0061e0,0x60071a0,0x3f801798,0x0,0x6a206228,0x60071a8,0x3f8017e8,0x0
.long 0x6a406270,0x60071b0,0x3f801838,0x0,0x6a6062b8,0x60071b8,0x3f801888,0x0
.long 0x6a806300,0x60071c0,0x3f8018d8,0x0,0x6aa06348,0x60071c8,0x3f801928,0x0
.long 0x6ac06390,0x60071d0,0x3f801978,0x0,0x6ae063d8,0x60071d8,0x3f8019c8,0x0
.long 0x6b006420,0x60071e0,0x3f801a18,0x0,0x6b206468,0x60071e8,0x3f801a68,0x0
.long 0x6b4064b0,0x60071f0,0x3f801ab8,0x0,0x6b6064f8,0x60071f8,0x3f801b08,0x0
.long 0x6b8060c0,0x13007200,0x3f801b58,0x0,0x6ba06108,0x13007208,0x3f801ba8,0x0
.long 0x6bc06150,0x13007210,0x3f801bf8,0x0,0x6be06198,0x13007218,0x3f801c48,0x0
.long 0x6c0061e0,0x13007220,0x3f801c98,0x0,0x6c206228,0x13007228,0x3f801ce8,0x0
.long 0x6c406270,0x13007230,0x3f801d38,0x0,0x6c6062b8,0x13007238,0x3f801d88,0x0
.long 0x6c806300,0x13007240,0x3f801dd8,0x0,0x6ca06348,0x13007248,0x3f801e28,0x0
.long 0x6cc06390,0x13007250,0x3f801e78,0x0,0x6ce063d8,0x13007258,0x3f801ec8,0x0
.long 0x6d006420,0x13007260,0x3f801f18,0x0,0x6d206468,0x13007268,0x3f801f68,0x0
.long 0x6d4064b0,0x13007270,0x3f801fb8,0x0,0x6d6064f8,0x13007278,0x3f802008,0x0
.long 0x6d8060c0,0x20007180,0x3f802a20,0x0,0x6da06108,0x20007188,0x3f8020b0,0x0
.long 0x6dc06150,0x20007190,0x3f802100,0x0,0x6de06198,0x20007198,0x3f802150,0x0
.long 0x6e0061e0,0x200071a0,0x3f8021a0,0x0,0x6e206228,0x200071a8,0x3f8021f0,0x0
.long 0x6e406270,0x200071b0,0x3f802240,0x0,0x6e6062b8,0x200071b8,0x3f802290,0x0
.long 0x6e806300,0x200071c0,0x3f8022e0,0x0,0x6ea06348,0x200071c8,0x3f802330,0x0
.long 0x6ec06390,0x200071d0,0x3f802380,0x0,0x6ee063d8,0x200071d8,0x3f8023d0,0x0
.long 0x6f006420,0x200071e0,0x3f802420,0x0,0x6f206468,0x200071e8,0x3f802470,0x0
.long 0x6f4064b0,0x200071f0,0x3f8024c0,0x0,0x6f6064f8,0x200071f8,0x3f802510,0x0
.long 0x6f8060c0,0x2d007200,0x3f802560,0x0,0x6fa06108,0x2d007208,0x3f8025b0,0x0
.long 0x6fc06150,0x2d007210,0x3f802600,0x0,0x6fe06198,0x2d007218,0x3f802650,0x0
.long 0x700061e0,0x2d007220,0x3f8026a0,0x0,0x70206228,0x2d007228,0x3f8026f0,0x0
.long 0x70406270,0x2d007230,0x3f802740,0x0,0x706062b8,0x2d007238,0x3f802790,0x0
.long 0x70806300,0x2d007240,0x3f8027e0,0x0,0x70a06348,0x2d007248,0x3f802830,0x0
.long 0x70c06390,0x2d007250,0x3f802880,0x0,0x70e063d8,0x2d007258,0x3f8028d0,0x0
.long 0x71006420,0x2d007260,0x3f802920,0x0,0x71206468,0x2d007268,0x3f802970,0x0
.long 0x714064b0,0x2d007270,0x3f8029c0,0x0,0x716064f8,0x2d007278,0x3f802a10,0x0
code_end:
.section .rodata,"a"
.p2align 6
.amdhsa_kernel phK_kernel
  .amdhsa_next_free_vgpr 256
  .amdhsa_next_free_sgpr 102
  .amdhsa_accum_offset 256
  .amdhsa_group_segment_fixed_size 0
  .amdhsa_kernarg_size 88
  .amdhsa_user_sgpr_count 2
  .amdhsa_user_sgpr_kernarg_segment_ptr 1
  .amdhsa_system_sgpr_workgroup_id_x 1
.end_amdhsa_kernel
```
